```python
import torch

def _softmax(x, axis=-1):
    return torch.softmax(x, dim=axis)
def _gelu(x):
    return torch.nn.functional.gelu(x, approximate="tanh")
def _silu(x):
    return torch.nn.functional.silu(x)
def _sigmoid(x):
    return torch.sigmoid(x)
def _layernorm(x, axis=-1, eps=1e-5):
    m = x.mean(dim=axis, keepdim=True)
    v = x.var(dim=axis, keepdim=True, unbiased=False)
    return (x - m) / torch.sqrt(v + eps)
def _scatter_add(tgt, idx, src, axis=0):
    return tgt.clone().index_add_(axis, idx, src)
def _segment_sum(src, seg, n):
    out = torch.zeros((n,) + src.shape[1:], dtype=src.dtype)
    return out.index_add_(0, seg, src)
def _pad(x, pw):
    flat = tuple(v for pair in reversed(pw) for v in pair)
    return torch.nn.functional.pad(x, flat)

kernel_name = 'interleave_layers__sliding_local_dilated__mixer_s_mlp__prompt'

def setup_inputs():

    _w = (lambda a: (lambda t: t.to(torch.bfloat16) if t.is_floating_point() else t)(torch.as_tensor(a)))
    def _A_setup():
        B, S, D = 1, 2048, 448
        return {
            "x": _w((lambda *s: torch.randn(*s, dtype=torch.bfloat16) * 0.05)(B, S, D)),
            "wqkv": _w((lambda *s: torch.randn(*s, dtype=torch.bfloat16) * 0.1)(D, 3 * D)),
            "wo": _w((lambda *s: torch.randn(*s, dtype=torch.bfloat16) * 0.1)(D, D)),
        }
    _A_in = _A_setup()

    def _B_setup():
        B, S, D, F = 1, 2048, 448, 1792
        return {
            "x":  _w((lambda *s: torch.randn(*s, dtype=torch.bfloat16) * 0.05)(B, S, D)),
            "w1": _w((lambda *s: torch.randn(*s, dtype=torch.bfloat16) * 3.2)(D, D) * (D ** -0.5)),
            "w2": _w((lambda *s: torch.randn(*s, dtype=torch.bfloat16) * 3.2)(D, D) * (D ** -0.5)),
            "w3": _w((lambda *s: torch.randn(*s, dtype=torch.bfloat16) * 3.2)(D, F) * (D ** -0.5)),
            "w4": _w((lambda *s: torch.randn(*s, dtype=torch.bfloat16) * 3.2)(F, D) * (F ** -0.5)),
        }
    _B_in = _B_setup()

    return {
        "A_x": _A_in["x"],
        "A_wqkv": _A_in["wqkv"],
        "A_wo": _A_in["wo"],
        "B_x": _B_in["x"],
        "B_w1": _B_in["w1"],
        "B_w2": _B_in["w2"],
        "B_w3": _B_in["w3"],
        "B_w4": _B_in["w4"],
    }

def reference(A_x, A_wqkv, A_wo, B_x, B_w1, B_w2, B_w3, B_w4):
    def _A_ref(x, wqkv, wo):
        B, S, D = x.shape
        H = 16; Dh = D // H
        W, dil = 8, 2
        qkv = (lambda x, *d: x.permute(*d))((x @ wqkv).reshape(B, S, 3, H, Dh), 2, 0, 3, 1, 4)
        q, k, v = qkv[0], qkv[1], qkv[2]
        scale = Dh ** -0.5
        pos = torch.arange(S)
        off = torch.arange(W) * dil
        idx = pos[:, None] - off[None, :]
        mask = idx >= 0
        idx_c = torch.where(mask, idx, 0).reshape(-1)
        kg = k[:, :, idx_c, :].reshape(B, H, S, W, Dh)
        vg = v[:, :, idx_c, :].reshape(B, H, S, W, Dh)
        logits = torch.einsum("bhsd,bhswd->bhsw", q, kg) * scale
        logits = torch.where(mask[None, None, :, :], logits, -1e9)
        attn = _softmax(logits, axis=-1)
        o = torch.einsum("bhsw,bhswd->bhsd", attn, vg)
        return (lambda x, *d: x.permute(*d))(o, 0, 2, 1, 3).reshape(B, S, D) @ wo

    def _B_ref(x, w1, w2, w3, w4):
        B, S, D = x.shape
        h = _gelu(_layernorm(x, axis=-1) @ w1)
        c = D // 4
        g0 = _pad(h[:, :, 0*c:1*c], ((0, 0), (1, 0), (0, 0)))[:, :S, :]
        g1 = _pad(h[:, :, 1*c:2*c], ((0, 0), (0, 1), (0, 0)))[:, 1:, :]
        g2 = _pad(h[:, :, 2*c:3*c], ((0, 0), (2, 0), (0, 0)))[:, :S, :]
        g3 = _pad(h[:, :, 3*c:   ], ((0, 0), (0, 2), (0, 0)))[:, 2:, :]
        hs = torch.concatenate([g0, g1, g2, g3], axis=-1) @ w2
        x1 = x + hs
        h2 = _gelu(_layernorm(x1, axis=-1) @ w3) @ w4
        return x1 + h2

    x = A_x
    x = x + _A_ref(_layernorm(x, axis=-1), A_wqkv, A_wo)
    x = x + _B_ref(_layernorm(x, axis=-1), B_w1, B_w2, B_w3, B_w4)
    x = x + _A_ref(_layernorm(x, axis=-1), A_wqkv, A_wo)
    x = x + _B_ref(_layernorm(x, axis=-1), B_w1, B_w2, B_w3, B_w4)
    return x
```

```asm
; @launch kernel=prep_kernel grid=(354,1,1) block=(256,1,1) lds=0
; @launch kernel=qkv0_kernel grid=(256,1,1) block=(512,1,1) lds=106240
; @launch kernel=wo0_kernel grid=(256,1,1) block=(512,1,1) lds=29952
; @launch kernel=w10_kernel grid=(256,1,1) block=(512,1,1) lds=29952
; @launch kernel=w20_kernel grid=(256,1,1) block=(512,1,1) lds=29952
; @launch kernel=w30_kernel grid=(224,1,1) block=(512,1,1) lds=59904
; @launch kernel=w40_kernel grid=(256,1,1) block=(512,1,1) lds=115968
; @launch kernel=qkv1_kernel grid=(256,1,1) block=(512,1,1) lds=106240
; @launch kernel=wo1_kernel grid=(256,1,1) block=(512,1,1) lds=29952
; @launch kernel=w11_kernel grid=(256,1,1) block=(512,1,1) lds=29952
; @launch kernel=w21_kernel grid=(256,1,1) block=(512,1,1) lds=29952
; @launch kernel=w31_kernel grid=(224,1,1) block=(512,1,1) lds=59904
; @launch kernel=w41_kernel grid=(256,1,1) block=(512,1,1) lds=115968
.amdgcn_target "amdgcn-amd-amdhsa--gfx950"
.text
.globl prep_kernel
.p2align 8
.type prep_kernel,@function
prep_kernel:
    v_lshrrev_b32 v1, 6, v0
    s_nop 0
    v_readfirstlane_b32 s3, v1
    s_lshl_b32 s4, s2, 2
    s_add_u32 s4, s4, s3
    s_cmp_ge_u32 s4, 1414
    s_cbranch_scc1 L_prep_done
    s_load_dwordx4 s[8:11], s[0:1], 0
    s_load_dwordx4 s[12:15], s[0:1], 16
    s_load_dwordx4 s[16:19], s[0:1], 32
    s_load_dwordx4 s[20:23], s[0:1], 48
    s_load_dwordx2 s[24:25], s[0:1], 80
    v_and_b32 v2, 63, v0
    v_lshrrev_b32 v3, 4, v2
    v_and_b32 v4, 15, v2
    v_lshlrev_b32 v5, 4, v2
    s_lshl_b32 s4, s4, 2
    s_waitcnt lgkmcnt(0)
    s_mov_b32 s28, s24
    s_mov_b32 s29, s25
    s_and_b32 s29, s29, 0xffff
    s_mov_b32 s30, 0x10000000
    s_mov_b32 s31, 0x00020000
    s_add_u32 s48, s4, 0
    s_cmp_ge_u32 s48, 1344
    s_cbranch_scc1 L_prep_n_A_wqkv_0
    s_sub_u32 s5, s48, 0
    s_mul_hi_u32 s6, s5, 0x12492493
    s_mul_i32 s32, s6, 14
    s_sub_u32 s7, s5, s32
    s_mul_hi_u32 s34, s6, 0x15555556
    s_mul_i32 s32, s34, 12
    s_sub_u32 s35, s6, s32
    s_lshr_b32 s36, s35, 2
    s_and_b32 s37, s35, 3
    s_mul_i32 s33, s36, 448
    s_mul_i32 s32, s34, 56
    s_add_u32 s33, s33, s32
    s_lshl_b32 s32, s37, 4
    s_add_u32 s33, s33, s32
    s_mov_b32 s40, s10
    s_mov_b32 s41, s11
    s_and_b32 s41, s41, 0xffff
    s_mov_b32 s42, 0x126000
    s_mov_b32 s43, 0x00020000
    s_mul_i32 s44, s7, 43008
    s_add_u32 s44, s44, s33
    s_lshl_b32 s44, s44, 1
    s_movk_i32 s45, 10752
    v_mul_lo_u32 v6, v3, s45
    v_add_lshl_u32 v6, v6, v4, 1
    s_add_u32 s46, s44, 0
    buffer_load_ushort v16, v6, s[40:43], s46 offen
    s_add_u32 s46, s44, 2688
    buffer_load_ushort v17, v6, s[40:43], s46 offen
    s_add_u32 s46, s44, 5376
    buffer_load_ushort v18, v6, s[40:43], s46 offen
    s_add_u32 s46, s44, 8064
    buffer_load_ushort v19, v6, s[40:43], s46 offen
    s_add_u32 s46, s44, 10752
    buffer_load_ushort v20, v6, s[40:43], s46 offen
    s_add_u32 s46, s44, 13440
    buffer_load_ushort v21, v6, s[40:43], s46 offen
    s_add_u32 s46, s44, 16128
    buffer_load_ushort v22, v6, s[40:43], s46 offen
    s_add_u32 s46, s44, 18816
    buffer_load_ushort v23, v6, s[40:43], s46 offen
    s_lshl_b32 s60, s5, 10
    s_add_u32 s60, s60, 0x0
    s_branch L_prep_b0_done
L_prep_n_A_wqkv_0:
    s_cmp_ge_u32 s48, 1736
    s_cbranch_scc1 L_prep_n_A_wo_0
    s_sub_u32 s5, s48, 1344
    s_mul_hi_u32 s6, s5, 0x12492493
    s_mul_i32 s32, s6, 14
    s_sub_u32 s7, s5, s32
    s_lshl_b32 s33, s6, 4
    s_mov_b32 s40, s12
    s_mov_b32 s41, s13
    s_and_b32 s41, s41, 0xffff
    s_mov_b32 s42, 0x62000
    s_mov_b32 s43, 0x00020000
    s_mul_i32 s44, s7, 14336
    s_add_u32 s44, s44, s33
    s_lshl_b32 s44, s44, 1
    s_movk_i32 s45, 3584
    v_mul_lo_u32 v6, v3, s45
    v_add_lshl_u32 v6, v6, v4, 1
    s_add_u32 s46, s44, 0
    buffer_load_ushort v16, v6, s[40:43], s46 offen
    s_add_u32 s46, s44, 896
    buffer_load_ushort v17, v6, s[40:43], s46 offen
    s_add_u32 s46, s44, 1792
    buffer_load_ushort v18, v6, s[40:43], s46 offen
    s_add_u32 s46, s44, 2688
    buffer_load_ushort v19, v6, s[40:43], s46 offen
    s_add_u32 s46, s44, 3584
    buffer_load_ushort v20, v6, s[40:43], s46 offen
    s_add_u32 s46, s44, 4480
    buffer_load_ushort v21, v6, s[40:43], s46 offen
    s_add_u32 s46, s44, 5376
    buffer_load_ushort v22, v6, s[40:43], s46 offen
    s_add_u32 s46, s44, 6272
    buffer_load_ushort v23, v6, s[40:43], s46 offen
    s_lshl_b32 s60, s5, 10
    s_add_u32 s60, s60, 0x150000
    s_branch L_prep_b0_done
L_prep_n_A_wo_0:
    s_cmp_ge_u32 s48, 2128
    s_cbranch_scc1 L_prep_n_B_w1_0
    s_sub_u32 s5, s48, 1736
    s_mul_hi_u32 s6, s5, 0x12492493
    s_mul_i32 s32, s6, 14
    s_sub_u32 s7, s5, s32
    s_lshl_b32 s33, s6, 4
    s_mov_b32 s40, s16
    s_mov_b32 s41, s17
    s_and_b32 s41, s41, 0xffff
    s_mov_b32 s42, 0x62000
    s_mov_b32 s43, 0x00020000
    s_mul_i32 s44, s7, 14336
    s_add_u32 s44, s44, s33
    s_lshl_b32 s44, s44, 1
    s_movk_i32 s45, 3584
    v_mul_lo_u32 v6, v3, s45
    v_add_lshl_u32 v6, v6, v4, 1
    s_add_u32 s46, s44, 0
    buffer_load_ushort v16, v6, s[40:43], s46 offen
    s_add_u32 s46, s44, 896
    buffer_load_ushort v17, v6, s[40:43], s46 offen
    s_add_u32 s46, s44, 1792
    buffer_load_ushort v18, v6, s[40:43], s46 offen
    s_add_u32 s46, s44, 2688
    buffer_load_ushort v19, v6, s[40:43], s46 offen
    s_add_u32 s46, s44, 3584
    buffer_load_ushort v20, v6, s[40:43], s46 offen
    s_add_u32 s46, s44, 4480
    buffer_load_ushort v21, v6, s[40:43], s46 offen
    s_add_u32 s46, s44, 5376
    buffer_load_ushort v22, v6, s[40:43], s46 offen
    s_add_u32 s46, s44, 6272
    buffer_load_ushort v23, v6, s[40:43], s46 offen
    s_lshl_b32 s60, s5, 10
    s_add_u32 s60, s60, 0x1b2000
    s_branch L_prep_b0_done
L_prep_n_B_w1_0:
    s_cmp_ge_u32 s48, 2520
    s_cbranch_scc1 L_prep_n_B_w2_0
    s_sub_u32 s5, s48, 2128
    s_mul_hi_u32 s6, s5, 0x12492493
    s_mul_i32 s32, s6, 14
    s_sub_u32 s7, s5, s32
    s_lshl_b32 s33, s6, 4
    s_mov_b32 s40, s18
    s_mov_b32 s41, s19
    s_and_b32 s41, s41, 0xffff
    s_mov_b32 s42, 0x62000
    s_mov_b32 s43, 0x00020000
    s_mul_i32 s44, s7, 14336
    s_add_u32 s44, s44, s33
    s_lshl_b32 s44, s44, 1
    s_movk_i32 s45, 3584
    v_mul_lo_u32 v6, v3, s45
    v_add_lshl_u32 v6, v6, v4, 1
    s_add_u32 s46, s44, 0
    buffer_load_ushort v16, v6, s[40:43], s46 offen
    s_add_u32 s46, s44, 896
    buffer_load_ushort v17, v6, s[40:43], s46 offen
    s_add_u32 s46, s44, 1792
    buffer_load_ushort v18, v6, s[40:43], s46 offen
    s_add_u32 s46, s44, 2688
    buffer_load_ushort v19, v6, s[40:43], s46 offen
    s_add_u32 s46, s44, 3584
    buffer_load_ushort v20, v6, s[40:43], s46 offen
    s_add_u32 s46, s44, 4480
    buffer_load_ushort v21, v6, s[40:43], s46 offen
    s_add_u32 s46, s44, 5376
    buffer_load_ushort v22, v6, s[40:43], s46 offen
    s_add_u32 s46, s44, 6272
    buffer_load_ushort v23, v6, s[40:43], s46 offen
    s_lshl_b32 s60, s5, 10
    s_add_u32 s60, s60, 0x214000
    s_branch L_prep_b0_done
L_prep_n_B_w2_0:
    s_cmp_ge_u32 s48, 4088
    s_cbranch_scc1 L_prep_n_B_w3_0
    s_sub_u32 s5, s48, 2520
    s_mul_hi_u32 s6, s5, 0x12492493
    s_mul_i32 s32, s6, 14
    s_sub_u32 s7, s5, s32
    s_lshl_b32 s33, s6, 4
    s_mov_b32 s40, s20
    s_mov_b32 s41, s21
    s_and_b32 s41, s41, 0xffff
    s_mov_b32 s42, 0x188000
    s_mov_b32 s43, 0x00020000
    s_mul_i32 s44, s7, 57344
    s_add_u32 s44, s44, s33
    s_lshl_b32 s44, s44, 1
    s_movk_i32 s45, 14336
    v_mul_lo_u32 v6, v3, s45
    v_add_lshl_u32 v6, v6, v4, 1
    s_add_u32 s46, s44, 0
    buffer_load_ushort v16, v6, s[40:43], s46 offen
    s_add_u32 s46, s44, 3584
    buffer_load_ushort v17, v6, s[40:43], s46 offen
    s_add_u32 s46, s44, 7168
    buffer_load_ushort v18, v6, s[40:43], s46 offen
    s_add_u32 s46, s44, 10752
    buffer_load_ushort v19, v6, s[40:43], s46 offen
    s_add_u32 s46, s44, 14336
    buffer_load_ushort v20, v6, s[40:43], s46 offen
    s_add_u32 s46, s44, 17920
    buffer_load_ushort v21, v6, s[40:43], s46 offen
    s_add_u32 s46, s44, 21504
    buffer_load_ushort v22, v6, s[40:43], s46 offen
    s_add_u32 s46, s44, 25088
    buffer_load_ushort v23, v6, s[40:43], s46 offen
    s_lshl_b32 s60, s5, 10
    s_add_u32 s60, s60, 0x276000
    s_branch L_prep_b0_done
L_prep_n_B_w3_0:
    s_cmp_ge_u32 s48, 5656
    s_cbranch_scc1 L_prep_n_B_w4_0
    s_sub_u32 s5, s48, 4088
    s_mul_hi_u32 s6, s5, 0x4924925
    s_mul_i32 s32, s6, 56
    s_sub_u32 s7, s5, s32
    s_lshl_b32 s33, s6, 4
    s_mov_b32 s40, s22
    s_mov_b32 s41, s23
    s_and_b32 s41, s41, 0xffff
    s_mov_b32 s42, 0x188000
    s_mov_b32 s43, 0x00020000
    s_mul_i32 s44, s7, 14336
    s_add_u32 s44, s44, s33
    s_lshl_b32 s44, s44, 1
    s_movk_i32 s45, 3584
    v_mul_lo_u32 v6, v3, s45
    v_add_lshl_u32 v6, v6, v4, 1
    s_add_u32 s46, s44, 0
    buffer_load_ushort v16, v6, s[40:43], s46 offen
    s_add_u32 s46, s44, 896
    buffer_load_ushort v17, v6, s[40:43], s46 offen
    s_add_u32 s46, s44, 1792
    buffer_load_ushort v18, v6, s[40:43], s46 offen
    s_add_u32 s46, s44, 2688
    buffer_load_ushort v19, v6, s[40:43], s46 offen
    s_add_u32 s46, s44, 3584
    buffer_load_ushort v20, v6, s[40:43], s46 offen
    s_add_u32 s46, s44, 4480
    buffer_load_ushort v21, v6, s[40:43], s46 offen
    s_add_u32 s46, s44, 5376
    buffer_load_ushort v22, v6, s[40:43], s46 offen
    s_add_u32 s46, s44, 6272
    buffer_load_ushort v23, v6, s[40:43], s46 offen
    s_lshl_b32 s60, s5, 10
    s_add_u32 s60, s60, 0x3fe000
    s_branch L_prep_b0_done
L_prep_n_B_w4_0:
    s_mov_b32 s60, 0x10000000
L_prep_b0_done:
    s_nop 0
    s_add_u32 s48, s4, 1
    s_cmp_ge_u32 s48, 1344
    s_cbranch_scc1 L_prep_n_A_wqkv_1
    s_sub_u32 s5, s48, 0
    s_mul_hi_u32 s6, s5, 0x12492493
    s_mul_i32 s32, s6, 14
    s_sub_u32 s7, s5, s32
    s_mul_hi_u32 s34, s6, 0x15555556
    s_mul_i32 s32, s34, 12
    s_sub_u32 s35, s6, s32
    s_lshr_b32 s36, s35, 2
    s_and_b32 s37, s35, 3
    s_mul_i32 s33, s36, 448
    s_mul_i32 s32, s34, 56
    s_add_u32 s33, s33, s32
    s_lshl_b32 s32, s37, 4
    s_add_u32 s33, s33, s32
    s_mov_b32 s40, s10
    s_mov_b32 s41, s11
    s_and_b32 s41, s41, 0xffff
    s_mov_b32 s42, 0x126000
    s_mov_b32 s43, 0x00020000
    s_mul_i32 s44, s7, 43008
    s_add_u32 s44, s44, s33
    s_lshl_b32 s44, s44, 1
    s_movk_i32 s45, 10752
    v_mul_lo_u32 v6, v3, s45
    v_add_lshl_u32 v6, v6, v4, 1
    s_add_u32 s46, s44, 0
    buffer_load_ushort v24, v6, s[40:43], s46 offen
    s_add_u32 s46, s44, 2688
    buffer_load_ushort v25, v6, s[40:43], s46 offen
    s_add_u32 s46, s44, 5376
    buffer_load_ushort v26, v6, s[40:43], s46 offen
    s_add_u32 s46, s44, 8064
    buffer_load_ushort v27, v6, s[40:43], s46 offen
    s_add_u32 s46, s44, 10752
    buffer_load_ushort v28, v6, s[40:43], s46 offen
    s_add_u32 s46, s44, 13440
    buffer_load_ushort v29, v6, s[40:43], s46 offen
    s_add_u32 s46, s44, 16128
    buffer_load_ushort v30, v6, s[40:43], s46 offen
    s_add_u32 s46, s44, 18816
    buffer_load_ushort v31, v6, s[40:43], s46 offen
    s_lshl_b32 s61, s5, 10
    s_add_u32 s61, s61, 0x0
    s_branch L_prep_b1_done
L_prep_n_A_wqkv_1:
    s_cmp_ge_u32 s48, 1736
    s_cbranch_scc1 L_prep_n_A_wo_1
    s_sub_u32 s5, s48, 1344
    s_mul_hi_u32 s6, s5, 0x12492493
    s_mul_i32 s32, s6, 14
    s_sub_u32 s7, s5, s32
    s_lshl_b32 s33, s6, 4
    s_mov_b32 s40, s12
    s_mov_b32 s41, s13
    s_and_b32 s41, s41, 0xffff
    s_mov_b32 s42, 0x62000
    s_mov_b32 s43, 0x00020000
    s_mul_i32 s44, s7, 14336
    s_add_u32 s44, s44, s33
    s_lshl_b32 s44, s44, 1
    s_movk_i32 s45, 3584
    v_mul_lo_u32 v6, v3, s45
    v_add_lshl_u32 v6, v6, v4, 1
    s_add_u32 s46, s44, 0
    buffer_load_ushort v24, v6, s[40:43], s46 offen
    s_add_u32 s46, s44, 896
    buffer_load_ushort v25, v6, s[40:43], s46 offen
    s_add_u32 s46, s44, 1792
    buffer_load_ushort v26, v6, s[40:43], s46 offen
    s_add_u32 s46, s44, 2688
    buffer_load_ushort v27, v6, s[40:43], s46 offen
    s_add_u32 s46, s44, 3584
    buffer_load_ushort v28, v6, s[40:43], s46 offen
    s_add_u32 s46, s44, 4480
    buffer_load_ushort v29, v6, s[40:43], s46 offen
    s_add_u32 s46, s44, 5376
    buffer_load_ushort v30, v6, s[40:43], s46 offen
    s_add_u32 s46, s44, 6272
    buffer_load_ushort v31, v6, s[40:43], s46 offen
    s_lshl_b32 s61, s5, 10
    s_add_u32 s61, s61, 0x150000
    s_branch L_prep_b1_done
L_prep_n_A_wo_1:
    s_cmp_ge_u32 s48, 2128
    s_cbranch_scc1 L_prep_n_B_w1_1
    s_sub_u32 s5, s48, 1736
    s_mul_hi_u32 s6, s5, 0x12492493
    s_mul_i32 s32, s6, 14
    s_sub_u32 s7, s5, s32
    s_lshl_b32 s33, s6, 4
    s_mov_b32 s40, s16
    s_mov_b32 s41, s17
    s_and_b32 s41, s41, 0xffff
    s_mov_b32 s42, 0x62000
    s_mov_b32 s43, 0x00020000
    s_mul_i32 s44, s7, 14336
    s_add_u32 s44, s44, s33
    s_lshl_b32 s44, s44, 1
    s_movk_i32 s45, 3584
    v_mul_lo_u32 v6, v3, s45
    v_add_lshl_u32 v6, v6, v4, 1
    s_add_u32 s46, s44, 0
    buffer_load_ushort v24, v6, s[40:43], s46 offen
    s_add_u32 s46, s44, 896
    buffer_load_ushort v25, v6, s[40:43], s46 offen
    s_add_u32 s46, s44, 1792
    buffer_load_ushort v26, v6, s[40:43], s46 offen
    s_add_u32 s46, s44, 2688
    buffer_load_ushort v27, v6, s[40:43], s46 offen
    s_add_u32 s46, s44, 3584
    buffer_load_ushort v28, v6, s[40:43], s46 offen
    s_add_u32 s46, s44, 4480
    buffer_load_ushort v29, v6, s[40:43], s46 offen
    s_add_u32 s46, s44, 5376
    buffer_load_ushort v30, v6, s[40:43], s46 offen
    s_add_u32 s46, s44, 6272
    buffer_load_ushort v31, v6, s[40:43], s46 offen
    s_lshl_b32 s61, s5, 10
    s_add_u32 s61, s61, 0x1b2000
    s_branch L_prep_b1_done
L_prep_n_B_w1_1:
    s_cmp_ge_u32 s48, 2520
    s_cbranch_scc1 L_prep_n_B_w2_1
    s_sub_u32 s5, s48, 2128
    s_mul_hi_u32 s6, s5, 0x12492493
    s_mul_i32 s32, s6, 14
    s_sub_u32 s7, s5, s32
    s_lshl_b32 s33, s6, 4
    s_mov_b32 s40, s18
    s_mov_b32 s41, s19
    s_and_b32 s41, s41, 0xffff
    s_mov_b32 s42, 0x62000
    s_mov_b32 s43, 0x00020000
    s_mul_i32 s44, s7, 14336
    s_add_u32 s44, s44, s33
    s_lshl_b32 s44, s44, 1
    s_movk_i32 s45, 3584
    v_mul_lo_u32 v6, v3, s45
    v_add_lshl_u32 v6, v6, v4, 1
    s_add_u32 s46, s44, 0
    buffer_load_ushort v24, v6, s[40:43], s46 offen
    s_add_u32 s46, s44, 896
    buffer_load_ushort v25, v6, s[40:43], s46 offen
    s_add_u32 s46, s44, 1792
    buffer_load_ushort v26, v6, s[40:43], s46 offen
    s_add_u32 s46, s44, 2688
    buffer_load_ushort v27, v6, s[40:43], s46 offen
    s_add_u32 s46, s44, 3584
    buffer_load_ushort v28, v6, s[40:43], s46 offen
    s_add_u32 s46, s44, 4480
    buffer_load_ushort v29, v6, s[40:43], s46 offen
    s_add_u32 s46, s44, 5376
    buffer_load_ushort v30, v6, s[40:43], s46 offen
    s_add_u32 s46, s44, 6272
    buffer_load_ushort v31, v6, s[40:43], s46 offen
    s_lshl_b32 s61, s5, 10
    s_add_u32 s61, s61, 0x214000
    s_branch L_prep_b1_done
L_prep_n_B_w2_1:
    s_cmp_ge_u32 s48, 4088
    s_cbranch_scc1 L_prep_n_B_w3_1
    s_sub_u32 s5, s48, 2520
    s_mul_hi_u32 s6, s5, 0x12492493
    s_mul_i32 s32, s6, 14
    s_sub_u32 s7, s5, s32
    s_lshl_b32 s33, s6, 4
    s_mov_b32 s40, s20
    s_mov_b32 s41, s21
    s_and_b32 s41, s41, 0xffff
    s_mov_b32 s42, 0x188000
    s_mov_b32 s43, 0x00020000
    s_mul_i32 s44, s7, 57344
    s_add_u32 s44, s44, s33
    s_lshl_b32 s44, s44, 1
    s_movk_i32 s45, 14336
    v_mul_lo_u32 v6, v3, s45
    v_add_lshl_u32 v6, v6, v4, 1
    s_add_u32 s46, s44, 0
    buffer_load_ushort v24, v6, s[40:43], s46 offen
    s_add_u32 s46, s44, 3584
    buffer_load_ushort v25, v6, s[40:43], s46 offen
    s_add_u32 s46, s44, 7168
    buffer_load_ushort v26, v6, s[40:43], s46 offen
    s_add_u32 s46, s44, 10752
    buffer_load_ushort v27, v6, s[40:43], s46 offen
    s_add_u32 s46, s44, 14336
    buffer_load_ushort v28, v6, s[40:43], s46 offen
    s_add_u32 s46, s44, 17920
    buffer_load_ushort v29, v6, s[40:43], s46 offen
    s_add_u32 s46, s44, 21504
    buffer_load_ushort v30, v6, s[40:43], s46 offen
    s_add_u32 s46, s44, 25088
    buffer_load_ushort v31, v6, s[40:43], s46 offen
    s_lshl_b32 s61, s5, 10
    s_add_u32 s61, s61, 0x276000
    s_branch L_prep_b1_done
L_prep_n_B_w3_1:
    s_cmp_ge_u32 s48, 5656
    s_cbranch_scc1 L_prep_n_B_w4_1
    s_sub_u32 s5, s48, 4088
    s_mul_hi_u32 s6, s5, 0x4924925
    s_mul_i32 s32, s6, 56
    s_sub_u32 s7, s5, s32
    s_lshl_b32 s33, s6, 4
    s_mov_b32 s40, s22
    s_mov_b32 s41, s23
    s_and_b32 s41, s41, 0xffff
    s_mov_b32 s42, 0x188000
    s_mov_b32 s43, 0x00020000
    s_mul_i32 s44, s7, 14336
    s_add_u32 s44, s44, s33
    s_lshl_b32 s44, s44, 1
    s_movk_i32 s45, 3584
    v_mul_lo_u32 v6, v3, s45
    v_add_lshl_u32 v6, v6, v4, 1
    s_add_u32 s46, s44, 0
    buffer_load_ushort v24, v6, s[40:43], s46 offen
    s_add_u32 s46, s44, 896
    buffer_load_ushort v25, v6, s[40:43], s46 offen
    s_add_u32 s46, s44, 1792
    buffer_load_ushort v26, v6, s[40:43], s46 offen
    s_add_u32 s46, s44, 2688
    buffer_load_ushort v27, v6, s[40:43], s46 offen
    s_add_u32 s46, s44, 3584
    buffer_load_ushort v28, v6, s[40:43], s46 offen
    s_add_u32 s46, s44, 4480
    buffer_load_ushort v29, v6, s[40:43], s46 offen
    s_add_u32 s46, s44, 5376
    buffer_load_ushort v30, v6, s[40:43], s46 offen
    s_add_u32 s46, s44, 6272
    buffer_load_ushort v31, v6, s[40:43], s46 offen
    s_lshl_b32 s61, s5, 10
    s_add_u32 s61, s61, 0x3fe000
    s_branch L_prep_b1_done
L_prep_n_B_w4_1:
    s_mov_b32 s61, 0x10000000
L_prep_b1_done:
    s_nop 0
    s_add_u32 s48, s4, 2
    s_cmp_ge_u32 s48, 1344
    s_cbranch_scc1 L_prep_n_A_wqkv_2
    s_sub_u32 s5, s48, 0
    s_mul_hi_u32 s6, s5, 0x12492493
    s_mul_i32 s32, s6, 14
    s_sub_u32 s7, s5, s32
    s_mul_hi_u32 s34, s6, 0x15555556
    s_mul_i32 s32, s34, 12
    s_sub_u32 s35, s6, s32
    s_lshr_b32 s36, s35, 2
    s_and_b32 s37, s35, 3
    s_mul_i32 s33, s36, 448
    s_mul_i32 s32, s34, 56
    s_add_u32 s33, s33, s32
    s_lshl_b32 s32, s37, 4
    s_add_u32 s33, s33, s32
    s_mov_b32 s40, s10
    s_mov_b32 s41, s11
    s_and_b32 s41, s41, 0xffff
    s_mov_b32 s42, 0x126000
    s_mov_b32 s43, 0x00020000
    s_mul_i32 s44, s7, 43008
    s_add_u32 s44, s44, s33
    s_lshl_b32 s44, s44, 1
    s_movk_i32 s45, 10752
    v_mul_lo_u32 v6, v3, s45
    v_add_lshl_u32 v6, v6, v4, 1
    s_add_u32 s46, s44, 0
    buffer_load_ushort v32, v6, s[40:43], s46 offen
    s_add_u32 s46, s44, 2688
    buffer_load_ushort v33, v6, s[40:43], s46 offen
    s_add_u32 s46, s44, 5376
    buffer_load_ushort v34, v6, s[40:43], s46 offen
    s_add_u32 s46, s44, 8064
    buffer_load_ushort v35, v6, s[40:43], s46 offen
    s_add_u32 s46, s44, 10752
    buffer_load_ushort v36, v6, s[40:43], s46 offen
    s_add_u32 s46, s44, 13440
    buffer_load_ushort v37, v6, s[40:43], s46 offen
    s_add_u32 s46, s44, 16128
    buffer_load_ushort v38, v6, s[40:43], s46 offen
    s_add_u32 s46, s44, 18816
    buffer_load_ushort v39, v6, s[40:43], s46 offen
    s_lshl_b32 s62, s5, 10
    s_add_u32 s62, s62, 0x0
    s_branch L_prep_b2_done
L_prep_n_A_wqkv_2:
    s_cmp_ge_u32 s48, 1736
    s_cbranch_scc1 L_prep_n_A_wo_2
    s_sub_u32 s5, s48, 1344
    s_mul_hi_u32 s6, s5, 0x12492493
    s_mul_i32 s32, s6, 14
    s_sub_u32 s7, s5, s32
    s_lshl_b32 s33, s6, 4
    s_mov_b32 s40, s12
    s_mov_b32 s41, s13
    s_and_b32 s41, s41, 0xffff
    s_mov_b32 s42, 0x62000
    s_mov_b32 s43, 0x00020000
    s_mul_i32 s44, s7, 14336
    s_add_u32 s44, s44, s33
    s_lshl_b32 s44, s44, 1
    s_movk_i32 s45, 3584
    v_mul_lo_u32 v6, v3, s45
    v_add_lshl_u32 v6, v6, v4, 1
    s_add_u32 s46, s44, 0
    buffer_load_ushort v32, v6, s[40:43], s46 offen
    s_add_u32 s46, s44, 896
    buffer_load_ushort v33, v6, s[40:43], s46 offen
    s_add_u32 s46, s44, 1792
    buffer_load_ushort v34, v6, s[40:43], s46 offen
    s_add_u32 s46, s44, 2688
    buffer_load_ushort v35, v6, s[40:43], s46 offen
    s_add_u32 s46, s44, 3584
    buffer_load_ushort v36, v6, s[40:43], s46 offen
    s_add_u32 s46, s44, 4480
    buffer_load_ushort v37, v6, s[40:43], s46 offen
    s_add_u32 s46, s44, 5376
    buffer_load_ushort v38, v6, s[40:43], s46 offen
    s_add_u32 s46, s44, 6272
    buffer_load_ushort v39, v6, s[40:43], s46 offen
    s_lshl_b32 s62, s5, 10
    s_add_u32 s62, s62, 0x150000
    s_branch L_prep_b2_done
L_prep_n_A_wo_2:
    s_cmp_ge_u32 s48, 2128
    s_cbranch_scc1 L_prep_n_B_w1_2
    s_sub_u32 s5, s48, 1736
    s_mul_hi_u32 s6, s5, 0x12492493
    s_mul_i32 s32, s6, 14
    s_sub_u32 s7, s5, s32
    s_lshl_b32 s33, s6, 4
    s_mov_b32 s40, s16
    s_mov_b32 s41, s17
    s_and_b32 s41, s41, 0xffff
    s_mov_b32 s42, 0x62000
    s_mov_b32 s43, 0x00020000
    s_mul_i32 s44, s7, 14336
    s_add_u32 s44, s44, s33
    s_lshl_b32 s44, s44, 1
    s_movk_i32 s45, 3584
    v_mul_lo_u32 v6, v3, s45
    v_add_lshl_u32 v6, v6, v4, 1
    s_add_u32 s46, s44, 0
    buffer_load_ushort v32, v6, s[40:43], s46 offen
    s_add_u32 s46, s44, 896
    buffer_load_ushort v33, v6, s[40:43], s46 offen
    s_add_u32 s46, s44, 1792
    buffer_load_ushort v34, v6, s[40:43], s46 offen
    s_add_u32 s46, s44, 2688
    buffer_load_ushort v35, v6, s[40:43], s46 offen
    s_add_u32 s46, s44, 3584
    buffer_load_ushort v36, v6, s[40:43], s46 offen
    s_add_u32 s46, s44, 4480
    buffer_load_ushort v37, v6, s[40:43], s46 offen
    s_add_u32 s46, s44, 5376
    buffer_load_ushort v38, v6, s[40:43], s46 offen
    s_add_u32 s46, s44, 6272
    buffer_load_ushort v39, v6, s[40:43], s46 offen
    s_lshl_b32 s62, s5, 10
    s_add_u32 s62, s62, 0x1b2000
    s_branch L_prep_b2_done
L_prep_n_B_w1_2:
    s_cmp_ge_u32 s48, 2520
    s_cbranch_scc1 L_prep_n_B_w2_2
    s_sub_u32 s5, s48, 2128
    s_mul_hi_u32 s6, s5, 0x12492493
    s_mul_i32 s32, s6, 14
    s_sub_u32 s7, s5, s32
    s_lshl_b32 s33, s6, 4
    s_mov_b32 s40, s18
    s_mov_b32 s41, s19
    s_and_b32 s41, s41, 0xffff
    s_mov_b32 s42, 0x62000
    s_mov_b32 s43, 0x00020000
    s_mul_i32 s44, s7, 14336
    s_add_u32 s44, s44, s33
    s_lshl_b32 s44, s44, 1
    s_movk_i32 s45, 3584
    v_mul_lo_u32 v6, v3, s45
    v_add_lshl_u32 v6, v6, v4, 1
    s_add_u32 s46, s44, 0
    buffer_load_ushort v32, v6, s[40:43], s46 offen
    s_add_u32 s46, s44, 896
    buffer_load_ushort v33, v6, s[40:43], s46 offen
    s_add_u32 s46, s44, 1792
    buffer_load_ushort v34, v6, s[40:43], s46 offen
    s_add_u32 s46, s44, 2688
    buffer_load_ushort v35, v6, s[40:43], s46 offen
    s_add_u32 s46, s44, 3584
    buffer_load_ushort v36, v6, s[40:43], s46 offen
    s_add_u32 s46, s44, 4480
    buffer_load_ushort v37, v6, s[40:43], s46 offen
    s_add_u32 s46, s44, 5376
    buffer_load_ushort v38, v6, s[40:43], s46 offen
    s_add_u32 s46, s44, 6272
    buffer_load_ushort v39, v6, s[40:43], s46 offen
    s_lshl_b32 s62, s5, 10
    s_add_u32 s62, s62, 0x214000
    s_branch L_prep_b2_done
L_prep_n_B_w2_2:
    s_cmp_ge_u32 s48, 4088
    s_cbranch_scc1 L_prep_n_B_w3_2
    s_sub_u32 s5, s48, 2520
    s_mul_hi_u32 s6, s5, 0x12492493
    s_mul_i32 s32, s6, 14
    s_sub_u32 s7, s5, s32
    s_lshl_b32 s33, s6, 4
    s_mov_b32 s40, s20
    s_mov_b32 s41, s21
    s_and_b32 s41, s41, 0xffff
    s_mov_b32 s42, 0x188000
    s_mov_b32 s43, 0x00020000
    s_mul_i32 s44, s7, 57344
    s_add_u32 s44, s44, s33
    s_lshl_b32 s44, s44, 1
    s_movk_i32 s45, 14336
    v_mul_lo_u32 v6, v3, s45
    v_add_lshl_u32 v6, v6, v4, 1
    s_add_u32 s46, s44, 0
    buffer_load_ushort v32, v6, s[40:43], s46 offen
    s_add_u32 s46, s44, 3584
    buffer_load_ushort v33, v6, s[40:43], s46 offen
    s_add_u32 s46, s44, 7168
    buffer_load_ushort v34, v6, s[40:43], s46 offen
    s_add_u32 s46, s44, 10752
    buffer_load_ushort v35, v6, s[40:43], s46 offen
    s_add_u32 s46, s44, 14336
    buffer_load_ushort v36, v6, s[40:43], s46 offen
    s_add_u32 s46, s44, 17920
    buffer_load_ushort v37, v6, s[40:43], s46 offen
    s_add_u32 s46, s44, 21504
    buffer_load_ushort v38, v6, s[40:43], s46 offen
    s_add_u32 s46, s44, 25088
    buffer_load_ushort v39, v6, s[40:43], s46 offen
    s_lshl_b32 s62, s5, 10
    s_add_u32 s62, s62, 0x276000
    s_branch L_prep_b2_done
L_prep_n_B_w3_2:
    s_cmp_ge_u32 s48, 5656
    s_cbranch_scc1 L_prep_n_B_w4_2
    s_sub_u32 s5, s48, 4088
    s_mul_hi_u32 s6, s5, 0x4924925
    s_mul_i32 s32, s6, 56
    s_sub_u32 s7, s5, s32
    s_lshl_b32 s33, s6, 4
    s_mov_b32 s40, s22
    s_mov_b32 s41, s23
    s_and_b32 s41, s41, 0xffff
    s_mov_b32 s42, 0x188000
    s_mov_b32 s43, 0x00020000
    s_mul_i32 s44, s7, 14336
    s_add_u32 s44, s44, s33
    s_lshl_b32 s44, s44, 1
    s_movk_i32 s45, 3584
    v_mul_lo_u32 v6, v3, s45
    v_add_lshl_u32 v6, v6, v4, 1
    s_add_u32 s46, s44, 0
    buffer_load_ushort v32, v6, s[40:43], s46 offen
    s_add_u32 s46, s44, 896
    buffer_load_ushort v33, v6, s[40:43], s46 offen
    s_add_u32 s46, s44, 1792
    buffer_load_ushort v34, v6, s[40:43], s46 offen
    s_add_u32 s46, s44, 2688
    buffer_load_ushort v35, v6, s[40:43], s46 offen
    s_add_u32 s46, s44, 3584
    buffer_load_ushort v36, v6, s[40:43], s46 offen
    s_add_u32 s46, s44, 4480
    buffer_load_ushort v37, v6, s[40:43], s46 offen
    s_add_u32 s46, s44, 5376
    buffer_load_ushort v38, v6, s[40:43], s46 offen
    s_add_u32 s46, s44, 6272
    buffer_load_ushort v39, v6, s[40:43], s46 offen
    s_lshl_b32 s62, s5, 10
    s_add_u32 s62, s62, 0x3fe000
    s_branch L_prep_b2_done
L_prep_n_B_w4_2:
    s_mov_b32 s62, 0x10000000
L_prep_b2_done:
    s_nop 0
    s_add_u32 s48, s4, 3
    s_cmp_ge_u32 s48, 1344
    s_cbranch_scc1 L_prep_n_A_wqkv_3
    s_sub_u32 s5, s48, 0
    s_mul_hi_u32 s6, s5, 0x12492493
    s_mul_i32 s32, s6, 14
    s_sub_u32 s7, s5, s32
    s_mul_hi_u32 s34, s6, 0x15555556
    s_mul_i32 s32, s34, 12
    s_sub_u32 s35, s6, s32
    s_lshr_b32 s36, s35, 2
    s_and_b32 s37, s35, 3
    s_mul_i32 s33, s36, 448
    s_mul_i32 s32, s34, 56
    s_add_u32 s33, s33, s32
    s_lshl_b32 s32, s37, 4
    s_add_u32 s33, s33, s32
    s_mov_b32 s40, s10
    s_mov_b32 s41, s11
    s_and_b32 s41, s41, 0xffff
    s_mov_b32 s42, 0x126000
    s_mov_b32 s43, 0x00020000
    s_mul_i32 s44, s7, 43008
    s_add_u32 s44, s44, s33
    s_lshl_b32 s44, s44, 1
    s_movk_i32 s45, 10752
    v_mul_lo_u32 v6, v3, s45
    v_add_lshl_u32 v6, v6, v4, 1
    s_add_u32 s46, s44, 0
    buffer_load_ushort v40, v6, s[40:43], s46 offen
    s_add_u32 s46, s44, 2688
    buffer_load_ushort v41, v6, s[40:43], s46 offen
    s_add_u32 s46, s44, 5376
    buffer_load_ushort v42, v6, s[40:43], s46 offen
    s_add_u32 s46, s44, 8064
    buffer_load_ushort v43, v6, s[40:43], s46 offen
    s_add_u32 s46, s44, 10752
    buffer_load_ushort v44, v6, s[40:43], s46 offen
    s_add_u32 s46, s44, 13440
    buffer_load_ushort v45, v6, s[40:43], s46 offen
    s_add_u32 s46, s44, 16128
    buffer_load_ushort v46, v6, s[40:43], s46 offen
    s_add_u32 s46, s44, 18816
    buffer_load_ushort v47, v6, s[40:43], s46 offen
    s_lshl_b32 s63, s5, 10
    s_add_u32 s63, s63, 0x0
    s_branch L_prep_b3_done
L_prep_n_A_wqkv_3:
    s_cmp_ge_u32 s48, 1736
    s_cbranch_scc1 L_prep_n_A_wo_3
    s_sub_u32 s5, s48, 1344
    s_mul_hi_u32 s6, s5, 0x12492493
    s_mul_i32 s32, s6, 14
    s_sub_u32 s7, s5, s32
    s_lshl_b32 s33, s6, 4
    s_mov_b32 s40, s12
    s_mov_b32 s41, s13
    s_and_b32 s41, s41, 0xffff
    s_mov_b32 s42, 0x62000
    s_mov_b32 s43, 0x00020000
    s_mul_i32 s44, s7, 14336
    s_add_u32 s44, s44, s33
    s_lshl_b32 s44, s44, 1
    s_movk_i32 s45, 3584
    v_mul_lo_u32 v6, v3, s45
    v_add_lshl_u32 v6, v6, v4, 1
    s_add_u32 s46, s44, 0
    buffer_load_ushort v40, v6, s[40:43], s46 offen
    s_add_u32 s46, s44, 896
    buffer_load_ushort v41, v6, s[40:43], s46 offen
    s_add_u32 s46, s44, 1792
    buffer_load_ushort v42, v6, s[40:43], s46 offen
    s_add_u32 s46, s44, 2688
    buffer_load_ushort v43, v6, s[40:43], s46 offen
    s_add_u32 s46, s44, 3584
    buffer_load_ushort v44, v6, s[40:43], s46 offen
    s_add_u32 s46, s44, 4480
    buffer_load_ushort v45, v6, s[40:43], s46 offen
    s_add_u32 s46, s44, 5376
    buffer_load_ushort v46, v6, s[40:43], s46 offen
    s_add_u32 s46, s44, 6272
    buffer_load_ushort v47, v6, s[40:43], s46 offen
    s_lshl_b32 s63, s5, 10
    s_add_u32 s63, s63, 0x150000
    s_branch L_prep_b3_done
L_prep_n_A_wo_3:
    s_cmp_ge_u32 s48, 2128
    s_cbranch_scc1 L_prep_n_B_w1_3
    s_sub_u32 s5, s48, 1736
    s_mul_hi_u32 s6, s5, 0x12492493
    s_mul_i32 s32, s6, 14
    s_sub_u32 s7, s5, s32
    s_lshl_b32 s33, s6, 4
    s_mov_b32 s40, s16
    s_mov_b32 s41, s17
    s_and_b32 s41, s41, 0xffff
    s_mov_b32 s42, 0x62000
    s_mov_b32 s43, 0x00020000
    s_mul_i32 s44, s7, 14336
    s_add_u32 s44, s44, s33
    s_lshl_b32 s44, s44, 1
    s_movk_i32 s45, 3584
    v_mul_lo_u32 v6, v3, s45
    v_add_lshl_u32 v6, v6, v4, 1
    s_add_u32 s46, s44, 0
    buffer_load_ushort v40, v6, s[40:43], s46 offen
    s_add_u32 s46, s44, 896
    buffer_load_ushort v41, v6, s[40:43], s46 offen
    s_add_u32 s46, s44, 1792
    buffer_load_ushort v42, v6, s[40:43], s46 offen
    s_add_u32 s46, s44, 2688
    buffer_load_ushort v43, v6, s[40:43], s46 offen
    s_add_u32 s46, s44, 3584
    buffer_load_ushort v44, v6, s[40:43], s46 offen
    s_add_u32 s46, s44, 4480
    buffer_load_ushort v45, v6, s[40:43], s46 offen
    s_add_u32 s46, s44, 5376
    buffer_load_ushort v46, v6, s[40:43], s46 offen
    s_add_u32 s46, s44, 6272
    buffer_load_ushort v47, v6, s[40:43], s46 offen
    s_lshl_b32 s63, s5, 10
    s_add_u32 s63, s63, 0x1b2000
    s_branch L_prep_b3_done
L_prep_n_B_w1_3:
    s_cmp_ge_u32 s48, 2520
    s_cbranch_scc1 L_prep_n_B_w2_3
    s_sub_u32 s5, s48, 2128
    s_mul_hi_u32 s6, s5, 0x12492493
    s_mul_i32 s32, s6, 14
    s_sub_u32 s7, s5, s32
    s_lshl_b32 s33, s6, 4
    s_mov_b32 s40, s18
    s_mov_b32 s41, s19
    s_and_b32 s41, s41, 0xffff
    s_mov_b32 s42, 0x62000
    s_mov_b32 s43, 0x00020000
    s_mul_i32 s44, s7, 14336
    s_add_u32 s44, s44, s33
    s_lshl_b32 s44, s44, 1
    s_movk_i32 s45, 3584
    v_mul_lo_u32 v6, v3, s45
    v_add_lshl_u32 v6, v6, v4, 1
    s_add_u32 s46, s44, 0
    buffer_load_ushort v40, v6, s[40:43], s46 offen
    s_add_u32 s46, s44, 896
    buffer_load_ushort v41, v6, s[40:43], s46 offen
    s_add_u32 s46, s44, 1792
    buffer_load_ushort v42, v6, s[40:43], s46 offen
    s_add_u32 s46, s44, 2688
    buffer_load_ushort v43, v6, s[40:43], s46 offen
    s_add_u32 s46, s44, 3584
    buffer_load_ushort v44, v6, s[40:43], s46 offen
    s_add_u32 s46, s44, 4480
    buffer_load_ushort v45, v6, s[40:43], s46 offen
    s_add_u32 s46, s44, 5376
    buffer_load_ushort v46, v6, s[40:43], s46 offen
    s_add_u32 s46, s44, 6272
    buffer_load_ushort v47, v6, s[40:43], s46 offen
    s_lshl_b32 s63, s5, 10
    s_add_u32 s63, s63, 0x214000
    s_branch L_prep_b3_done
L_prep_n_B_w2_3:
    s_cmp_ge_u32 s48, 4088
    s_cbranch_scc1 L_prep_n_B_w3_3
    s_sub_u32 s5, s48, 2520
    s_mul_hi_u32 s6, s5, 0x12492493
    s_mul_i32 s32, s6, 14
    s_sub_u32 s7, s5, s32
    s_lshl_b32 s33, s6, 4
    s_mov_b32 s40, s20
    s_mov_b32 s41, s21
    s_and_b32 s41, s41, 0xffff
    s_mov_b32 s42, 0x188000
    s_mov_b32 s43, 0x00020000
    s_mul_i32 s44, s7, 57344
    s_add_u32 s44, s44, s33
    s_lshl_b32 s44, s44, 1
    s_movk_i32 s45, 14336
    v_mul_lo_u32 v6, v3, s45
    v_add_lshl_u32 v6, v6, v4, 1
    s_add_u32 s46, s44, 0
    buffer_load_ushort v40, v6, s[40:43], s46 offen
    s_add_u32 s46, s44, 3584
    buffer_load_ushort v41, v6, s[40:43], s46 offen
    s_add_u32 s46, s44, 7168
    buffer_load_ushort v42, v6, s[40:43], s46 offen
    s_add_u32 s46, s44, 10752
    buffer_load_ushort v43, v6, s[40:43], s46 offen
    s_add_u32 s46, s44, 14336
    buffer_load_ushort v44, v6, s[40:43], s46 offen
    s_add_u32 s46, s44, 17920
    buffer_load_ushort v45, v6, s[40:43], s46 offen
    s_add_u32 s46, s44, 21504
    buffer_load_ushort v46, v6, s[40:43], s46 offen
    s_add_u32 s46, s44, 25088
    buffer_load_ushort v47, v6, s[40:43], s46 offen
    s_lshl_b32 s63, s5, 10
    s_add_u32 s63, s63, 0x276000
    s_branch L_prep_b3_done
L_prep_n_B_w3_3:
    s_cmp_ge_u32 s48, 5656
    s_cbranch_scc1 L_prep_n_B_w4_3
    s_sub_u32 s5, s48, 4088
    s_mul_hi_u32 s6, s5, 0x4924925
    s_mul_i32 s32, s6, 56
    s_sub_u32 s7, s5, s32
    s_lshl_b32 s33, s6, 4
    s_mov_b32 s40, s22
    s_mov_b32 s41, s23
    s_and_b32 s41, s41, 0xffff
    s_mov_b32 s42, 0x188000
    s_mov_b32 s43, 0x00020000
    s_mul_i32 s44, s7, 14336
    s_add_u32 s44, s44, s33
    s_lshl_b32 s44, s44, 1
    s_movk_i32 s45, 3584
    v_mul_lo_u32 v6, v3, s45
    v_add_lshl_u32 v6, v6, v4, 1
    s_add_u32 s46, s44, 0
    buffer_load_ushort v40, v6, s[40:43], s46 offen
    s_add_u32 s46, s44, 896
    buffer_load_ushort v41, v6, s[40:43], s46 offen
    s_add_u32 s46, s44, 1792
    buffer_load_ushort v42, v6, s[40:43], s46 offen
    s_add_u32 s46, s44, 2688
    buffer_load_ushort v43, v6, s[40:43], s46 offen
    s_add_u32 s46, s44, 3584
    buffer_load_ushort v44, v6, s[40:43], s46 offen
    s_add_u32 s46, s44, 4480
    buffer_load_ushort v45, v6, s[40:43], s46 offen
    s_add_u32 s46, s44, 5376
    buffer_load_ushort v46, v6, s[40:43], s46 offen
    s_add_u32 s46, s44, 6272
    buffer_load_ushort v47, v6, s[40:43], s46 offen
    s_lshl_b32 s63, s5, 10
    s_add_u32 s63, s63, 0x3fe000
    s_branch L_prep_b3_done
L_prep_n_B_w4_3:
    s_mov_b32 s63, 0x10000000
L_prep_b3_done:
    s_nop 0
    s_waitcnt vmcnt(0)
    v_lshl_or_b32 v8, v17, 16, v16
    v_lshl_or_b32 v9, v19, 16, v18
    v_lshl_or_b32 v10, v21, 16, v20
    v_lshl_or_b32 v11, v23, 16, v22
    buffer_store_dwordx4 v[8:11], v5, s[28:31], s60 offen
    s_nop 1
    v_lshl_or_b32 v8, v25, 16, v24
    v_lshl_or_b32 v9, v27, 16, v26
    v_lshl_or_b32 v10, v29, 16, v28
    v_lshl_or_b32 v11, v31, 16, v30
    buffer_store_dwordx4 v[8:11], v5, s[28:31], s61 offen
    s_nop 1
    v_lshl_or_b32 v8, v33, 16, v32
    v_lshl_or_b32 v9, v35, 16, v34
    v_lshl_or_b32 v10, v37, 16, v36
    v_lshl_or_b32 v11, v39, 16, v38
    buffer_store_dwordx4 v[8:11], v5, s[28:31], s62 offen
    s_nop 1
    v_lshl_or_b32 v8, v41, 16, v40
    v_lshl_or_b32 v9, v43, 16, v42
    v_lshl_or_b32 v10, v45, 16, v44
    v_lshl_or_b32 v11, v47, 16, v46
    buffer_store_dwordx4 v[8:11], v5, s[28:31], s63 offen
    s_nop 1
L_prep_done:
    s_endpgm
.globl qkv0_kernel
.p2align 8
.type qkv0_kernel,@function
qkv0_kernel:
    s_cmp_ge_u32 s2, 256
    s_cbranch_scc1 L_qkv0_kernel_done
    s_load_dwordx4 s[32:35], s[0:1], 0
    s_load_dwordx4 s[36:39], s[0:1], 64
    s_load_dwordx2 s[40:41], s[0:1], 80
    v_lshrrev_b32 v4, 6, v0
    v_and_b32 v1, 63, v0
    v_readfirstlane_b32 s3, v4
    s_lshr_b32 s7, s2, 3
    s_mul_hi_u32 s4, s7, 0x20000000
    s_mul_i32 s42, s4, 8
    s_sub_u32 s5, s7, s42
    s_and_b32 s7, s2, 7
    s_mul_i32 s7, s7, 4
    s_add_u32 s4, s4, s7
    s_mul_i32 s6, s4, 64
    v_and_b32 v2, 15, v1
    v_lshrrev_b32 v3, 4, v1
    s_mov_b32 s28, 0x3f803f80
    s_mov_b32 s29, 0x3d372713
    s_mov_b32 s30, 0xc0135761
    s_waitcnt lgkmcnt(0)
    s_mov_b32 s8, s40
    s_mov_b32 s9, s41
    s_and_b32 s9, s9, 0xffff
    s_mov_b32 s10, 0x10000000
    s_mov_b32 s11, 0x00020000
    s_mov_b32 s12, s32
    s_mov_b32 s13, s33
    s_and_b32 s13, s13, 0xffff
    s_mov_b32 s14, 0x1c0000
    s_mov_b32 s15, 0x00020000
    s_add_u32 s16, s40, 0xb86000
    s_addc_u32 s17, s41, 0
    s_and_b32 s17, s17, 0xffff
    s_mov_b32 s18, 0x1c0000
    s_mov_b32 s19, 0x00020000
    v_lshrrev_b32 v184, 3, v1
    v_and_b32 v185, 7, v1
    s_mul_i32 s42, s3, 8
    v_add_u32 v184, s42, v184
    v_mul_u32_u24 v187, 928, v184
    v_lshl_add_u32 v187, v185, 4, v187
    v_add_u32 v187, 32000, v187
    v_add_u32 v186, s6, v184
    v_subrev_u32 v186, 16, v186
    s_movk_i32 s42, 896
    v_mul_lo_u32 v186, v186, s42
    v_lshl_add_u32 v186, v185, 4, v186
    buffer_load_dwordx4 v[128:131], v186, s[12:15], 0 offen offset:0
    buffer_load_dwordx4 v[132:135], v186, s[12:15], 0 offen offset:128
    buffer_load_dwordx4 v[136:139], v186, s[12:15], 0 offen offset:256
    buffer_load_dwordx4 v[140:143], v186, s[12:15], 0 offen offset:384
    buffer_load_dwordx4 v[144:147], v186, s[12:15], 0 offen offset:512
    buffer_load_dwordx4 v[148:151], v186, s[12:15], 0 offen offset:640
    buffer_load_dwordx4 v[152:155], v186, s[12:15], 0 offen offset:768
    v_add_u32 v188, 57344, v186
    buffer_load_dwordx4 v[156:159], v188, s[12:15], 0 offen offset:0
    buffer_load_dwordx4 v[160:163], v188, s[12:15], 0 offen offset:128
    buffer_load_dwordx4 v[164:167], v188, s[12:15], 0 offen offset:256
    buffer_load_dwordx4 v[168:171], v188, s[12:15], 0 offen offset:384
    buffer_load_dwordx4 v[172:175], v188, s[12:15], 0 offen offset:512
    buffer_load_dwordx4 v[176:179], v188, s[12:15], 0 offen offset:640
    buffer_load_dwordx4 v[180:183], v188, s[12:15], 0 offen offset:768
    v_lshlrev_b32 v6, 4, v1
    s_mov_b32 s43, 0
    s_cmp_eq_u32 s3, 0
    s_cselect_b32 s43, 4, s43
    s_cmp_eq_u32 s3, 1
    s_cselect_b32 s43, 6, s43
    s_cmp_eq_u32 s3, 2
    s_cselect_b32 s43, 8, s43
    s_cmp_eq_u32 s3, 3
    s_cselect_b32 s43, 10, s43
    s_cmp_eq_u32 s3, 5
    s_cselect_b32 s43, 1, s43
    s_cmp_eq_u32 s3, 6
    s_cselect_b32 s43, 2, s43
    s_cmp_eq_u32 s3, 7
    s_cselect_b32 s43, 3, s43
    s_mul_i32 s48, s5, 12
    s_add_u32 s48, s48, s43
    s_mul_i32 s48, s48, 14336
    s_add_u32 s48, s48, 0x0
    s_barrier
    buffer_load_dwordx4 v[16:19], v6, s[8:11], s48 offen offset:0
    s_add_u32 s49, s48, 0x3000
    buffer_load_dwordx4 v[72:75], v6, s[8:11], s49 offen offset:2048
    buffer_load_dwordx4 v[20:23], v6, s[8:11], s48 offen offset:1024
    s_add_u32 s49, s48, 0x3000
    buffer_load_dwordx4 v[76:79], v6, s[8:11], s49 offen offset:3072
    buffer_load_dwordx4 v[24:27], v6, s[8:11], s48 offen offset:2048
    s_add_u32 s49, s48, 0x4000
    buffer_load_dwordx4 v[80:83], v6, s[8:11], s49 offen offset:0
    buffer_load_dwordx4 v[28:31], v6, s[8:11], s48 offen offset:3072
    s_add_u32 s49, s48, 0x4000
    buffer_load_dwordx4 v[84:87], v6, s[8:11], s49 offen offset:1024
    s_add_u32 s49, s48, 0x1000
    buffer_load_dwordx4 v[32:35], v6, s[8:11], s49 offen offset:0
    s_add_u32 s49, s48, 0x4000
    buffer_load_dwordx4 v[88:91], v6, s[8:11], s49 offen offset:2048
    s_add_u32 s49, s48, 0x1000
    buffer_load_dwordx4 v[36:39], v6, s[8:11], s49 offen offset:1024
    s_add_u32 s49, s48, 0x4000
    buffer_load_dwordx4 v[92:95], v6, s[8:11], s49 offen offset:3072
    s_add_u32 s49, s48, 0x1000
    buffer_load_dwordx4 v[40:43], v6, s[8:11], s49 offen offset:2048
    s_add_u32 s49, s48, 0x5000
    buffer_load_dwordx4 v[96:99], v6, s[8:11], s49 offen offset:0
    s_add_u32 s49, s48, 0x1000
    buffer_load_dwordx4 v[44:47], v6, s[8:11], s49 offen offset:3072
    s_add_u32 s49, s48, 0x5000
    buffer_load_dwordx4 v[100:103], v6, s[8:11], s49 offen offset:1024
    s_add_u32 s49, s48, 0x2000
    buffer_load_dwordx4 v[48:51], v6, s[8:11], s49 offen offset:0
    s_add_u32 s49, s48, 0x5000
    buffer_load_dwordx4 v[104:107], v6, s[8:11], s49 offen offset:2048
    s_add_u32 s49, s48, 0x2000
    buffer_load_dwordx4 v[52:55], v6, s[8:11], s49 offen offset:1024
    s_add_u32 s49, s48, 0x5000
    buffer_load_dwordx4 v[108:111], v6, s[8:11], s49 offen offset:3072
    s_add_u32 s49, s48, 0x2000
    buffer_load_dwordx4 v[56:59], v6, s[8:11], s49 offen offset:2048
    s_add_u32 s49, s48, 0x6000
    buffer_load_dwordx4 v[112:115], v6, s[8:11], s49 offen offset:0
    s_add_u32 s49, s48, 0x2000
    buffer_load_dwordx4 v[60:63], v6, s[8:11], s49 offen offset:3072
    s_add_u32 s49, s48, 0x6000
    buffer_load_dwordx4 v[116:119], v6, s[8:11], s49 offen offset:1024
    s_add_u32 s49, s48, 0x3000
    buffer_load_dwordx4 v[64:67], v6, s[8:11], s49 offen offset:0
    s_add_u32 s49, s48, 0x6000
    buffer_load_dwordx4 v[120:123], v6, s[8:11], s49 offen offset:2048
    s_add_u32 s49, s48, 0x3000
    buffer_load_dwordx4 v[68:71], v6, s[8:11], s49 offen offset:1024
    s_add_u32 s49, s48, 0x6000
    buffer_load_dwordx4 v[124:127], v6, s[8:11], s49 offen offset:3072
    s_waitcnt vmcnt(35)
    v_mov_b32 v194, 0
    v_mov_b32 v195, 0
    v_mov_b32 v198, 0
    v_mov_b32 v199, 0
    v_dot2_f32_bf16 v194, v128, s28, v194
    v_dot2_f32_bf16 v195, v128, v128, v195
    v_dot2_f32_bf16 v198, v129, s28, v198
    v_dot2_f32_bf16 v199, v129, v129, v199
    v_dot2_f32_bf16 v194, v130, s28, v194
    v_dot2_f32_bf16 v195, v130, v130, v195
    v_dot2_f32_bf16 v198, v131, s28, v198
    v_dot2_f32_bf16 v199, v131, v131, v199
    v_dot2_f32_bf16 v194, v132, s28, v194
    v_dot2_f32_bf16 v195, v132, v132, v195
    v_dot2_f32_bf16 v198, v133, s28, v198
    v_dot2_f32_bf16 v199, v133, v133, v199
    v_dot2_f32_bf16 v194, v134, s28, v194
    v_dot2_f32_bf16 v195, v134, v134, v195
    v_dot2_f32_bf16 v198, v135, s28, v198
    v_dot2_f32_bf16 v199, v135, v135, v199
    v_dot2_f32_bf16 v194, v136, s28, v194
    v_dot2_f32_bf16 v195, v136, v136, v195
    v_dot2_f32_bf16 v198, v137, s28, v198
    v_dot2_f32_bf16 v199, v137, v137, v199
    v_dot2_f32_bf16 v194, v138, s28, v194
    v_dot2_f32_bf16 v195, v138, v138, v195
    v_dot2_f32_bf16 v198, v139, s28, v198
    v_dot2_f32_bf16 v199, v139, v139, v199
    v_dot2_f32_bf16 v194, v140, s28, v194
    v_dot2_f32_bf16 v195, v140, v140, v195
    v_dot2_f32_bf16 v198, v141, s28, v198
    v_dot2_f32_bf16 v199, v141, v141, v199
    v_dot2_f32_bf16 v194, v142, s28, v194
    v_dot2_f32_bf16 v195, v142, v142, v195
    v_dot2_f32_bf16 v198, v143, s28, v198
    v_dot2_f32_bf16 v199, v143, v143, v199
    v_dot2_f32_bf16 v194, v144, s28, v194
    v_dot2_f32_bf16 v195, v144, v144, v195
    v_dot2_f32_bf16 v198, v145, s28, v198
    v_dot2_f32_bf16 v199, v145, v145, v199
    v_dot2_f32_bf16 v194, v146, s28, v194
    v_dot2_f32_bf16 v195, v146, v146, v195
    v_dot2_f32_bf16 v198, v147, s28, v198
    v_dot2_f32_bf16 v199, v147, v147, v199
    v_dot2_f32_bf16 v194, v148, s28, v194
    v_dot2_f32_bf16 v195, v148, v148, v195
    v_dot2_f32_bf16 v198, v149, s28, v198
    v_dot2_f32_bf16 v199, v149, v149, v199
    v_dot2_f32_bf16 v194, v150, s28, v194
    v_dot2_f32_bf16 v195, v150, v150, v195
    v_dot2_f32_bf16 v198, v151, s28, v198
    v_dot2_f32_bf16 v199, v151, v151, v199
    v_dot2_f32_bf16 v194, v152, s28, v194
    v_dot2_f32_bf16 v195, v152, v152, v195
    v_dot2_f32_bf16 v198, v153, s28, v198
    v_dot2_f32_bf16 v199, v153, v153, v199
    v_dot2_f32_bf16 v194, v154, s28, v194
    v_dot2_f32_bf16 v195, v154, v154, v195
    v_dot2_f32_bf16 v198, v155, s28, v198
    v_dot2_f32_bf16 v199, v155, v155, v199
    s_nop 1
    v_add_f32 v194, v194, v198
    v_add_f32 v195, v195, v199
    s_nop 0
    v_add_f32_dpp v196, v194, v194 quad_perm:[1,0,3,2] row_mask:0xf bank_mask:0xf
    s_nop 1
    v_add_f32_dpp v194, v196, v196 quad_perm:[2,3,0,1] row_mask:0xf bank_mask:0xf
    s_nop 1
    v_add_f32_dpp v196, v194, v194 row_half_mirror row_mask:0xf bank_mask:0xf
    v_mov_b32 v194, v196
    v_add_f32_dpp v196, v195, v195 quad_perm:[1,0,3,2] row_mask:0xf bank_mask:0xf
    s_nop 1
    v_add_f32_dpp v195, v196, v196 quad_perm:[2,3,0,1] row_mask:0xf bank_mask:0xf
    s_nop 1
    v_add_f32_dpp v196, v195, v195 row_half_mirror row_mask:0xf bank_mask:0xf
    v_mov_b32 v195, v196
    v_mul_f32 v194, 0x3b124925, v194
    v_mul_f32 v195, 0x3b124925, v195
    v_fma_f32 v195, -v194, v194, v195
    v_max_f32 v195, 0, v195
    v_cvt_pk_bf16_f32 v196, v194, v194
    v_lshlrev_b32 v192, 16, v196
    v_cvt_pk_bf16_f32 v196, v195, v195
    v_lshlrev_b32 v197, 16, v196
    v_add_f32 v197, 0x3727c5ac, v197
    v_cvt_pk_bf16_f32 v196, v197, v197
    v_lshlrev_b32 v197, 16, v196
    v_sqrt_f32 v197, v197
    s_nop 0
    v_cvt_pk_bf16_f32 v196, v197, v197
    v_lshlrev_b32 v197, 16, v196
    v_rcp_f32 v193, v197
    s_nop 0
    v_fma_f32 v196, -v197, v193, 2.0
    v_mul_f32 v193, v193, v196
    v_mov_b32 v190, v193
    v_mul_f32 v191, v192, v193
    v_lshlrev_b32 v200, 3, v184
    ds_write_b64 v200, v[190:191] offset:0
    ds_write_b128 v187, v[128:131] offset:0
    ds_write_b128 v187, v[132:135] offset:128
    ds_write_b128 v187, v[136:139] offset:256
    ds_write_b128 v187, v[140:143] offset:384
    ds_write_b128 v187, v[144:147] offset:512
    ds_write_b128 v187, v[148:151] offset:640
    ds_write_b128 v187, v[152:155] offset:768
    s_cmp_ge_u32 s3, 2
    s_cbranch_scc1 L_qkv0_kernel_nohalo_1
    s_waitcnt vmcnt(28)
    v_mov_b32 v194, 0
    v_mov_b32 v195, 0
    v_mov_b32 v198, 0
    v_mov_b32 v199, 0
    v_dot2_f32_bf16 v194, v156, s28, v194
    v_dot2_f32_bf16 v195, v156, v156, v195
    v_dot2_f32_bf16 v198, v157, s28, v198
    v_dot2_f32_bf16 v199, v157, v157, v199
    v_dot2_f32_bf16 v194, v158, s28, v194
    v_dot2_f32_bf16 v195, v158, v158, v195
    v_dot2_f32_bf16 v198, v159, s28, v198
    v_dot2_f32_bf16 v199, v159, v159, v199
    v_dot2_f32_bf16 v194, v160, s28, v194
    v_dot2_f32_bf16 v195, v160, v160, v195
    v_dot2_f32_bf16 v198, v161, s28, v198
    v_dot2_f32_bf16 v199, v161, v161, v199
    v_dot2_f32_bf16 v194, v162, s28, v194
    v_dot2_f32_bf16 v195, v162, v162, v195
    v_dot2_f32_bf16 v198, v163, s28, v198
    v_dot2_f32_bf16 v199, v163, v163, v199
    v_dot2_f32_bf16 v194, v164, s28, v194
    v_dot2_f32_bf16 v195, v164, v164, v195
    v_dot2_f32_bf16 v198, v165, s28, v198
    v_dot2_f32_bf16 v199, v165, v165, v199
    v_dot2_f32_bf16 v194, v166, s28, v194
    v_dot2_f32_bf16 v195, v166, v166, v195
    v_dot2_f32_bf16 v198, v167, s28, v198
    v_dot2_f32_bf16 v199, v167, v167, v199
    v_dot2_f32_bf16 v194, v168, s28, v194
    v_dot2_f32_bf16 v195, v168, v168, v195
    v_dot2_f32_bf16 v198, v169, s28, v198
    v_dot2_f32_bf16 v199, v169, v169, v199
    v_dot2_f32_bf16 v194, v170, s28, v194
    v_dot2_f32_bf16 v195, v170, v170, v195
    v_dot2_f32_bf16 v198, v171, s28, v198
    v_dot2_f32_bf16 v199, v171, v171, v199
    v_dot2_f32_bf16 v194, v172, s28, v194
    v_dot2_f32_bf16 v195, v172, v172, v195
    v_dot2_f32_bf16 v198, v173, s28, v198
    v_dot2_f32_bf16 v199, v173, v173, v199
    v_dot2_f32_bf16 v194, v174, s28, v194
    v_dot2_f32_bf16 v195, v174, v174, v195
    v_dot2_f32_bf16 v198, v175, s28, v198
    v_dot2_f32_bf16 v199, v175, v175, v199
    v_dot2_f32_bf16 v194, v176, s28, v194
    v_dot2_f32_bf16 v195, v176, v176, v195
    v_dot2_f32_bf16 v198, v177, s28, v198
    v_dot2_f32_bf16 v199, v177, v177, v199
    v_dot2_f32_bf16 v194, v178, s28, v194
    v_dot2_f32_bf16 v195, v178, v178, v195
    v_dot2_f32_bf16 v198, v179, s28, v198
    v_dot2_f32_bf16 v199, v179, v179, v199
    v_dot2_f32_bf16 v194, v180, s28, v194
    v_dot2_f32_bf16 v195, v180, v180, v195
    v_dot2_f32_bf16 v198, v181, s28, v198
    v_dot2_f32_bf16 v199, v181, v181, v199
    v_dot2_f32_bf16 v194, v182, s28, v194
    v_dot2_f32_bf16 v195, v182, v182, v195
    v_dot2_f32_bf16 v198, v183, s28, v198
    v_dot2_f32_bf16 v199, v183, v183, v199
    s_nop 1
    v_add_f32 v194, v194, v198
    v_add_f32 v195, v195, v199
    s_nop 0
    v_add_f32_dpp v196, v194, v194 quad_perm:[1,0,3,2] row_mask:0xf bank_mask:0xf
    s_nop 1
    v_add_f32_dpp v194, v196, v196 quad_perm:[2,3,0,1] row_mask:0xf bank_mask:0xf
    s_nop 1
    v_add_f32_dpp v196, v194, v194 row_half_mirror row_mask:0xf bank_mask:0xf
    v_mov_b32 v194, v196
    v_add_f32_dpp v196, v195, v195 quad_perm:[1,0,3,2] row_mask:0xf bank_mask:0xf
    s_nop 1
    v_add_f32_dpp v195, v196, v196 quad_perm:[2,3,0,1] row_mask:0xf bank_mask:0xf
    s_nop 1
    v_add_f32_dpp v196, v195, v195 row_half_mirror row_mask:0xf bank_mask:0xf
    v_mov_b32 v195, v196
    v_mul_f32 v194, 0x3b124925, v194
    v_mul_f32 v195, 0x3b124925, v195
    v_fma_f32 v195, -v194, v194, v195
    v_max_f32 v195, 0, v195
    v_cvt_pk_bf16_f32 v196, v194, v194
    v_lshlrev_b32 v192, 16, v196
    v_cvt_pk_bf16_f32 v196, v195, v195
    v_lshlrev_b32 v197, 16, v196
    v_add_f32 v197, 0x3727c5ac, v197
    v_cvt_pk_bf16_f32 v196, v197, v197
    v_lshlrev_b32 v197, 16, v196
    v_sqrt_f32 v197, v197
    s_nop 0
    v_cvt_pk_bf16_f32 v196, v197, v197
    v_lshlrev_b32 v197, 16, v196
    v_rcp_f32 v193, v197
    s_nop 0
    v_fma_f32 v196, -v197, v193, 2.0
    v_mul_f32 v193, v193, v196
    v_mov_b32 v190, v193
    v_mul_f32 v191, v192, v193
    ds_write_b64 v200, v[190:191] offset:512
    ds_write_b128 v187, v[156:159] offset:59392
    ds_write_b128 v187, v[160:163] offset:59520
    ds_write_b128 v187, v[164:167] offset:59648
    ds_write_b128 v187, v[168:171] offset:59776
    ds_write_b128 v187, v[172:175] offset:59904
    ds_write_b128 v187, v[176:179] offset:60032
    ds_write_b128 v187, v[180:183] offset:60160
L_qkv0_kernel_nohalo_1:
    s_nop 1
    s_waitcnt lgkmcnt(0)
    s_barrier
    v_mul_u32_u24 v7, 928, v2
    v_lshl_add_u32 v7, v3, 4, v7
    v_add_u32 v7, 32000, v7
    s_movk_i32 s42, 896
    v_mul_lo_u32 v8, v2, s42
    v_lshl_add_u32 v8, v3, 3, v8
    v_mov_b32 v12, s28
    v_mov_b32 v13, s28
    v_mov_b32 v14, s28
    v_mov_b32 v15, s28
    v_lshlrev_b32 v9, 3, v2
    s_cmp_eq_u32 s3, 0
    s_cbranch_scc1 L_qkv0_kernel_var_2
    s_cmp_eq_u32 s3, 1
    s_cbranch_scc1 L_qkv0_kernel_var_2
    s_cmp_eq_u32 s3, 2
    s_cbranch_scc1 L_qkv0_kernel_var_2
    s_cmp_eq_u32 s3, 3
    s_cbranch_scc1 L_qkv0_kernel_var_2
    s_cmp_eq_u32 s3, 4
    s_cbranch_scc1 L_qkv0_kernel_var_3
    s_cmp_eq_u32 s3, 5
    s_cbranch_scc1 L_qkv0_kernel_var_3
    s_cmp_eq_u32 s3, 6
    s_cbranch_scc1 L_qkv0_kernel_var_3
    s_cmp_eq_u32 s3, 7
    s_cbranch_scc1 L_qkv0_kernel_var_3
    s_branch L_qkv0_kernel_end
L_qkv0_kernel_var_2:
    s_nop 4
    v_mov_b32 v128, 0
    v_mov_b32 v129, 0
    v_mov_b32 v130, 0
    v_mov_b32 v131, 0
    v_mov_b32 v132, 0
    v_mov_b32 v133, 0
    v_mov_b32 v134, 0
    v_mov_b32 v135, 0
    v_mov_b32 v136, 0
    v_mov_b32 v137, 0
    v_mov_b32 v138, 0
    v_mov_b32 v139, 0
    v_mov_b32 v140, 0
    v_mov_b32 v141, 0
    v_mov_b32 v142, 0
    v_mov_b32 v143, 0
    v_mov_b32 v144, 0
    v_mov_b32 v145, 0
    v_mov_b32 v146, 0
    v_mov_b32 v147, 0
    v_mov_b32 v148, 0
    v_mov_b32 v149, 0
    v_mov_b32 v150, 0
    v_mov_b32 v151, 0
    v_mov_b32 v152, 0
    v_mov_b32 v153, 0
    v_mov_b32 v154, 0
    v_mov_b32 v155, 0
    v_mov_b32 v156, 0
    v_mov_b32 v157, 0
    v_mov_b32 v158, 0
    v_mov_b32 v159, 0
    v_mov_b32 v160, 0
    v_mov_b32 v161, 0
    v_mov_b32 v162, 0
    v_mov_b32 v163, 0
    v_mov_b32 v164, 0
    v_mov_b32 v165, 0
    v_mov_b32 v166, 0
    v_mov_b32 v167, 0
    v_mov_b32 v208, 0
    v_mov_b32 v209, 0
    v_mov_b32 v210, 0
    v_mov_b32 v211, 0
    v_mov_b32 v212, 0
    v_mov_b32 v213, 0
    v_mov_b32 v214, 0
    v_mov_b32 v215, 0
    s_mul_i32 s50, s6, 896
    s_mul_i32 s51, s5, 384
    s_add_u32 s50, s50, s51
    s_lshl_b32 s51, s43, 5
    s_add_u32 s50, s50, s51
    ds_read_b128 v[168:171], v7 offset:0
    ds_read_b128 v[172:175], v7 offset:14848
    ds_read_b128 v[176:179], v7 offset:29696
    ds_read_b128 v[180:183], v7 offset:44544
    ds_read_b128 v[184:187], v7 offset:59392
    ds_read_b128 v[188:191], v7 offset:64
    ds_read_b128 v[192:195], v7 offset:14912
    ds_read_b128 v[196:199], v7 offset:29760
    ds_read_b128 v[200:203], v7 offset:44608
    ds_read_b128 v[204:207], v7 offset:59456
    s_waitcnt lgkmcnt(5)
    s_waitcnt vmcnt(27)
    s_waitcnt vmcnt(26)
    v_mfma_f32_16x16x32_bf16 v[128:131], v[16:19], v[168:171], v[128:131]
    v_mfma_f32_16x16x32_bf16 v[136:139], v[16:19], v[172:175], v[136:139]
    v_mfma_f32_16x16x32_bf16 v[144:147], v[16:19], v[176:179], v[144:147]
    v_mfma_f32_16x16x32_bf16 v[152:155], v[16:19], v[180:183], v[152:155]
    v_mfma_f32_16x16x32_bf16 v[160:163], v[16:19], v[184:187], v[160:163]
    v_mfma_f32_16x16x32_bf16 v[208:211], v[16:19], v[12:15], v[208:211]
    v_mfma_f32_16x16x32_bf16 v[132:135], v[72:75], v[168:171], v[132:135]
    v_mfma_f32_16x16x32_bf16 v[140:143], v[72:75], v[172:175], v[140:143]
    v_mfma_f32_16x16x32_bf16 v[148:151], v[72:75], v[176:179], v[148:151]
    v_mfma_f32_16x16x32_bf16 v[156:159], v[72:75], v[180:183], v[156:159]
    v_mfma_f32_16x16x32_bf16 v[164:167], v[72:75], v[184:187], v[164:167]
    v_mfma_f32_16x16x32_bf16 v[212:215], v[72:75], v[12:15], v[212:215]
    ds_read_b128 v[168:171], v7 offset:128
    ds_read_b128 v[172:175], v7 offset:14976
    ds_read_b128 v[176:179], v7 offset:29824
    ds_read_b128 v[180:183], v7 offset:44672
    ds_read_b128 v[184:187], v7 offset:59520
    s_waitcnt lgkmcnt(5)
    s_waitcnt vmcnt(25)
    s_waitcnt vmcnt(24)
    v_mfma_f32_16x16x32_bf16 v[128:131], v[20:23], v[188:191], v[128:131]
    v_mfma_f32_16x16x32_bf16 v[136:139], v[20:23], v[192:195], v[136:139]
    v_mfma_f32_16x16x32_bf16 v[144:147], v[20:23], v[196:199], v[144:147]
    v_mfma_f32_16x16x32_bf16 v[152:155], v[20:23], v[200:203], v[152:155]
    v_mfma_f32_16x16x32_bf16 v[160:163], v[20:23], v[204:207], v[160:163]
    v_mfma_f32_16x16x32_bf16 v[208:211], v[20:23], v[12:15], v[208:211]
    v_mfma_f32_16x16x32_bf16 v[132:135], v[76:79], v[188:191], v[132:135]
    v_mfma_f32_16x16x32_bf16 v[140:143], v[76:79], v[192:195], v[140:143]
    v_mfma_f32_16x16x32_bf16 v[148:151], v[76:79], v[196:199], v[148:151]
    v_mfma_f32_16x16x32_bf16 v[156:159], v[76:79], v[200:203], v[156:159]
    v_mfma_f32_16x16x32_bf16 v[164:167], v[76:79], v[204:207], v[164:167]
    v_mfma_f32_16x16x32_bf16 v[212:215], v[76:79], v[12:15], v[212:215]
    ds_read_b128 v[188:191], v7 offset:192
    ds_read_b128 v[192:195], v7 offset:15040
    ds_read_b128 v[196:199], v7 offset:29888
    ds_read_b128 v[200:203], v7 offset:44736
    ds_read_b128 v[204:207], v7 offset:59584
    s_waitcnt lgkmcnt(5)
    s_waitcnt vmcnt(23)
    s_waitcnt vmcnt(22)
    v_mfma_f32_16x16x32_bf16 v[128:131], v[24:27], v[168:171], v[128:131]
    v_mfma_f32_16x16x32_bf16 v[136:139], v[24:27], v[172:175], v[136:139]
    v_mfma_f32_16x16x32_bf16 v[144:147], v[24:27], v[176:179], v[144:147]
    v_mfma_f32_16x16x32_bf16 v[152:155], v[24:27], v[180:183], v[152:155]
    v_mfma_f32_16x16x32_bf16 v[160:163], v[24:27], v[184:187], v[160:163]
    v_mfma_f32_16x16x32_bf16 v[208:211], v[24:27], v[12:15], v[208:211]
    v_mfma_f32_16x16x32_bf16 v[132:135], v[80:83], v[168:171], v[132:135]
    v_mfma_f32_16x16x32_bf16 v[140:143], v[80:83], v[172:175], v[140:143]
    v_mfma_f32_16x16x32_bf16 v[148:151], v[80:83], v[176:179], v[148:151]
    v_mfma_f32_16x16x32_bf16 v[156:159], v[80:83], v[180:183], v[156:159]
    v_mfma_f32_16x16x32_bf16 v[164:167], v[80:83], v[184:187], v[164:167]
    v_mfma_f32_16x16x32_bf16 v[212:215], v[80:83], v[12:15], v[212:215]
    ds_read_b128 v[168:171], v7 offset:256
    ds_read_b128 v[172:175], v7 offset:15104
    ds_read_b128 v[176:179], v7 offset:29952
    ds_read_b128 v[180:183], v7 offset:44800
    ds_read_b128 v[184:187], v7 offset:59648
    s_waitcnt lgkmcnt(5)
    s_waitcnt vmcnt(21)
    s_waitcnt vmcnt(20)
    v_mfma_f32_16x16x32_bf16 v[128:131], v[28:31], v[188:191], v[128:131]
    v_mfma_f32_16x16x32_bf16 v[136:139], v[28:31], v[192:195], v[136:139]
    v_mfma_f32_16x16x32_bf16 v[144:147], v[28:31], v[196:199], v[144:147]
    v_mfma_f32_16x16x32_bf16 v[152:155], v[28:31], v[200:203], v[152:155]
    v_mfma_f32_16x16x32_bf16 v[160:163], v[28:31], v[204:207], v[160:163]
    v_mfma_f32_16x16x32_bf16 v[208:211], v[28:31], v[12:15], v[208:211]
    v_mfma_f32_16x16x32_bf16 v[132:135], v[84:87], v[188:191], v[132:135]
    v_mfma_f32_16x16x32_bf16 v[140:143], v[84:87], v[192:195], v[140:143]
    v_mfma_f32_16x16x32_bf16 v[148:151], v[84:87], v[196:199], v[148:151]
    v_mfma_f32_16x16x32_bf16 v[156:159], v[84:87], v[200:203], v[156:159]
    v_mfma_f32_16x16x32_bf16 v[164:167], v[84:87], v[204:207], v[164:167]
    v_mfma_f32_16x16x32_bf16 v[212:215], v[84:87], v[12:15], v[212:215]
    ds_read_b128 v[188:191], v7 offset:320
    ds_read_b128 v[192:195], v7 offset:15168
    ds_read_b128 v[196:199], v7 offset:30016
    ds_read_b128 v[200:203], v7 offset:44864
    ds_read_b128 v[204:207], v7 offset:59712
    s_waitcnt lgkmcnt(5)
    s_waitcnt vmcnt(19)
    s_waitcnt vmcnt(18)
    v_mfma_f32_16x16x32_bf16 v[128:131], v[32:35], v[168:171], v[128:131]
    v_mfma_f32_16x16x32_bf16 v[136:139], v[32:35], v[172:175], v[136:139]
    v_mfma_f32_16x16x32_bf16 v[144:147], v[32:35], v[176:179], v[144:147]
    v_mfma_f32_16x16x32_bf16 v[152:155], v[32:35], v[180:183], v[152:155]
    v_mfma_f32_16x16x32_bf16 v[160:163], v[32:35], v[184:187], v[160:163]
    v_mfma_f32_16x16x32_bf16 v[208:211], v[32:35], v[12:15], v[208:211]
    v_mfma_f32_16x16x32_bf16 v[132:135], v[88:91], v[168:171], v[132:135]
    v_mfma_f32_16x16x32_bf16 v[140:143], v[88:91], v[172:175], v[140:143]
    v_mfma_f32_16x16x32_bf16 v[148:151], v[88:91], v[176:179], v[148:151]
    v_mfma_f32_16x16x32_bf16 v[156:159], v[88:91], v[180:183], v[156:159]
    v_mfma_f32_16x16x32_bf16 v[164:167], v[88:91], v[184:187], v[164:167]
    v_mfma_f32_16x16x32_bf16 v[212:215], v[88:91], v[12:15], v[212:215]
    ds_read_b128 v[168:171], v7 offset:384
    ds_read_b128 v[172:175], v7 offset:15232
    ds_read_b128 v[176:179], v7 offset:30080
    ds_read_b128 v[180:183], v7 offset:44928
    ds_read_b128 v[184:187], v7 offset:59776
    s_waitcnt lgkmcnt(5)
    s_waitcnt vmcnt(17)
    s_waitcnt vmcnt(16)
    v_mfma_f32_16x16x32_bf16 v[128:131], v[36:39], v[188:191], v[128:131]
    v_mfma_f32_16x16x32_bf16 v[136:139], v[36:39], v[192:195], v[136:139]
    v_mfma_f32_16x16x32_bf16 v[144:147], v[36:39], v[196:199], v[144:147]
    v_mfma_f32_16x16x32_bf16 v[152:155], v[36:39], v[200:203], v[152:155]
    v_mfma_f32_16x16x32_bf16 v[160:163], v[36:39], v[204:207], v[160:163]
    v_mfma_f32_16x16x32_bf16 v[208:211], v[36:39], v[12:15], v[208:211]
    v_mfma_f32_16x16x32_bf16 v[132:135], v[92:95], v[188:191], v[132:135]
    v_mfma_f32_16x16x32_bf16 v[140:143], v[92:95], v[192:195], v[140:143]
    v_mfma_f32_16x16x32_bf16 v[148:151], v[92:95], v[196:199], v[148:151]
    v_mfma_f32_16x16x32_bf16 v[156:159], v[92:95], v[200:203], v[156:159]
    v_mfma_f32_16x16x32_bf16 v[164:167], v[92:95], v[204:207], v[164:167]
    v_mfma_f32_16x16x32_bf16 v[212:215], v[92:95], v[12:15], v[212:215]
    ds_read_b128 v[188:191], v7 offset:448
    ds_read_b128 v[192:195], v7 offset:15296
    ds_read_b128 v[196:199], v7 offset:30144
    ds_read_b128 v[200:203], v7 offset:44992
    ds_read_b128 v[204:207], v7 offset:59840
    s_waitcnt lgkmcnt(5)
    s_waitcnt vmcnt(15)
    s_waitcnt vmcnt(14)
    v_mfma_f32_16x16x32_bf16 v[128:131], v[40:43], v[168:171], v[128:131]
    v_mfma_f32_16x16x32_bf16 v[136:139], v[40:43], v[172:175], v[136:139]
    v_mfma_f32_16x16x32_bf16 v[144:147], v[40:43], v[176:179], v[144:147]
    v_mfma_f32_16x16x32_bf16 v[152:155], v[40:43], v[180:183], v[152:155]
    v_mfma_f32_16x16x32_bf16 v[160:163], v[40:43], v[184:187], v[160:163]
    v_mfma_f32_16x16x32_bf16 v[208:211], v[40:43], v[12:15], v[208:211]
    v_mfma_f32_16x16x32_bf16 v[132:135], v[96:99], v[168:171], v[132:135]
    v_mfma_f32_16x16x32_bf16 v[140:143], v[96:99], v[172:175], v[140:143]
    v_mfma_f32_16x16x32_bf16 v[148:151], v[96:99], v[176:179], v[148:151]
    v_mfma_f32_16x16x32_bf16 v[156:159], v[96:99], v[180:183], v[156:159]
    v_mfma_f32_16x16x32_bf16 v[164:167], v[96:99], v[184:187], v[164:167]
    v_mfma_f32_16x16x32_bf16 v[212:215], v[96:99], v[12:15], v[212:215]
    ds_read_b128 v[168:171], v7 offset:512
    ds_read_b128 v[172:175], v7 offset:15360
    ds_read_b128 v[176:179], v7 offset:30208
    ds_read_b128 v[180:183], v7 offset:45056
    ds_read_b128 v[184:187], v7 offset:59904
    s_waitcnt lgkmcnt(5)
    s_waitcnt vmcnt(13)
    s_waitcnt vmcnt(12)
    v_mfma_f32_16x16x32_bf16 v[128:131], v[44:47], v[188:191], v[128:131]
    v_mfma_f32_16x16x32_bf16 v[136:139], v[44:47], v[192:195], v[136:139]
    v_mfma_f32_16x16x32_bf16 v[144:147], v[44:47], v[196:199], v[144:147]
    v_mfma_f32_16x16x32_bf16 v[152:155], v[44:47], v[200:203], v[152:155]
    v_mfma_f32_16x16x32_bf16 v[160:163], v[44:47], v[204:207], v[160:163]
    v_mfma_f32_16x16x32_bf16 v[208:211], v[44:47], v[12:15], v[208:211]
    v_mfma_f32_16x16x32_bf16 v[132:135], v[100:103], v[188:191], v[132:135]
    v_mfma_f32_16x16x32_bf16 v[140:143], v[100:103], v[192:195], v[140:143]
    v_mfma_f32_16x16x32_bf16 v[148:151], v[100:103], v[196:199], v[148:151]
    v_mfma_f32_16x16x32_bf16 v[156:159], v[100:103], v[200:203], v[156:159]
    v_mfma_f32_16x16x32_bf16 v[164:167], v[100:103], v[204:207], v[164:167]
    v_mfma_f32_16x16x32_bf16 v[212:215], v[100:103], v[12:15], v[212:215]
    ds_read_b128 v[188:191], v7 offset:576
    ds_read_b128 v[192:195], v7 offset:15424
    ds_read_b128 v[196:199], v7 offset:30272
    ds_read_b128 v[200:203], v7 offset:45120
    ds_read_b128 v[204:207], v7 offset:59968
    s_waitcnt lgkmcnt(5)
    s_waitcnt vmcnt(11)
    s_waitcnt vmcnt(10)
    v_mfma_f32_16x16x32_bf16 v[128:131], v[48:51], v[168:171], v[128:131]
    v_mfma_f32_16x16x32_bf16 v[136:139], v[48:51], v[172:175], v[136:139]
    v_mfma_f32_16x16x32_bf16 v[144:147], v[48:51], v[176:179], v[144:147]
    v_mfma_f32_16x16x32_bf16 v[152:155], v[48:51], v[180:183], v[152:155]
    v_mfma_f32_16x16x32_bf16 v[160:163], v[48:51], v[184:187], v[160:163]
    v_mfma_f32_16x16x32_bf16 v[208:211], v[48:51], v[12:15], v[208:211]
    v_mfma_f32_16x16x32_bf16 v[132:135], v[104:107], v[168:171], v[132:135]
    v_mfma_f32_16x16x32_bf16 v[140:143], v[104:107], v[172:175], v[140:143]
    v_mfma_f32_16x16x32_bf16 v[148:151], v[104:107], v[176:179], v[148:151]
    v_mfma_f32_16x16x32_bf16 v[156:159], v[104:107], v[180:183], v[156:159]
    v_mfma_f32_16x16x32_bf16 v[164:167], v[104:107], v[184:187], v[164:167]
    v_mfma_f32_16x16x32_bf16 v[212:215], v[104:107], v[12:15], v[212:215]
    ds_read_b128 v[168:171], v7 offset:640
    ds_read_b128 v[172:175], v7 offset:15488
    ds_read_b128 v[176:179], v7 offset:30336
    ds_read_b128 v[180:183], v7 offset:45184
    ds_read_b128 v[184:187], v7 offset:60032
    s_waitcnt lgkmcnt(5)
    s_waitcnt vmcnt(9)
    s_waitcnt vmcnt(8)
    v_mfma_f32_16x16x32_bf16 v[128:131], v[52:55], v[188:191], v[128:131]
    v_mfma_f32_16x16x32_bf16 v[136:139], v[52:55], v[192:195], v[136:139]
    v_mfma_f32_16x16x32_bf16 v[144:147], v[52:55], v[196:199], v[144:147]
    v_mfma_f32_16x16x32_bf16 v[152:155], v[52:55], v[200:203], v[152:155]
    v_mfma_f32_16x16x32_bf16 v[160:163], v[52:55], v[204:207], v[160:163]
    v_mfma_f32_16x16x32_bf16 v[208:211], v[52:55], v[12:15], v[208:211]
    v_mfma_f32_16x16x32_bf16 v[132:135], v[108:111], v[188:191], v[132:135]
    v_mfma_f32_16x16x32_bf16 v[140:143], v[108:111], v[192:195], v[140:143]
    v_mfma_f32_16x16x32_bf16 v[148:151], v[108:111], v[196:199], v[148:151]
    v_mfma_f32_16x16x32_bf16 v[156:159], v[108:111], v[200:203], v[156:159]
    v_mfma_f32_16x16x32_bf16 v[164:167], v[108:111], v[204:207], v[164:167]
    v_mfma_f32_16x16x32_bf16 v[212:215], v[108:111], v[12:15], v[212:215]
    ds_read_b128 v[188:191], v7 offset:704
    ds_read_b128 v[192:195], v7 offset:15552
    ds_read_b128 v[196:199], v7 offset:30400
    ds_read_b128 v[200:203], v7 offset:45248
    ds_read_b128 v[204:207], v7 offset:60096
    s_waitcnt lgkmcnt(5)
    s_waitcnt vmcnt(7)
    s_waitcnt vmcnt(6)
    v_mfma_f32_16x16x32_bf16 v[128:131], v[56:59], v[168:171], v[128:131]
    v_mfma_f32_16x16x32_bf16 v[136:139], v[56:59], v[172:175], v[136:139]
    v_mfma_f32_16x16x32_bf16 v[144:147], v[56:59], v[176:179], v[144:147]
    v_mfma_f32_16x16x32_bf16 v[152:155], v[56:59], v[180:183], v[152:155]
    v_mfma_f32_16x16x32_bf16 v[160:163], v[56:59], v[184:187], v[160:163]
    v_mfma_f32_16x16x32_bf16 v[208:211], v[56:59], v[12:15], v[208:211]
    v_mfma_f32_16x16x32_bf16 v[132:135], v[112:115], v[168:171], v[132:135]
    v_mfma_f32_16x16x32_bf16 v[140:143], v[112:115], v[172:175], v[140:143]
    v_mfma_f32_16x16x32_bf16 v[148:151], v[112:115], v[176:179], v[148:151]
    v_mfma_f32_16x16x32_bf16 v[156:159], v[112:115], v[180:183], v[156:159]
    v_mfma_f32_16x16x32_bf16 v[164:167], v[112:115], v[184:187], v[164:167]
    v_mfma_f32_16x16x32_bf16 v[212:215], v[112:115], v[12:15], v[212:215]
    ds_read_b128 v[168:171], v7 offset:768
    ds_read_b128 v[172:175], v7 offset:15616
    ds_read_b128 v[176:179], v7 offset:30464
    ds_read_b128 v[180:183], v7 offset:45312
    ds_read_b128 v[184:187], v7 offset:60160
    s_waitcnt lgkmcnt(5)
    s_waitcnt vmcnt(5)
    s_waitcnt vmcnt(4)
    v_mfma_f32_16x16x32_bf16 v[128:131], v[60:63], v[188:191], v[128:131]
    v_mfma_f32_16x16x32_bf16 v[136:139], v[60:63], v[192:195], v[136:139]
    v_mfma_f32_16x16x32_bf16 v[144:147], v[60:63], v[196:199], v[144:147]
    v_mfma_f32_16x16x32_bf16 v[152:155], v[60:63], v[200:203], v[152:155]
    v_mfma_f32_16x16x32_bf16 v[160:163], v[60:63], v[204:207], v[160:163]
    v_mfma_f32_16x16x32_bf16 v[208:211], v[60:63], v[12:15], v[208:211]
    v_mfma_f32_16x16x32_bf16 v[132:135], v[116:119], v[188:191], v[132:135]
    v_mfma_f32_16x16x32_bf16 v[140:143], v[116:119], v[192:195], v[140:143]
    v_mfma_f32_16x16x32_bf16 v[148:151], v[116:119], v[196:199], v[148:151]
    v_mfma_f32_16x16x32_bf16 v[156:159], v[116:119], v[200:203], v[156:159]
    v_mfma_f32_16x16x32_bf16 v[164:167], v[116:119], v[204:207], v[164:167]
    v_mfma_f32_16x16x32_bf16 v[212:215], v[116:119], v[12:15], v[212:215]
    ds_read_b128 v[188:191], v7 offset:832
    ds_read_b128 v[192:195], v7 offset:15680
    ds_read_b128 v[196:199], v7 offset:30528
    ds_read_b128 v[200:203], v7 offset:45376
    ds_read_b128 v[204:207], v7 offset:60224
    s_waitcnt lgkmcnt(5)
    s_waitcnt vmcnt(3)
    s_waitcnt vmcnt(2)
    v_mfma_f32_16x16x32_bf16 v[128:131], v[64:67], v[168:171], v[128:131]
    v_mfma_f32_16x16x32_bf16 v[136:139], v[64:67], v[172:175], v[136:139]
    v_mfma_f32_16x16x32_bf16 v[144:147], v[64:67], v[176:179], v[144:147]
    v_mfma_f32_16x16x32_bf16 v[152:155], v[64:67], v[180:183], v[152:155]
    v_mfma_f32_16x16x32_bf16 v[160:163], v[64:67], v[184:187], v[160:163]
    v_mfma_f32_16x16x32_bf16 v[208:211], v[64:67], v[12:15], v[208:211]
    v_mfma_f32_16x16x32_bf16 v[132:135], v[120:123], v[168:171], v[132:135]
    v_mfma_f32_16x16x32_bf16 v[140:143], v[120:123], v[172:175], v[140:143]
    v_mfma_f32_16x16x32_bf16 v[148:151], v[120:123], v[176:179], v[148:151]
    v_mfma_f32_16x16x32_bf16 v[156:159], v[120:123], v[180:183], v[156:159]
    v_mfma_f32_16x16x32_bf16 v[164:167], v[120:123], v[184:187], v[164:167]
    v_mfma_f32_16x16x32_bf16 v[212:215], v[120:123], v[12:15], v[212:215]
    s_waitcnt lgkmcnt(0)
    s_waitcnt vmcnt(1)
    s_waitcnt vmcnt(0)
    v_mfma_f32_16x16x32_bf16 v[128:131], v[68:71], v[188:191], v[128:131]
    v_mfma_f32_16x16x32_bf16 v[136:139], v[68:71], v[192:195], v[136:139]
    v_mfma_f32_16x16x32_bf16 v[144:147], v[68:71], v[196:199], v[144:147]
    v_mfma_f32_16x16x32_bf16 v[152:155], v[68:71], v[200:203], v[152:155]
    v_mfma_f32_16x16x32_bf16 v[160:163], v[68:71], v[204:207], v[160:163]
    v_mfma_f32_16x16x32_bf16 v[208:211], v[68:71], v[12:15], v[208:211]
    v_mfma_f32_16x16x32_bf16 v[132:135], v[124:127], v[188:191], v[132:135]
    v_mfma_f32_16x16x32_bf16 v[140:143], v[124:127], v[192:195], v[140:143]
    v_mfma_f32_16x16x32_bf16 v[148:151], v[124:127], v[196:199], v[148:151]
    v_mfma_f32_16x16x32_bf16 v[156:159], v[124:127], v[200:203], v[156:159]
    v_mfma_f32_16x16x32_bf16 v[164:167], v[124:127], v[204:207], v[164:167]
    v_mfma_f32_16x16x32_bf16 v[212:215], v[124:127], v[12:15], v[212:215]
    ds_read_b64 v[224:225], v9 offset:0
    ds_read_b64 v[226:227], v9 offset:128
    ds_read_b64 v[228:229], v9 offset:256
    ds_read_b64 v[230:231], v9 offset:384
    ds_read_b64 v[232:233], v9 offset:512
    s_waitcnt lgkmcnt(0)
    v_mul_u32_u24 v234, 392, v2
    v_lshl_add_u32 v234, v3, 3, v234
    s_lshr_b32 s52, s43, 2
    s_lshl_b32 s52, s52, 7
    s_and_b32 s53, s43, 3
    s_lshl_b32 s53, s53, 5
    s_add_u32 s52, s52, s53
    v_add_u32 v234, s52, v234
    v_mul_f32 v218, v208, v225
    v_fma_f32 v128, v128, v224, -v218
    v_mul_f32 v218, v209, v225
    v_fma_f32 v129, v129, v224, -v218
    v_mul_f32 v218, v210, v225
    v_fma_f32 v130, v130, v224, -v218
    v_mul_f32 v218, v211, v225
    v_fma_f32 v131, v131, v224, -v218
    v_cvt_pk_bf16_f32 v216, v128, v129
    v_cvt_pk_bf16_f32 v217, v130, v131
    ds_write_b64 v234, v[216:217] offset:640
    v_mul_f32 v218, v212, v225
    v_fma_f32 v132, v132, v224, -v218
    v_mul_f32 v218, v213, v225
    v_fma_f32 v133, v133, v224, -v218
    v_mul_f32 v218, v214, v225
    v_fma_f32 v134, v134, v224, -v218
    v_mul_f32 v218, v215, v225
    v_fma_f32 v135, v135, v224, -v218
    v_cvt_pk_bf16_f32 v216, v132, v133
    v_cvt_pk_bf16_f32 v217, v134, v135
    ds_write_b64 v234, v[216:217] offset:672
    v_mul_f32 v218, v208, v227
    v_fma_f32 v136, v136, v226, -v218
    v_mul_f32 v218, v209, v227
    v_fma_f32 v137, v137, v226, -v218
    v_mul_f32 v218, v210, v227
    v_fma_f32 v138, v138, v226, -v218
    v_mul_f32 v218, v211, v227
    v_fma_f32 v139, v139, v226, -v218
    v_cvt_pk_bf16_f32 v216, v136, v137
    v_cvt_pk_bf16_f32 v217, v138, v139
    ds_write_b64 v234, v[216:217] offset:6912
    v_mul_f32 v218, v212, v227
    v_fma_f32 v140, v140, v226, -v218
    v_mul_f32 v218, v213, v227
    v_fma_f32 v141, v141, v226, -v218
    v_mul_f32 v218, v214, v227
    v_fma_f32 v142, v142, v226, -v218
    v_mul_f32 v218, v215, v227
    v_fma_f32 v143, v143, v226, -v218
    v_cvt_pk_bf16_f32 v216, v140, v141
    v_cvt_pk_bf16_f32 v217, v142, v143
    ds_write_b64 v234, v[216:217] offset:6944
    v_mul_f32 v218, v208, v229
    v_fma_f32 v144, v144, v228, -v218
    v_mul_f32 v218, v209, v229
    v_fma_f32 v145, v145, v228, -v218
    v_mul_f32 v218, v210, v229
    v_fma_f32 v146, v146, v228, -v218
    v_mul_f32 v218, v211, v229
    v_fma_f32 v147, v147, v228, -v218
    v_cvt_pk_bf16_f32 v216, v144, v145
    v_cvt_pk_bf16_f32 v217, v146, v147
    ds_write_b64 v234, v[216:217] offset:13184
    v_mul_f32 v218, v212, v229
    v_fma_f32 v148, v148, v228, -v218
    v_mul_f32 v218, v213, v229
    v_fma_f32 v149, v149, v228, -v218
    v_mul_f32 v218, v214, v229
    v_fma_f32 v150, v150, v228, -v218
    v_mul_f32 v218, v215, v229
    v_fma_f32 v151, v151, v228, -v218
    v_cvt_pk_bf16_f32 v216, v148, v149
    v_cvt_pk_bf16_f32 v217, v150, v151
    ds_write_b64 v234, v[216:217] offset:13216
    v_mul_f32 v218, v208, v231
    v_fma_f32 v152, v152, v230, -v218
    v_mul_f32 v218, v209, v231
    v_fma_f32 v153, v153, v230, -v218
    v_mul_f32 v218, v210, v231
    v_fma_f32 v154, v154, v230, -v218
    v_mul_f32 v218, v211, v231
    v_fma_f32 v155, v155, v230, -v218
    v_cvt_pk_bf16_f32 v216, v152, v153
    v_cvt_pk_bf16_f32 v217, v154, v155
    ds_write_b64 v234, v[216:217] offset:19456
    v_mul_f32 v218, v212, v231
    v_fma_f32 v156, v156, v230, -v218
    v_mul_f32 v218, v213, v231
    v_fma_f32 v157, v157, v230, -v218
    v_mul_f32 v218, v214, v231
    v_fma_f32 v158, v158, v230, -v218
    v_mul_f32 v218, v215, v231
    v_fma_f32 v159, v159, v230, -v218
    v_cvt_pk_bf16_f32 v216, v156, v157
    v_cvt_pk_bf16_f32 v217, v158, v159
    ds_write_b64 v234, v[216:217] offset:19488
    v_mul_f32 v218, v208, v233
    v_fma_f32 v160, v160, v232, -v218
    v_mul_f32 v218, v209, v233
    v_fma_f32 v161, v161, v232, -v218
    v_mul_f32 v218, v210, v233
    v_fma_f32 v162, v162, v232, -v218
    v_mul_f32 v218, v211, v233
    v_fma_f32 v163, v163, v232, -v218
    v_cvt_pk_bf16_f32 v216, v160, v161
    v_cvt_pk_bf16_f32 v217, v162, v163
    ds_write_b64 v234, v[216:217] offset:25728
    v_mul_f32 v218, v212, v233
    v_fma_f32 v164, v164, v232, -v218
    v_mul_f32 v218, v213, v233
    v_fma_f32 v165, v165, v232, -v218
    v_mul_f32 v218, v214, v233
    v_fma_f32 v166, v166, v232, -v218
    v_mul_f32 v218, v215, v233
    v_fma_f32 v167, v167, v232, -v218
    v_cvt_pk_bf16_f32 v216, v164, v165
    v_cvt_pk_bf16_f32 v217, v166, v167
    ds_write_b64 v234, v[216:217] offset:25760
    s_branch L_qkv0_kernel_end
L_qkv0_kernel_var_3:
    s_nop 4
    v_mov_b32 v128, 0
    v_mov_b32 v129, 0
    v_mov_b32 v130, 0
    v_mov_b32 v131, 0
    v_mov_b32 v132, 0
    v_mov_b32 v133, 0
    v_mov_b32 v134, 0
    v_mov_b32 v135, 0
    v_mov_b32 v136, 0
    v_mov_b32 v137, 0
    v_mov_b32 v138, 0
    v_mov_b32 v139, 0
    v_mov_b32 v140, 0
    v_mov_b32 v141, 0
    v_mov_b32 v142, 0
    v_mov_b32 v143, 0
    v_mov_b32 v176, 0
    v_mov_b32 v177, 0
    v_mov_b32 v178, 0
    v_mov_b32 v179, 0
    s_mul_i32 s50, s6, 896
    s_mul_i32 s51, s5, 384
    s_add_u32 s50, s50, s51
    s_lshl_b32 s51, s43, 5
    s_add_u32 s50, s50, s51
    ds_read_b128 v[144:147], v7 offset:14848
    ds_read_b128 v[148:151], v7 offset:29696
    ds_read_b128 v[152:155], v7 offset:44544
    ds_read_b128 v[156:159], v7 offset:59392
    ds_read_b128 v[160:163], v7 offset:14912
    ds_read_b128 v[164:167], v7 offset:29760
    ds_read_b128 v[168:171], v7 offset:44608
    ds_read_b128 v[172:175], v7 offset:59456
    s_waitcnt lgkmcnt(4)
    s_waitcnt vmcnt(27)
    v_mfma_f32_16x16x32_bf16 v[128:131], v[16:19], v[144:147], v[128:131]
    v_mfma_f32_16x16x32_bf16 v[132:135], v[16:19], v[148:151], v[132:135]
    v_mfma_f32_16x16x32_bf16 v[136:139], v[16:19], v[152:155], v[136:139]
    v_mfma_f32_16x16x32_bf16 v[140:143], v[16:19], v[156:159], v[140:143]
    v_mfma_f32_16x16x32_bf16 v[176:179], v[16:19], v[12:15], v[176:179]
    ds_read_b128 v[144:147], v7 offset:14976
    ds_read_b128 v[148:151], v7 offset:29824
    ds_read_b128 v[152:155], v7 offset:44672
    ds_read_b128 v[156:159], v7 offset:59520
    s_waitcnt lgkmcnt(4)
    s_waitcnt vmcnt(25)
    v_mfma_f32_16x16x32_bf16 v[128:131], v[20:23], v[160:163], v[128:131]
    v_mfma_f32_16x16x32_bf16 v[132:135], v[20:23], v[164:167], v[132:135]
    v_mfma_f32_16x16x32_bf16 v[136:139], v[20:23], v[168:171], v[136:139]
    v_mfma_f32_16x16x32_bf16 v[140:143], v[20:23], v[172:175], v[140:143]
    v_mfma_f32_16x16x32_bf16 v[176:179], v[20:23], v[12:15], v[176:179]
    ds_read_b128 v[160:163], v7 offset:15040
    ds_read_b128 v[164:167], v7 offset:29888
    ds_read_b128 v[168:171], v7 offset:44736
    ds_read_b128 v[172:175], v7 offset:59584
    s_waitcnt lgkmcnt(4)
    s_waitcnt vmcnt(23)
    v_mfma_f32_16x16x32_bf16 v[128:131], v[24:27], v[144:147], v[128:131]
    v_mfma_f32_16x16x32_bf16 v[132:135], v[24:27], v[148:151], v[132:135]
    v_mfma_f32_16x16x32_bf16 v[136:139], v[24:27], v[152:155], v[136:139]
    v_mfma_f32_16x16x32_bf16 v[140:143], v[24:27], v[156:159], v[140:143]
    v_mfma_f32_16x16x32_bf16 v[176:179], v[24:27], v[12:15], v[176:179]
    ds_read_b128 v[144:147], v7 offset:15104
    ds_read_b128 v[148:151], v7 offset:29952
    ds_read_b128 v[152:155], v7 offset:44800
    ds_read_b128 v[156:159], v7 offset:59648
    s_waitcnt lgkmcnt(4)
    s_waitcnt vmcnt(21)
    v_mfma_f32_16x16x32_bf16 v[128:131], v[28:31], v[160:163], v[128:131]
    v_mfma_f32_16x16x32_bf16 v[132:135], v[28:31], v[164:167], v[132:135]
    v_mfma_f32_16x16x32_bf16 v[136:139], v[28:31], v[168:171], v[136:139]
    v_mfma_f32_16x16x32_bf16 v[140:143], v[28:31], v[172:175], v[140:143]
    v_mfma_f32_16x16x32_bf16 v[176:179], v[28:31], v[12:15], v[176:179]
    ds_read_b128 v[160:163], v7 offset:15168
    ds_read_b128 v[164:167], v7 offset:30016
    ds_read_b128 v[168:171], v7 offset:44864
    ds_read_b128 v[172:175], v7 offset:59712
    s_waitcnt lgkmcnt(4)
    s_waitcnt vmcnt(19)
    v_mfma_f32_16x16x32_bf16 v[128:131], v[32:35], v[144:147], v[128:131]
    v_mfma_f32_16x16x32_bf16 v[132:135], v[32:35], v[148:151], v[132:135]
    v_mfma_f32_16x16x32_bf16 v[136:139], v[32:35], v[152:155], v[136:139]
    v_mfma_f32_16x16x32_bf16 v[140:143], v[32:35], v[156:159], v[140:143]
    v_mfma_f32_16x16x32_bf16 v[176:179], v[32:35], v[12:15], v[176:179]
    ds_read_b128 v[144:147], v7 offset:15232
    ds_read_b128 v[148:151], v7 offset:30080
    ds_read_b128 v[152:155], v7 offset:44928
    ds_read_b128 v[156:159], v7 offset:59776
    s_waitcnt lgkmcnt(4)
    s_waitcnt vmcnt(17)
    v_mfma_f32_16x16x32_bf16 v[128:131], v[36:39], v[160:163], v[128:131]
    v_mfma_f32_16x16x32_bf16 v[132:135], v[36:39], v[164:167], v[132:135]
    v_mfma_f32_16x16x32_bf16 v[136:139], v[36:39], v[168:171], v[136:139]
    v_mfma_f32_16x16x32_bf16 v[140:143], v[36:39], v[172:175], v[140:143]
    v_mfma_f32_16x16x32_bf16 v[176:179], v[36:39], v[12:15], v[176:179]
    ds_read_b128 v[160:163], v7 offset:15296
    ds_read_b128 v[164:167], v7 offset:30144
    ds_read_b128 v[168:171], v7 offset:44992
    ds_read_b128 v[172:175], v7 offset:59840
    s_waitcnt lgkmcnt(4)
    s_waitcnt vmcnt(15)
    v_mfma_f32_16x16x32_bf16 v[128:131], v[40:43], v[144:147], v[128:131]
    v_mfma_f32_16x16x32_bf16 v[132:135], v[40:43], v[148:151], v[132:135]
    v_mfma_f32_16x16x32_bf16 v[136:139], v[40:43], v[152:155], v[136:139]
    v_mfma_f32_16x16x32_bf16 v[140:143], v[40:43], v[156:159], v[140:143]
    v_mfma_f32_16x16x32_bf16 v[176:179], v[40:43], v[12:15], v[176:179]
    ds_read_b128 v[144:147], v7 offset:15360
    ds_read_b128 v[148:151], v7 offset:30208
    ds_read_b128 v[152:155], v7 offset:45056
    ds_read_b128 v[156:159], v7 offset:59904
    s_waitcnt lgkmcnt(4)
    s_waitcnt vmcnt(13)
    v_mfma_f32_16x16x32_bf16 v[128:131], v[44:47], v[160:163], v[128:131]
    v_mfma_f32_16x16x32_bf16 v[132:135], v[44:47], v[164:167], v[132:135]
    v_mfma_f32_16x16x32_bf16 v[136:139], v[44:47], v[168:171], v[136:139]
    v_mfma_f32_16x16x32_bf16 v[140:143], v[44:47], v[172:175], v[140:143]
    v_mfma_f32_16x16x32_bf16 v[176:179], v[44:47], v[12:15], v[176:179]
    ds_read_b128 v[160:163], v7 offset:15424
    ds_read_b128 v[164:167], v7 offset:30272
    ds_read_b128 v[168:171], v7 offset:45120
    ds_read_b128 v[172:175], v7 offset:59968
    s_waitcnt lgkmcnt(4)
    s_waitcnt vmcnt(11)
    v_mfma_f32_16x16x32_bf16 v[128:131], v[48:51], v[144:147], v[128:131]
    v_mfma_f32_16x16x32_bf16 v[132:135], v[48:51], v[148:151], v[132:135]
    v_mfma_f32_16x16x32_bf16 v[136:139], v[48:51], v[152:155], v[136:139]
    v_mfma_f32_16x16x32_bf16 v[140:143], v[48:51], v[156:159], v[140:143]
    v_mfma_f32_16x16x32_bf16 v[176:179], v[48:51], v[12:15], v[176:179]
    ds_read_b128 v[144:147], v7 offset:15488
    ds_read_b128 v[148:151], v7 offset:30336
    ds_read_b128 v[152:155], v7 offset:45184
    ds_read_b128 v[156:159], v7 offset:60032
    s_waitcnt lgkmcnt(4)
    s_waitcnt vmcnt(9)
    v_mfma_f32_16x16x32_bf16 v[128:131], v[52:55], v[160:163], v[128:131]
    v_mfma_f32_16x16x32_bf16 v[132:135], v[52:55], v[164:167], v[132:135]
    v_mfma_f32_16x16x32_bf16 v[136:139], v[52:55], v[168:171], v[136:139]
    v_mfma_f32_16x16x32_bf16 v[140:143], v[52:55], v[172:175], v[140:143]
    v_mfma_f32_16x16x32_bf16 v[176:179], v[52:55], v[12:15], v[176:179]
    ds_read_b128 v[160:163], v7 offset:15552
    ds_read_b128 v[164:167], v7 offset:30400
    ds_read_b128 v[168:171], v7 offset:45248
    ds_read_b128 v[172:175], v7 offset:60096
    s_waitcnt lgkmcnt(4)
    s_waitcnt vmcnt(7)
    v_mfma_f32_16x16x32_bf16 v[128:131], v[56:59], v[144:147], v[128:131]
    v_mfma_f32_16x16x32_bf16 v[132:135], v[56:59], v[148:151], v[132:135]
    v_mfma_f32_16x16x32_bf16 v[136:139], v[56:59], v[152:155], v[136:139]
    v_mfma_f32_16x16x32_bf16 v[140:143], v[56:59], v[156:159], v[140:143]
    v_mfma_f32_16x16x32_bf16 v[176:179], v[56:59], v[12:15], v[176:179]
    ds_read_b128 v[144:147], v7 offset:15616
    ds_read_b128 v[148:151], v7 offset:30464
    ds_read_b128 v[152:155], v7 offset:45312
    ds_read_b128 v[156:159], v7 offset:60160
    s_waitcnt lgkmcnt(4)
    s_waitcnt vmcnt(5)
    v_mfma_f32_16x16x32_bf16 v[128:131], v[60:63], v[160:163], v[128:131]
    v_mfma_f32_16x16x32_bf16 v[132:135], v[60:63], v[164:167], v[132:135]
    v_mfma_f32_16x16x32_bf16 v[136:139], v[60:63], v[168:171], v[136:139]
    v_mfma_f32_16x16x32_bf16 v[140:143], v[60:63], v[172:175], v[140:143]
    v_mfma_f32_16x16x32_bf16 v[176:179], v[60:63], v[12:15], v[176:179]
    ds_read_b128 v[160:163], v7 offset:15680
    ds_read_b128 v[164:167], v7 offset:30528
    ds_read_b128 v[168:171], v7 offset:45376
    ds_read_b128 v[172:175], v7 offset:60224
    s_waitcnt lgkmcnt(4)
    s_waitcnt vmcnt(3)
    v_mfma_f32_16x16x32_bf16 v[128:131], v[64:67], v[144:147], v[128:131]
    v_mfma_f32_16x16x32_bf16 v[132:135], v[64:67], v[148:151], v[132:135]
    v_mfma_f32_16x16x32_bf16 v[136:139], v[64:67], v[152:155], v[136:139]
    v_mfma_f32_16x16x32_bf16 v[140:143], v[64:67], v[156:159], v[140:143]
    v_mfma_f32_16x16x32_bf16 v[176:179], v[64:67], v[12:15], v[176:179]
    s_waitcnt lgkmcnt(0)
    s_waitcnt vmcnt(1)
    v_mfma_f32_16x16x32_bf16 v[128:131], v[68:71], v[160:163], v[128:131]
    v_mfma_f32_16x16x32_bf16 v[132:135], v[68:71], v[164:167], v[132:135]
    v_mfma_f32_16x16x32_bf16 v[136:139], v[68:71], v[168:171], v[136:139]
    v_mfma_f32_16x16x32_bf16 v[140:143], v[68:71], v[172:175], v[140:143]
    v_mfma_f32_16x16x32_bf16 v[176:179], v[68:71], v[12:15], v[176:179]
    ds_read_b64 v[188:189], v9 offset:128
    ds_read_b64 v[190:191], v9 offset:256
    ds_read_b64 v[192:193], v9 offset:384
    ds_read_b64 v[194:195], v9 offset:512
    s_waitcnt lgkmcnt(0)
    v_mul_u32_u24 v196, 392, v2
    v_lshl_add_u32 v196, v3, 3, v196
    s_lshr_b32 s52, s43, 2
    s_lshl_b32 s52, s52, 7
    s_and_b32 s53, s43, 3
    s_lshl_b32 s53, s53, 5
    s_add_u32 s52, s52, s53
    v_add_u32 v196, s52, v196
    v_mul_f32 v182, v176, v189
    v_fma_f32 v128, v128, v188, -v182
    v_mul_f32 v182, v177, v189
    v_fma_f32 v129, v129, v188, -v182
    v_mul_f32 v182, v178, v189
    v_fma_f32 v130, v130, v188, -v182
    v_mul_f32 v182, v179, v189
    v_fma_f32 v131, v131, v188, -v182
    v_cvt_pk_bf16_f32 v180, v128, v129
    v_cvt_pk_bf16_f32 v181, v130, v131
    ds_write_b64 v196, v[180:181] offset:6912
    v_mul_f32 v182, v176, v191
    v_fma_f32 v132, v132, v190, -v182
    v_mul_f32 v182, v177, v191
    v_fma_f32 v133, v133, v190, -v182
    v_mul_f32 v182, v178, v191
    v_fma_f32 v134, v134, v190, -v182
    v_mul_f32 v182, v179, v191
    v_fma_f32 v135, v135, v190, -v182
    v_cvt_pk_bf16_f32 v180, v132, v133
    v_cvt_pk_bf16_f32 v181, v134, v135
    ds_write_b64 v196, v[180:181] offset:13184
    v_mul_f32 v182, v176, v193
    v_fma_f32 v136, v136, v192, -v182
    v_mul_f32 v182, v177, v193
    v_fma_f32 v137, v137, v192, -v182
    v_mul_f32 v182, v178, v193
    v_fma_f32 v138, v138, v192, -v182
    v_mul_f32 v182, v179, v193
    v_fma_f32 v139, v139, v192, -v182
    v_cvt_pk_bf16_f32 v180, v136, v137
    v_cvt_pk_bf16_f32 v181, v138, v139
    ds_write_b64 v196, v[180:181] offset:19456
    v_mul_f32 v182, v176, v195
    v_fma_f32 v140, v140, v194, -v182
    v_mul_f32 v182, v177, v195
    v_fma_f32 v141, v141, v194, -v182
    v_mul_f32 v182, v178, v195
    v_fma_f32 v142, v142, v194, -v182
    v_mul_f32 v182, v179, v195
    v_fma_f32 v143, v143, v194, -v182
    v_cvt_pk_bf16_f32 v180, v140, v141
    v_cvt_pk_bf16_f32 v181, v142, v143
    ds_write_b64 v196, v[180:181] offset:25728
    s_branch L_qkv0_kernel_end
L_qkv0_kernel_end:
    s_nop 1
    s_waitcnt lgkmcnt(0)
    s_barrier
    v_and_b32 v128, 3, v0
    v_bfe_u32 v129, v0, 2, 1
    v_lshrrev_b32 v130, 3, v0
    v_mul_u32_u24 v131, 392, v130
    v_mul_u32_u24 v134, 56, v129
    v_add_u32 v131, v131, v134
    v_add_u32 v131, 6912, v131
    v_mul_u32_u24 v134, 1568, v128
    v_sub_u32 v132, v131, v134
    v_add_u32 v132, 0xfffffd70, v132
    v_lshlrev_b32 v134, 4, v128
    v_add_u32 v133, v131, v134
    v_add_u32 v133, 0xffffeb90, v133
    ds_read_b64 v[138:139], v131 offset:0
    ds_read_b64 v[140:141], v131 offset:8
    ds_read_b64 v[142:143], v131 offset:16
    ds_read_b64 v[144:145], v131 offset:24
    ds_read_b64 v[146:147], v131 offset:32
    ds_read_b64 v[148:149], v131 offset:40
    ds_read_b64 v[150:151], v131 offset:48
    ds_read_b64 v[152:153], v132 offset:784
    ds_read_b64 v[154:155], v132 offset:792
    ds_read_b64 v[156:157], v132 offset:800
    ds_read_b64 v[158:159], v132 offset:808
    ds_read_b64 v[160:161], v132 offset:816
    ds_read_b64 v[162:163], v132 offset:824
    ds_read_b64 v[164:165], v132 offset:832
    ds_read_b64 v[166:167], v132 offset:0
    ds_read_b64 v[168:169], v132 offset:8
    ds_read_b64 v[170:171], v132 offset:16
    ds_read_b64 v[172:173], v132 offset:24
    ds_read_b64 v[174:175], v132 offset:32
    ds_read_b64 v[176:177], v132 offset:40
    ds_read_b64 v[178:179], v132 offset:48
    ds_read_b64 v[180:181], v133 offset:5488
    ds_read_b64 v[182:183], v133 offset:5496
    ds_read_b64 v[184:185], v133 offset:4704
    ds_read_b64 v[186:187], v133 offset:4712
    ds_read_b64 v[188:189], v133 offset:3920
    ds_read_b64 v[190:191], v133 offset:3928
    ds_read_b64 v[192:193], v133 offset:3136
    ds_read_b64 v[194:195], v133 offset:3144
    ds_read_b64 v[196:197], v133 offset:2352
    ds_read_b64 v[198:199], v133 offset:2360
    ds_read_b64 v[200:201], v133 offset:1568
    ds_read_b64 v[202:203], v133 offset:1576
    ds_read_b64 v[204:205], v133 offset:784
    ds_read_b64 v[206:207], v133 offset:792
    ds_read_b64 v[208:209], v133 offset:0
    ds_read_b64 v[210:211], v133 offset:8
    v_mov_b32 v212, 0
    v_mov_b32 v213, 0
    s_waitcnt lgkmcnt(0)
    v_dot2_f32_bf16 v212, v138, v152, v212
    v_dot2_f32_bf16 v213, v138, v166, v213
    v_dot2_f32_bf16 v212, v139, v153, v212
    v_dot2_f32_bf16 v213, v139, v167, v213
    v_dot2_f32_bf16 v212, v140, v154, v212
    v_dot2_f32_bf16 v213, v140, v168, v213
    v_dot2_f32_bf16 v212, v141, v155, v212
    v_dot2_f32_bf16 v213, v141, v169, v213
    v_dot2_f32_bf16 v212, v142, v156, v212
    v_dot2_f32_bf16 v213, v142, v170, v213
    v_dot2_f32_bf16 v212, v143, v157, v212
    v_dot2_f32_bf16 v213, v143, v171, v213
    v_dot2_f32_bf16 v212, v144, v158, v212
    v_dot2_f32_bf16 v213, v144, v172, v213
    v_dot2_f32_bf16 v212, v145, v159, v212
    v_dot2_f32_bf16 v213, v145, v173, v213
    v_dot2_f32_bf16 v212, v146, v160, v212
    v_dot2_f32_bf16 v213, v146, v174, v213
    v_dot2_f32_bf16 v212, v147, v161, v212
    v_dot2_f32_bf16 v213, v147, v175, v213
    v_dot2_f32_bf16 v212, v148, v162, v212
    v_dot2_f32_bf16 v213, v148, v176, v213
    v_dot2_f32_bf16 v212, v149, v163, v212
    v_dot2_f32_bf16 v213, v149, v177, v213
    v_dot2_f32_bf16 v212, v150, v164, v212
    v_dot2_f32_bf16 v213, v150, v178, v213
    v_dot2_f32_bf16 v212, v151, v165, v212
    v_dot2_f32_bf16 v213, v151, v179, v213
    s_nop 2
    v_cvt_pk_bf16_f32 v134, v212, v213
    v_lshlrev_b32 v212, 16, v134
    v_and_b32 v213, 0xffff0000, v134
    v_mul_f32 v212, 0x3e41848f, v212
    v_mul_f32 v213, 0x3e41848f, v213
    v_cvt_pk_bf16_f32 v134, v212, v213
    v_lshlrev_b32 v212, 16, v134
    v_and_b32 v213, 0xffff0000, v134
    v_add_u32 v135, s6, v130
    v_lshlrev_b32 v136, 2, v128
    v_sub_u32 v135, v135, v136
    v_mov_b32 v137, 0xce6e6b28
    v_cmp_gt_i32 vcc, 0, v135
    s_nop 1
    v_cndmask_b32 v212, v212, v137, vcc
    v_cmp_gt_i32 vcc, 2, v135
    s_nop 1
    v_cndmask_b32 v213, v213, v137, vcc
    v_max_f32 v134, v212, v213
    s_nop 1
    v_max_f32_dpp v135, v134, v134 quad_perm:[1,0,3,2] row_mask:0xf bank_mask:0xf
    s_nop 1
    v_max_f32_dpp v134, v135, v135 quad_perm:[2,3,0,1] row_mask:0xf bank_mask:0xf
    v_sub_f32 v212, v212, v134
    v_sub_f32 v213, v213, v134
    v_mul_f32 v212, 0x3fb8aa3b, v212
    v_mul_f32 v213, 0x3fb8aa3b, v213
    v_exp_f32 v212, v212
    v_exp_f32 v213, v213
    s_nop 0
    v_add_f32 v134, v212, v213
    s_nop 1
    v_add_f32_dpp v135, v134, v134 quad_perm:[1,0,3,2] row_mask:0xf bank_mask:0xf
    s_nop 1
    v_add_f32_dpp v134, v135, v135 quad_perm:[2,3,0,1] row_mask:0xf bank_mask:0xf
    v_rcp_f32 v134, v134
    s_nop 0
    v_mul_f32 v212, v212, v134
    v_mul_f32 v213, v213, v134
    v_cvt_pk_bf16_f32 v134, v212, v213
    s_nop 1
    v_mov_b32_dpp v214, v134 quad_perm:[0,0,0,0] row_mask:0xf bank_mask:0xf
    v_mov_b32_dpp v215, v134 quad_perm:[1,1,1,1] row_mask:0xf bank_mask:0xf
    v_mov_b32_dpp v216, v134 quad_perm:[2,2,2,2] row_mask:0xf bank_mask:0xf
    v_mov_b32_dpp v217, v134 quad_perm:[3,3,3,3] row_mask:0xf bank_mask:0xf
    v_mov_b32 v218, 0
    v_mov_b32 v219, 0
    v_mov_b32 v220, 0
    v_mov_b32 v221, 0
    v_mov_b32 v222, 0
    v_mov_b32 v223, 0
    v_mov_b32 v224, 0
    v_mov_b32 v225, 0
    s_mov_b32 s52, 0x05040100
    s_mov_b32 s53, 0x07060302
    v_perm_b32 v134, v184, v180, s52
    v_perm_b32 v135, v184, v180, s53
    v_dot2_f32_bf16 v218, v134, v214, v218
    v_dot2_f32_bf16 v219, v135, v214, v219
    v_perm_b32 v134, v185, v181, s52
    v_perm_b32 v135, v185, v181, s53
    v_dot2_f32_bf16 v220, v134, v214, v220
    v_dot2_f32_bf16 v221, v135, v214, v221
    v_perm_b32 v134, v186, v182, s52
    v_perm_b32 v135, v186, v182, s53
    v_dot2_f32_bf16 v222, v134, v214, v222
    v_dot2_f32_bf16 v223, v135, v214, v223
    v_perm_b32 v134, v187, v183, s52
    v_perm_b32 v135, v187, v183, s53
    v_dot2_f32_bf16 v224, v134, v214, v224
    v_dot2_f32_bf16 v225, v135, v214, v225
    v_perm_b32 v134, v192, v188, s52
    v_perm_b32 v135, v192, v188, s53
    v_dot2_f32_bf16 v218, v134, v215, v218
    v_dot2_f32_bf16 v219, v135, v215, v219
    v_perm_b32 v134, v193, v189, s52
    v_perm_b32 v135, v193, v189, s53
    v_dot2_f32_bf16 v220, v134, v215, v220
    v_dot2_f32_bf16 v221, v135, v215, v221
    v_perm_b32 v134, v194, v190, s52
    v_perm_b32 v135, v194, v190, s53
    v_dot2_f32_bf16 v222, v134, v215, v222
    v_dot2_f32_bf16 v223, v135, v215, v223
    v_perm_b32 v134, v195, v191, s52
    v_perm_b32 v135, v195, v191, s53
    v_dot2_f32_bf16 v224, v134, v215, v224
    v_dot2_f32_bf16 v225, v135, v215, v225
    v_perm_b32 v134, v200, v196, s52
    v_perm_b32 v135, v200, v196, s53
    v_dot2_f32_bf16 v218, v134, v216, v218
    v_dot2_f32_bf16 v219, v135, v216, v219
    v_perm_b32 v134, v201, v197, s52
    v_perm_b32 v135, v201, v197, s53
    v_dot2_f32_bf16 v220, v134, v216, v220
    v_dot2_f32_bf16 v221, v135, v216, v221
    v_perm_b32 v134, v202, v198, s52
    v_perm_b32 v135, v202, v198, s53
    v_dot2_f32_bf16 v222, v134, v216, v222
    v_dot2_f32_bf16 v223, v135, v216, v223
    v_perm_b32 v134, v203, v199, s52
    v_perm_b32 v135, v203, v199, s53
    v_dot2_f32_bf16 v224, v134, v216, v224
    v_dot2_f32_bf16 v225, v135, v216, v225
    v_perm_b32 v134, v208, v204, s52
    v_perm_b32 v135, v208, v204, s53
    v_dot2_f32_bf16 v218, v134, v217, v218
    v_dot2_f32_bf16 v219, v135, v217, v219
    v_perm_b32 v134, v209, v205, s52
    v_perm_b32 v135, v209, v205, s53
    v_dot2_f32_bf16 v220, v134, v217, v220
    v_dot2_f32_bf16 v221, v135, v217, v221
    v_perm_b32 v134, v210, v206, s52
    v_perm_b32 v135, v210, v206, s53
    v_dot2_f32_bf16 v222, v134, v217, v222
    v_dot2_f32_bf16 v223, v135, v217, v223
    v_perm_b32 v134, v211, v207, s52
    v_perm_b32 v135, v211, v207, s53
    v_dot2_f32_bf16 v224, v134, v217, v224
    v_dot2_f32_bf16 v225, v135, v217, v225
    v_cvt_pk_bf16_f32 v226, v218, v219
    v_cvt_pk_bf16_f32 v227, v220, v221
    v_cvt_pk_bf16_f32 v228, v222, v223
    v_cvt_pk_bf16_f32 v229, v224, v225
    v_add_u32 v135, s6, v130
    v_mul_u32_u24 v135, 896, v135
    v_lshl_add_u32 v136, s5, 1, v129
    v_mul_u32_u24 v136, 56, v136
    v_lshlrev_b32 v137, 4, v128
    v_add3_u32 v135, v135, v136, v137
    buffer_store_dwordx2 v[226:227], v135, s[16:19], 0 offen
    v_cmp_gt_u32 vcc, 3, v128
    s_and_saveexec_b64 s[54:55], vcc
    buffer_store_dwordx2 v[228:229], v135, s[16:19], 0 offen offset:8
    s_mov_b64 exec, s[54:55]
L_qkv0_kernel_done:
    s_endpgm
.globl wo0_kernel
.p2align 8
.type wo0_kernel,@function
wo0_kernel:
    s_cmp_ge_u32 s2, 256
    s_cbranch_scc1 L_wo0_kernel_done
    s_load_dwordx4 s[32:35], s[0:1], 0
    s_load_dwordx4 s[36:39], s[0:1], 64
    s_load_dwordx2 s[40:41], s[0:1], 80
    v_lshrrev_b32 v4, 6, v0
    v_and_b32 v1, 63, v0
    v_readfirstlane_b32 s3, v4
    s_lshr_b32 s7, s2, 3
    s_mul_hi_u32 s4, s7, 0x40000000
    s_mul_i32 s42, s4, 4
    s_sub_u32 s5, s7, s42
    s_and_b32 s7, s2, 7
    s_mul_i32 s7, s7, 8
    s_add_u32 s4, s4, s7
    s_mul_i32 s6, s4, 32
    v_and_b32 v2, 15, v1
    v_lshrrev_b32 v3, 4, v1
    s_mov_b32 s28, 0x3f803f80
    s_mov_b32 s29, 0x3d372713
    s_mov_b32 s30, 0xc0135761
    s_waitcnt lgkmcnt(0)
    s_mov_b32 s8, s40
    s_mov_b32 s9, s41
    s_and_b32 s9, s9, 0xffff
    s_mov_b32 s10, 0x10000000
    s_mov_b32 s11, 0x00020000
    s_add_u32 s12, s40, 0xb86000
    s_addc_u32 s13, s41, 0
    s_and_b32 s13, s13, 0xffff
    s_mov_b32 s14, 0x1c0000
    s_mov_b32 s15, 0x00020000
    s_add_u32 s16, s40, 0xd46000
    s_addc_u32 s17, s41, 0
    s_and_b32 s17, s17, 0xffff
    s_mov_b32 s18, 0x1c0000
    s_mov_b32 s19, 0x00020000
    s_mov_b32 s20, s32
    s_mov_b32 s21, s33
    s_and_b32 s21, s21, 0xffff
    s_mov_b32 s22, 0x1c0000
    s_mov_b32 s23, 0x00020000
    v_lshrrev_b32 v82, 4, v1
    v_and_b32 v83, 15, v1
    s_mul_i32 s42, s3, 4
    v_add_u32 v82, s42, v82
    v_mul_u32_u24 v85, 928, v82
    v_lshl_add_u32 v85, v83, 3, v85
    v_add_u32 v85, 256, v85
    v_add_u32 v84, s6, v82
    s_movk_i32 s42, 896
    v_mul_lo_u32 v84, v84, s42
    v_lshl_add_u32 v84, v83, 3, v84
    buffer_load_dwordx2 v[68:69], v84, s[12:15], 0 offen offset:0
    buffer_load_dwordx2 v[70:71], v84, s[12:15], 0 offen offset:128
    buffer_load_dwordx2 v[72:73], v84, s[12:15], 0 offen offset:256
    buffer_load_dwordx2 v[74:75], v84, s[12:15], 0 offen offset:384
    buffer_load_dwordx2 v[76:77], v84, s[12:15], 0 offen offset:512
    buffer_load_dwordx2 v[78:79], v84, s[12:15], 0 offen offset:640
    buffer_load_dwordx2 v[80:81], v84, s[12:15], 0 offen offset:768
    v_lshlrev_b32 v6, 4, v1
    s_mov_b32 s43, 0
    s_cmp_eq_u32 s3, 1
    s_cselect_b32 s43, 1, s43
    s_cmp_eq_u32 s3, 2
    s_cselect_b32 s43, 2, s43
    s_cmp_eq_u32 s3, 3
    s_cselect_b32 s43, 3, s43
    s_cmp_eq_u32 s3, 4
    s_cselect_b32 s43, 4, s43
    s_cmp_eq_u32 s3, 5
    s_cselect_b32 s43, 5, s43
    s_cmp_eq_u32 s3, 6
    s_cselect_b32 s43, 6, s43
    s_mul_i32 s48, s5, 7
    s_add_u32 s48, s48, s43
    s_mul_i32 s48, s48, 14336
    s_add_u32 s48, s48, 0x150000
    s_barrier
    buffer_load_dwordx4 v[12:15], v6, s[8:11], s48 offen offset:0
    buffer_load_dwordx4 v[16:19], v6, s[8:11], s48 offen offset:1024
    buffer_load_dwordx4 v[20:23], v6, s[8:11], s48 offen offset:2048
    buffer_load_dwordx4 v[24:27], v6, s[8:11], s48 offen offset:3072
    s_add_u32 s49, s48, 0x1000
    buffer_load_dwordx4 v[28:31], v6, s[8:11], s49 offen offset:0
    s_add_u32 s49, s48, 0x1000
    buffer_load_dwordx4 v[32:35], v6, s[8:11], s49 offen offset:1024
    s_add_u32 s49, s48, 0x1000
    buffer_load_dwordx4 v[36:39], v6, s[8:11], s49 offen offset:2048
    s_add_u32 s49, s48, 0x1000
    buffer_load_dwordx4 v[40:43], v6, s[8:11], s49 offen offset:3072
    s_add_u32 s49, s48, 0x2000
    buffer_load_dwordx4 v[44:47], v6, s[8:11], s49 offen offset:0
    s_add_u32 s49, s48, 0x2000
    buffer_load_dwordx4 v[48:51], v6, s[8:11], s49 offen offset:1024
    s_add_u32 s49, s48, 0x2000
    buffer_load_dwordx4 v[52:55], v6, s[8:11], s49 offen offset:2048
    s_add_u32 s49, s48, 0x2000
    buffer_load_dwordx4 v[56:59], v6, s[8:11], s49 offen offset:3072
    s_add_u32 s49, s48, 0x3000
    buffer_load_dwordx4 v[60:63], v6, s[8:11], s49 offen offset:0
    s_add_u32 s49, s48, 0x3000
    buffer_load_dwordx4 v[64:67], v6, s[8:11], s49 offen offset:1024
    s_waitcnt vmcnt(14)
    ds_write_b64 v85, v[68:69] offset:0
    ds_write_b64 v85, v[70:71] offset:128
    ds_write_b64 v85, v[72:73] offset:256
    ds_write_b64 v85, v[74:75] offset:384
    ds_write_b64 v85, v[76:77] offset:512
    ds_write_b64 v85, v[78:79] offset:640
    ds_write_b64 v85, v[80:81] offset:768
    s_waitcnt lgkmcnt(0)
    s_barrier
    v_mul_u32_u24 v7, 928, v2
    v_lshl_add_u32 v7, v3, 4, v7
    v_add_u32 v7, 256, v7
    s_movk_i32 s42, 896
    v_mul_lo_u32 v8, v2, s42
    v_lshl_add_u32 v8, v3, 3, v8
    v_lshlrev_b32 v9, 3, v2
    s_cmp_eq_u32 s3, 0
    s_cbranch_scc1 L_wo0_kernel_var_1
    s_cmp_eq_u32 s3, 1
    s_cbranch_scc1 L_wo0_kernel_var_1
    s_cmp_eq_u32 s3, 2
    s_cbranch_scc1 L_wo0_kernel_var_1
    s_cmp_eq_u32 s3, 3
    s_cbranch_scc1 L_wo0_kernel_var_1
    s_cmp_eq_u32 s3, 4
    s_cbranch_scc1 L_wo0_kernel_var_1
    s_cmp_eq_u32 s3, 5
    s_cbranch_scc1 L_wo0_kernel_var_1
    s_cmp_eq_u32 s3, 6
    s_cbranch_scc1 L_wo0_kernel_var_1
    s_branch L_wo0_kernel_end
L_wo0_kernel_var_1:
    s_nop 4
    v_mov_b32 v68, 0
    v_mov_b32 v69, 0
    v_mov_b32 v70, 0
    v_mov_b32 v71, 0
    v_mov_b32 v72, 0
    v_mov_b32 v73, 0
    v_mov_b32 v74, 0
    v_mov_b32 v75, 0
    s_mul_i32 s50, s6, 896
    s_mul_i32 s51, s5, 224
    s_add_u32 s50, s50, s51
    s_lshl_b32 s51, s43, 5
    s_add_u32 s50, s50, s51
    buffer_load_dwordx2 v[92:93], v8, s[20:23], s50 offen offset:0
    s_add_u32 s52, s50, 14336
    buffer_load_dwordx2 v[94:95], v8, s[20:23], s52 offen offset:0
    ds_read_b128 v[76:79], v7 offset:0
    ds_read_b128 v[80:83], v7 offset:14848
    ds_read_b128 v[84:87], v7 offset:64
    ds_read_b128 v[88:91], v7 offset:14912
    s_waitcnt lgkmcnt(2)
    s_waitcnt vmcnt(15)
    v_mfma_f32_16x16x32_bf16 v[68:71], v[12:15], v[76:79], v[68:71]
    v_mfma_f32_16x16x32_bf16 v[72:75], v[12:15], v[80:83], v[72:75]
    ds_read_b128 v[76:79], v7 offset:128
    ds_read_b128 v[80:83], v7 offset:14976
    s_waitcnt lgkmcnt(2)
    s_waitcnt vmcnt(14)
    v_mfma_f32_16x16x32_bf16 v[68:71], v[16:19], v[84:87], v[68:71]
    v_mfma_f32_16x16x32_bf16 v[72:75], v[16:19], v[88:91], v[72:75]
    ds_read_b128 v[84:87], v7 offset:192
    ds_read_b128 v[88:91], v7 offset:15040
    s_waitcnt lgkmcnt(2)
    s_waitcnt vmcnt(13)
    v_mfma_f32_16x16x32_bf16 v[68:71], v[20:23], v[76:79], v[68:71]
    v_mfma_f32_16x16x32_bf16 v[72:75], v[20:23], v[80:83], v[72:75]
    ds_read_b128 v[76:79], v7 offset:256
    ds_read_b128 v[80:83], v7 offset:15104
    s_waitcnt lgkmcnt(2)
    s_waitcnt vmcnt(12)
    v_mfma_f32_16x16x32_bf16 v[68:71], v[24:27], v[84:87], v[68:71]
    v_mfma_f32_16x16x32_bf16 v[72:75], v[24:27], v[88:91], v[72:75]
    ds_read_b128 v[84:87], v7 offset:320
    ds_read_b128 v[88:91], v7 offset:15168
    s_waitcnt lgkmcnt(2)
    s_waitcnt vmcnt(11)
    v_mfma_f32_16x16x32_bf16 v[68:71], v[28:31], v[76:79], v[68:71]
    v_mfma_f32_16x16x32_bf16 v[72:75], v[28:31], v[80:83], v[72:75]
    ds_read_b128 v[76:79], v7 offset:384
    ds_read_b128 v[80:83], v7 offset:15232
    s_waitcnt lgkmcnt(2)
    s_waitcnt vmcnt(10)
    v_mfma_f32_16x16x32_bf16 v[68:71], v[32:35], v[84:87], v[68:71]
    v_mfma_f32_16x16x32_bf16 v[72:75], v[32:35], v[88:91], v[72:75]
    ds_read_b128 v[84:87], v7 offset:448
    ds_read_b128 v[88:91], v7 offset:15296
    s_waitcnt lgkmcnt(2)
    s_waitcnt vmcnt(9)
    v_mfma_f32_16x16x32_bf16 v[68:71], v[36:39], v[76:79], v[68:71]
    v_mfma_f32_16x16x32_bf16 v[72:75], v[36:39], v[80:83], v[72:75]
    ds_read_b128 v[76:79], v7 offset:512
    ds_read_b128 v[80:83], v7 offset:15360
    s_waitcnt lgkmcnt(2)
    s_waitcnt vmcnt(8)
    v_mfma_f32_16x16x32_bf16 v[68:71], v[40:43], v[84:87], v[68:71]
    v_mfma_f32_16x16x32_bf16 v[72:75], v[40:43], v[88:91], v[72:75]
    ds_read_b128 v[84:87], v7 offset:576
    ds_read_b128 v[88:91], v7 offset:15424
    s_waitcnt lgkmcnt(2)
    s_waitcnt vmcnt(7)
    v_mfma_f32_16x16x32_bf16 v[68:71], v[44:47], v[76:79], v[68:71]
    v_mfma_f32_16x16x32_bf16 v[72:75], v[44:47], v[80:83], v[72:75]
    ds_read_b128 v[76:79], v7 offset:640
    ds_read_b128 v[80:83], v7 offset:15488
    s_waitcnt lgkmcnt(2)
    s_waitcnt vmcnt(6)
    v_mfma_f32_16x16x32_bf16 v[68:71], v[48:51], v[84:87], v[68:71]
    v_mfma_f32_16x16x32_bf16 v[72:75], v[48:51], v[88:91], v[72:75]
    ds_read_b128 v[84:87], v7 offset:704
    ds_read_b128 v[88:91], v7 offset:15552
    s_waitcnt lgkmcnt(2)
    s_waitcnt vmcnt(5)
    v_mfma_f32_16x16x32_bf16 v[68:71], v[52:55], v[76:79], v[68:71]
    v_mfma_f32_16x16x32_bf16 v[72:75], v[52:55], v[80:83], v[72:75]
    ds_read_b128 v[76:79], v7 offset:768
    ds_read_b128 v[80:83], v7 offset:15616
    s_waitcnt lgkmcnt(2)
    s_waitcnt vmcnt(4)
    v_mfma_f32_16x16x32_bf16 v[68:71], v[56:59], v[84:87], v[68:71]
    v_mfma_f32_16x16x32_bf16 v[72:75], v[56:59], v[88:91], v[72:75]
    ds_read_b128 v[84:87], v7 offset:832
    ds_read_b128 v[88:91], v7 offset:15680
    s_waitcnt lgkmcnt(2)
    s_waitcnt vmcnt(3)
    v_mfma_f32_16x16x32_bf16 v[68:71], v[60:63], v[76:79], v[68:71]
    v_mfma_f32_16x16x32_bf16 v[72:75], v[60:63], v[80:83], v[72:75]
    s_waitcnt lgkmcnt(0)
    s_waitcnt vmcnt(2)
    v_mfma_f32_16x16x32_bf16 v[68:71], v[64:67], v[84:87], v[68:71]
    v_mfma_f32_16x16x32_bf16 v[72:75], v[64:67], v[88:91], v[72:75]
    s_waitcnt vmcnt(0)
    s_nop 5
    v_cvt_pk_bf16_f32 v96, v68, v69
    v_cvt_pk_bf16_f32 v97, v70, v71
    v_lshlrev_b32 v100, 16, v92
    v_and_b32 v101, 0xffff0000, v92
    v_lshlrev_b32 v98, 16, v96
    v_and_b32 v99, 0xffff0000, v96
    v_add_f32 v98, v98, v100
    v_add_f32 v99, v99, v101
    v_cvt_pk_bf16_f32 v96, v98, v99
    v_lshlrev_b32 v100, 16, v93
    v_and_b32 v101, 0xffff0000, v93
    v_lshlrev_b32 v98, 16, v97
    v_and_b32 v99, 0xffff0000, v97
    v_add_f32 v98, v98, v100
    v_add_f32 v99, v99, v101
    v_cvt_pk_bf16_f32 v97, v98, v99
    buffer_store_dwordx2 v[96:97], v8, s[16:19], s50 offen offset:0
    s_add_u32 s52, s50, 14336
    v_cvt_pk_bf16_f32 v96, v72, v73
    v_cvt_pk_bf16_f32 v97, v74, v75
    v_lshlrev_b32 v100, 16, v94
    v_and_b32 v101, 0xffff0000, v94
    v_lshlrev_b32 v98, 16, v96
    v_and_b32 v99, 0xffff0000, v96
    v_add_f32 v98, v98, v100
    v_add_f32 v99, v99, v101
    v_cvt_pk_bf16_f32 v96, v98, v99
    v_lshlrev_b32 v100, 16, v95
    v_and_b32 v101, 0xffff0000, v95
    v_lshlrev_b32 v98, 16, v97
    v_and_b32 v99, 0xffff0000, v97
    v_add_f32 v98, v98, v100
    v_add_f32 v99, v99, v101
    v_cvt_pk_bf16_f32 v97, v98, v99
    buffer_store_dwordx2 v[96:97], v8, s[16:19], s52 offen offset:0
    s_branch L_wo0_kernel_end
L_wo0_kernel_end:
    s_nop 1
L_wo0_kernel_done:
    s_endpgm
.globl w10_kernel
.p2align 8
.type w10_kernel,@function
w10_kernel:
    s_cmp_ge_u32 s2, 256
    s_cbranch_scc1 L_w10_kernel_done
    s_load_dwordx4 s[32:35], s[0:1], 0
    s_load_dwordx4 s[36:39], s[0:1], 64
    s_load_dwordx2 s[40:41], s[0:1], 80
    v_lshrrev_b32 v4, 6, v0
    v_and_b32 v1, 63, v0
    v_readfirstlane_b32 s3, v4
    s_lshr_b32 s7, s2, 3
    s_mul_hi_u32 s4, s7, 0x40000000
    s_mul_i32 s42, s4, 4
    s_sub_u32 s5, s7, s42
    s_and_b32 s7, s2, 7
    s_mul_i32 s7, s7, 8
    s_add_u32 s4, s4, s7
    s_mul_i32 s6, s4, 32
    v_and_b32 v2, 15, v1
    v_lshrrev_b32 v3, 4, v1
    s_mov_b32 s28, 0x3f803f80
    s_mov_b32 s29, 0x3d372713
    s_mov_b32 s30, 0xc0135761
    s_waitcnt lgkmcnt(0)
    s_mov_b32 s8, s40
    s_mov_b32 s9, s41
    s_and_b32 s9, s9, 0xffff
    s_mov_b32 s10, 0x10000000
    s_mov_b32 s11, 0x00020000
    s_add_u32 s12, s40, 0xd46000
    s_addc_u32 s13, s41, 0
    s_and_b32 s13, s13, 0xffff
    s_mov_b32 s14, 0x1c0000
    s_mov_b32 s15, 0x00020000
    s_add_u32 s16, s40, 0x10c6000
    s_addc_u32 s17, s41, 0
    s_and_b32 s17, s17, 0xffff
    s_mov_b32 s18, 0x1c0000
    s_mov_b32 s19, 0x00020000
    s_add_u32 s44, s40, 0x3486000
    s_addc_u32 s45, s41, 0
    s_and_b32 s45, s45, 0xffff
    s_mov_b32 s46, 0x4000
    s_mov_b32 s47, 0x00020000
    v_lshrrev_b32 v86, 4, v1
    v_and_b32 v87, 15, v1
    s_mul_i32 s42, s3, 4
    v_add_u32 v86, s42, v86
    v_mul_u32_u24 v89, 928, v86
    v_lshl_add_u32 v89, v87, 3, v89
    v_add_u32 v89, 256, v89
    v_add_u32 v88, s6, v86
    s_movk_i32 s42, 896
    v_mul_lo_u32 v88, v88, s42
    v_lshl_add_u32 v88, v87, 3, v88
    buffer_load_dwordx2 v[72:73], v88, s[12:15], 0 offen offset:0
    buffer_load_dwordx2 v[74:75], v88, s[12:15], 0 offen offset:128
    buffer_load_dwordx2 v[76:77], v88, s[12:15], 0 offen offset:256
    buffer_load_dwordx2 v[78:79], v88, s[12:15], 0 offen offset:384
    buffer_load_dwordx2 v[80:81], v88, s[12:15], 0 offen offset:512
    buffer_load_dwordx2 v[82:83], v88, s[12:15], 0 offen offset:640
    buffer_load_dwordx2 v[84:85], v88, s[12:15], 0 offen offset:768
    v_lshlrev_b32 v6, 4, v1
    s_mov_b32 s43, 0
    s_cmp_eq_u32 s3, 1
    s_cselect_b32 s43, 1, s43
    s_cmp_eq_u32 s3, 2
    s_cselect_b32 s43, 2, s43
    s_cmp_eq_u32 s3, 3
    s_cselect_b32 s43, 3, s43
    s_cmp_eq_u32 s3, 4
    s_cselect_b32 s43, 4, s43
    s_cmp_eq_u32 s3, 5
    s_cselect_b32 s43, 5, s43
    s_cmp_eq_u32 s3, 6
    s_cselect_b32 s43, 6, s43
    s_mul_i32 s48, s5, 7
    s_add_u32 s48, s48, s43
    s_mul_i32 s48, s48, 14336
    s_add_u32 s48, s48, 0x1b2000
    s_barrier
    buffer_load_dwordx4 v[16:19], v6, s[8:11], s48 offen offset:0
    buffer_load_dwordx4 v[20:23], v6, s[8:11], s48 offen offset:1024
    buffer_load_dwordx4 v[24:27], v6, s[8:11], s48 offen offset:2048
    buffer_load_dwordx4 v[28:31], v6, s[8:11], s48 offen offset:3072
    s_add_u32 s49, s48, 0x1000
    buffer_load_dwordx4 v[32:35], v6, s[8:11], s49 offen offset:0
    s_add_u32 s49, s48, 0x1000
    buffer_load_dwordx4 v[36:39], v6, s[8:11], s49 offen offset:1024
    s_add_u32 s49, s48, 0x1000
    buffer_load_dwordx4 v[40:43], v6, s[8:11], s49 offen offset:2048
    s_add_u32 s49, s48, 0x1000
    buffer_load_dwordx4 v[44:47], v6, s[8:11], s49 offen offset:3072
    s_add_u32 s49, s48, 0x2000
    buffer_load_dwordx4 v[48:51], v6, s[8:11], s49 offen offset:0
    s_add_u32 s49, s48, 0x2000
    buffer_load_dwordx4 v[52:55], v6, s[8:11], s49 offen offset:1024
    s_add_u32 s49, s48, 0x2000
    buffer_load_dwordx4 v[56:59], v6, s[8:11], s49 offen offset:2048
    s_add_u32 s49, s48, 0x2000
    buffer_load_dwordx4 v[60:63], v6, s[8:11], s49 offen offset:3072
    s_add_u32 s49, s48, 0x3000
    buffer_load_dwordx4 v[64:67], v6, s[8:11], s49 offen offset:0
    s_add_u32 s49, s48, 0x3000
    buffer_load_dwordx4 v[68:71], v6, s[8:11], s49 offen offset:1024
    s_waitcnt vmcnt(14)
    v_mov_b32 v94, 0
    v_mov_b32 v95, 0
    v_mov_b32 v98, 0
    v_mov_b32 v99, 0
    v_dot2_f32_bf16 v94, v72, s28, v94
    v_dot2_f32_bf16 v95, v72, v72, v95
    v_dot2_f32_bf16 v98, v73, s28, v98
    v_dot2_f32_bf16 v99, v73, v73, v99
    v_dot2_f32_bf16 v94, v74, s28, v94
    v_dot2_f32_bf16 v95, v74, v74, v95
    v_dot2_f32_bf16 v98, v75, s28, v98
    v_dot2_f32_bf16 v99, v75, v75, v99
    v_dot2_f32_bf16 v94, v76, s28, v94
    v_dot2_f32_bf16 v95, v76, v76, v95
    v_dot2_f32_bf16 v98, v77, s28, v98
    v_dot2_f32_bf16 v99, v77, v77, v99
    v_dot2_f32_bf16 v94, v78, s28, v94
    v_dot2_f32_bf16 v95, v78, v78, v95
    v_dot2_f32_bf16 v98, v79, s28, v98
    v_dot2_f32_bf16 v99, v79, v79, v99
    v_dot2_f32_bf16 v94, v80, s28, v94
    v_dot2_f32_bf16 v95, v80, v80, v95
    v_dot2_f32_bf16 v98, v81, s28, v98
    v_dot2_f32_bf16 v99, v81, v81, v99
    v_dot2_f32_bf16 v94, v82, s28, v94
    v_dot2_f32_bf16 v95, v82, v82, v95
    v_dot2_f32_bf16 v98, v83, s28, v98
    v_dot2_f32_bf16 v99, v83, v83, v99
    v_dot2_f32_bf16 v94, v84, s28, v94
    v_dot2_f32_bf16 v95, v84, v84, v95
    v_dot2_f32_bf16 v98, v85, s28, v98
    v_dot2_f32_bf16 v99, v85, v85, v99
    s_nop 1
    v_add_f32 v94, v94, v98
    v_add_f32 v95, v95, v99
    s_nop 0
    v_add_f32_dpp v96, v94, v94 quad_perm:[1,0,3,2] row_mask:0xf bank_mask:0xf
    s_nop 1
    v_add_f32_dpp v94, v96, v96 quad_perm:[2,3,0,1] row_mask:0xf bank_mask:0xf
    s_nop 1
    v_add_f32_dpp v96, v94, v94 row_half_mirror row_mask:0xf bank_mask:0xf
    s_nop 1
    v_add_f32_dpp v94, v96, v96 row_mirror row_mask:0xf bank_mask:0xf
    v_add_f32_dpp v96, v95, v95 quad_perm:[1,0,3,2] row_mask:0xf bank_mask:0xf
    s_nop 1
    v_add_f32_dpp v95, v96, v96 quad_perm:[2,3,0,1] row_mask:0xf bank_mask:0xf
    s_nop 1
    v_add_f32_dpp v96, v95, v95 row_half_mirror row_mask:0xf bank_mask:0xf
    s_nop 1
    v_add_f32_dpp v95, v96, v96 row_mirror row_mask:0xf bank_mask:0xf
    v_mul_f32 v94, 0x3b124925, v94
    v_mul_f32 v95, 0x3b124925, v95
    v_fma_f32 v95, -v94, v94, v95
    v_max_f32 v95, 0, v95
    v_cvt_pk_bf16_f32 v96, v94, v94
    v_lshlrev_b32 v92, 16, v96
    v_cvt_pk_bf16_f32 v96, v95, v95
    v_lshlrev_b32 v97, 16, v96
    v_add_f32 v97, 0x3727c5ac, v97
    v_cvt_pk_bf16_f32 v96, v97, v97
    v_lshlrev_b32 v97, 16, v96
    v_sqrt_f32 v97, v97
    s_nop 0
    v_cvt_pk_bf16_f32 v96, v97, v97
    v_lshlrev_b32 v97, 16, v96
    v_rcp_f32 v93, v97
    s_nop 0
    v_fma_f32 v96, -v97, v93, 2.0
    v_mul_f32 v93, v93, v96
    v_sub_f32 v98, v94, v92
    v_mul_f32 v98, v98, v93
    v_cvt_pk_bf16_f32 v96, v98, v98
    v_lshlrev_b32 v98, 16, v96
    v_mul_f32 v99, v93, v93
    v_mul_f32 v99, v99, v95
    v_cvt_pk_bf16_f32 v96, v99, v99
    v_lshlrev_b32 v99, 16, v96
    v_add_f32 v99, 0x3727c5ac, v99
    v_cvt_pk_bf16_f32 v96, v99, v99
    v_lshlrev_b32 v99, 16, v96
    v_sqrt_f32 v99, v99
    s_nop 0
    v_cvt_pk_bf16_f32 v96, v99, v99
    v_lshlrev_b32 v99, 16, v96
    v_rcp_f32 v97, v99
    s_nop 0
    v_fma_f32 v96, -v99, v97, 2.0
    v_mul_f32 v97, v97, v96
    v_mul_f32 v90, v93, v97
    v_fma_f32 v91, v92, v93, v98
    v_mul_f32 v91, v91, v97
    v_lshlrev_b32 v100, 3, v86
    ds_write_b64 v100, v[90:91] offset:0
    s_cmp_lg_u32 s5, 0
    s_cbranch_scc1 L_w10_kernel_nost_1
    v_add_u32 v101, s6, v86
    v_lshlrev_b32 v101, 3, v101
    buffer_store_dwordx2 v[92:93], v101, s[44:47], 0 offen
L_w10_kernel_nost_1:
    s_nop 1
    ds_write_b64 v89, v[72:73] offset:0
    ds_write_b64 v89, v[74:75] offset:128
    ds_write_b64 v89, v[76:77] offset:256
    ds_write_b64 v89, v[78:79] offset:384
    ds_write_b64 v89, v[80:81] offset:512
    ds_write_b64 v89, v[82:83] offset:640
    ds_write_b64 v89, v[84:85] offset:768
    s_waitcnt lgkmcnt(0)
    s_barrier
    v_mul_u32_u24 v7, 928, v2
    v_lshl_add_u32 v7, v3, 4, v7
    v_add_u32 v7, 256, v7
    s_movk_i32 s42, 896
    v_mul_lo_u32 v8, v2, s42
    v_lshl_add_u32 v8, v3, 3, v8
    v_mov_b32 v12, s28
    v_mov_b32 v13, s28
    v_mov_b32 v14, s28
    v_mov_b32 v15, s28
    v_lshlrev_b32 v9, 3, v2
    s_cmp_eq_u32 s3, 0
    s_cbranch_scc1 L_w10_kernel_var_2
    s_cmp_eq_u32 s3, 1
    s_cbranch_scc1 L_w10_kernel_var_2
    s_cmp_eq_u32 s3, 2
    s_cbranch_scc1 L_w10_kernel_var_2
    s_cmp_eq_u32 s3, 3
    s_cbranch_scc1 L_w10_kernel_var_2
    s_cmp_eq_u32 s3, 4
    s_cbranch_scc1 L_w10_kernel_var_2
    s_cmp_eq_u32 s3, 5
    s_cbranch_scc1 L_w10_kernel_var_2
    s_cmp_eq_u32 s3, 6
    s_cbranch_scc1 L_w10_kernel_var_2
    s_branch L_w10_kernel_end
L_w10_kernel_var_2:
    s_nop 4
    v_mov_b32 v72, 0
    v_mov_b32 v73, 0
    v_mov_b32 v74, 0
    v_mov_b32 v75, 0
    v_mov_b32 v76, 0
    v_mov_b32 v77, 0
    v_mov_b32 v78, 0
    v_mov_b32 v79, 0
    v_mov_b32 v96, 0
    v_mov_b32 v97, 0
    v_mov_b32 v98, 0
    v_mov_b32 v99, 0
    s_mul_i32 s50, s6, 896
    s_mul_i32 s51, s5, 224
    s_add_u32 s50, s50, s51
    s_lshl_b32 s51, s43, 5
    s_add_u32 s50, s50, s51
    ds_read_b128 v[80:83], v7 offset:0
    ds_read_b128 v[84:87], v7 offset:14848
    ds_read_b128 v[88:91], v7 offset:64
    ds_read_b128 v[92:95], v7 offset:14912
    s_waitcnt lgkmcnt(2)
    s_waitcnt vmcnt(14)
    v_mfma_f32_16x16x32_bf16 v[72:75], v[16:19], v[80:83], v[72:75]
    v_mfma_f32_16x16x32_bf16 v[76:79], v[16:19], v[84:87], v[76:79]
    v_mfma_f32_16x16x32_bf16 v[96:99], v[16:19], v[12:15], v[96:99]
    ds_read_b128 v[80:83], v7 offset:128
    ds_read_b128 v[84:87], v7 offset:14976
    s_waitcnt lgkmcnt(2)
    s_waitcnt vmcnt(13)
    v_mfma_f32_16x16x32_bf16 v[72:75], v[20:23], v[88:91], v[72:75]
    v_mfma_f32_16x16x32_bf16 v[76:79], v[20:23], v[92:95], v[76:79]
    v_mfma_f32_16x16x32_bf16 v[96:99], v[20:23], v[12:15], v[96:99]
    ds_read_b128 v[88:91], v7 offset:192
    ds_read_b128 v[92:95], v7 offset:15040
    s_waitcnt lgkmcnt(2)
    s_waitcnt vmcnt(12)
    v_mfma_f32_16x16x32_bf16 v[72:75], v[24:27], v[80:83], v[72:75]
    v_mfma_f32_16x16x32_bf16 v[76:79], v[24:27], v[84:87], v[76:79]
    v_mfma_f32_16x16x32_bf16 v[96:99], v[24:27], v[12:15], v[96:99]
    ds_read_b128 v[80:83], v7 offset:256
    ds_read_b128 v[84:87], v7 offset:15104
    s_waitcnt lgkmcnt(2)
    s_waitcnt vmcnt(11)
    v_mfma_f32_16x16x32_bf16 v[72:75], v[28:31], v[88:91], v[72:75]
    v_mfma_f32_16x16x32_bf16 v[76:79], v[28:31], v[92:95], v[76:79]
    v_mfma_f32_16x16x32_bf16 v[96:99], v[28:31], v[12:15], v[96:99]
    ds_read_b128 v[88:91], v7 offset:320
    ds_read_b128 v[92:95], v7 offset:15168
    s_waitcnt lgkmcnt(2)
    s_waitcnt vmcnt(10)
    v_mfma_f32_16x16x32_bf16 v[72:75], v[32:35], v[80:83], v[72:75]
    v_mfma_f32_16x16x32_bf16 v[76:79], v[32:35], v[84:87], v[76:79]
    v_mfma_f32_16x16x32_bf16 v[96:99], v[32:35], v[12:15], v[96:99]
    ds_read_b128 v[80:83], v7 offset:384
    ds_read_b128 v[84:87], v7 offset:15232
    s_waitcnt lgkmcnt(2)
    s_waitcnt vmcnt(9)
    v_mfma_f32_16x16x32_bf16 v[72:75], v[36:39], v[88:91], v[72:75]
    v_mfma_f32_16x16x32_bf16 v[76:79], v[36:39], v[92:95], v[76:79]
    v_mfma_f32_16x16x32_bf16 v[96:99], v[36:39], v[12:15], v[96:99]
    ds_read_b128 v[88:91], v7 offset:448
    ds_read_b128 v[92:95], v7 offset:15296
    s_waitcnt lgkmcnt(2)
    s_waitcnt vmcnt(8)
    v_mfma_f32_16x16x32_bf16 v[72:75], v[40:43], v[80:83], v[72:75]
    v_mfma_f32_16x16x32_bf16 v[76:79], v[40:43], v[84:87], v[76:79]
    v_mfma_f32_16x16x32_bf16 v[96:99], v[40:43], v[12:15], v[96:99]
    ds_read_b128 v[80:83], v7 offset:512
    ds_read_b128 v[84:87], v7 offset:15360
    s_waitcnt lgkmcnt(2)
    s_waitcnt vmcnt(7)
    v_mfma_f32_16x16x32_bf16 v[72:75], v[44:47], v[88:91], v[72:75]
    v_mfma_f32_16x16x32_bf16 v[76:79], v[44:47], v[92:95], v[76:79]
    v_mfma_f32_16x16x32_bf16 v[96:99], v[44:47], v[12:15], v[96:99]
    ds_read_b128 v[88:91], v7 offset:576
    ds_read_b128 v[92:95], v7 offset:15424
    s_waitcnt lgkmcnt(2)
    s_waitcnt vmcnt(6)
    v_mfma_f32_16x16x32_bf16 v[72:75], v[48:51], v[80:83], v[72:75]
    v_mfma_f32_16x16x32_bf16 v[76:79], v[48:51], v[84:87], v[76:79]
    v_mfma_f32_16x16x32_bf16 v[96:99], v[48:51], v[12:15], v[96:99]
    ds_read_b128 v[80:83], v7 offset:640
    ds_read_b128 v[84:87], v7 offset:15488
    s_waitcnt lgkmcnt(2)
    s_waitcnt vmcnt(5)
    v_mfma_f32_16x16x32_bf16 v[72:75], v[52:55], v[88:91], v[72:75]
    v_mfma_f32_16x16x32_bf16 v[76:79], v[52:55], v[92:95], v[76:79]
    v_mfma_f32_16x16x32_bf16 v[96:99], v[52:55], v[12:15], v[96:99]
    ds_read_b128 v[88:91], v7 offset:704
    ds_read_b128 v[92:95], v7 offset:15552
    s_waitcnt lgkmcnt(2)
    s_waitcnt vmcnt(4)
    v_mfma_f32_16x16x32_bf16 v[72:75], v[56:59], v[80:83], v[72:75]
    v_mfma_f32_16x16x32_bf16 v[76:79], v[56:59], v[84:87], v[76:79]
    v_mfma_f32_16x16x32_bf16 v[96:99], v[56:59], v[12:15], v[96:99]
    ds_read_b128 v[80:83], v7 offset:768
    ds_read_b128 v[84:87], v7 offset:15616
    s_waitcnt lgkmcnt(2)
    s_waitcnt vmcnt(3)
    v_mfma_f32_16x16x32_bf16 v[72:75], v[60:63], v[88:91], v[72:75]
    v_mfma_f32_16x16x32_bf16 v[76:79], v[60:63], v[92:95], v[76:79]
    v_mfma_f32_16x16x32_bf16 v[96:99], v[60:63], v[12:15], v[96:99]
    ds_read_b128 v[88:91], v7 offset:832
    ds_read_b128 v[92:95], v7 offset:15680
    s_waitcnt lgkmcnt(2)
    s_waitcnt vmcnt(2)
    v_mfma_f32_16x16x32_bf16 v[72:75], v[64:67], v[80:83], v[72:75]
    v_mfma_f32_16x16x32_bf16 v[76:79], v[64:67], v[84:87], v[76:79]
    v_mfma_f32_16x16x32_bf16 v[96:99], v[64:67], v[12:15], v[96:99]
    s_waitcnt lgkmcnt(0)
    s_waitcnt vmcnt(1)
    v_mfma_f32_16x16x32_bf16 v[72:75], v[68:71], v[88:91], v[72:75]
    v_mfma_f32_16x16x32_bf16 v[76:79], v[68:71], v[92:95], v[76:79]
    v_mfma_f32_16x16x32_bf16 v[96:99], v[68:71], v[12:15], v[96:99]
    ds_read_b64 v[108:109], v9 offset:0
    ds_read_b64 v[110:111], v9 offset:128
    s_waitcnt lgkmcnt(0)
    s_nop 4
    v_mul_f32 v102, v96, v109
    v_fma_f32 v72, v72, v108, -v102
    v_mul_f32 v102, v97, v109
    v_fma_f32 v73, v73, v108, -v102
    v_mul_f32 v102, v98, v109
    v_fma_f32 v74, v74, v108, -v102
    v_mul_f32 v102, v99, v109
    v_fma_f32 v75, v75, v108, -v102
    v_cvt_pk_bf16_f32 v100, v72, v73
    v_cvt_pk_bf16_f32 v101, v74, v75
    v_lshlrev_b32 v102, 16, v100
    v_and_b32 v103, 0xffff0000, v100
    v_mul_f32 v104, v102, v102
    v_mul_f32 v105, v103, v103
    v_fma_f32 v104, v104, s29, 1.0
    v_fma_f32 v105, v105, s29, 1.0
    v_mul_f32 v104, v104, v102
    v_mul_f32 v105, v105, v103
    v_mul_f32 v104, s30, v104
    v_mul_f32 v105, s30, v105
    v_exp_f32 v104, v104
    v_exp_f32 v105, v105
    v_add_f32 v104, 1.0, v104
    v_add_f32 v105, 1.0, v105
    v_rcp_f32 v104, v104
    v_rcp_f32 v105, v105
    v_mul_f32 v102, v102, v104
    v_mul_f32 v103, v103, v105
    v_cvt_pk_bf16_f32 v100, v102, v103
    v_lshlrev_b32 v102, 16, v101
    v_and_b32 v103, 0xffff0000, v101
    v_mul_f32 v104, v102, v102
    v_mul_f32 v105, v103, v103
    v_fma_f32 v104, v104, s29, 1.0
    v_fma_f32 v105, v105, s29, 1.0
    v_mul_f32 v104, v104, v102
    v_mul_f32 v105, v105, v103
    v_mul_f32 v104, s30, v104
    v_mul_f32 v105, s30, v105
    v_exp_f32 v104, v104
    v_exp_f32 v105, v105
    v_add_f32 v104, 1.0, v104
    v_add_f32 v105, 1.0, v105
    v_rcp_f32 v104, v104
    v_rcp_f32 v105, v105
    v_mul_f32 v102, v102, v104
    v_mul_f32 v103, v103, v105
    v_cvt_pk_bf16_f32 v101, v102, v103
    buffer_store_dwordx2 v[100:101], v8, s[16:19], s50 offen offset:0
    s_add_u32 s52, s50, 14336
    v_mul_f32 v102, v96, v111
    v_fma_f32 v76, v76, v110, -v102
    v_mul_f32 v102, v97, v111
    v_fma_f32 v77, v77, v110, -v102
    v_mul_f32 v102, v98, v111
    v_fma_f32 v78, v78, v110, -v102
    v_mul_f32 v102, v99, v111
    v_fma_f32 v79, v79, v110, -v102
    v_cvt_pk_bf16_f32 v100, v76, v77
    v_cvt_pk_bf16_f32 v101, v78, v79
    v_lshlrev_b32 v102, 16, v100
    v_and_b32 v103, 0xffff0000, v100
    v_mul_f32 v104, v102, v102
    v_mul_f32 v105, v103, v103
    v_fma_f32 v104, v104, s29, 1.0
    v_fma_f32 v105, v105, s29, 1.0
    v_mul_f32 v104, v104, v102
    v_mul_f32 v105, v105, v103
    v_mul_f32 v104, s30, v104
    v_mul_f32 v105, s30, v105
    v_exp_f32 v104, v104
    v_exp_f32 v105, v105
    v_add_f32 v104, 1.0, v104
    v_add_f32 v105, 1.0, v105
    v_rcp_f32 v104, v104
    v_rcp_f32 v105, v105
    v_mul_f32 v102, v102, v104
    v_mul_f32 v103, v103, v105
    v_cvt_pk_bf16_f32 v100, v102, v103
    v_lshlrev_b32 v102, 16, v101
    v_and_b32 v103, 0xffff0000, v101
    v_mul_f32 v104, v102, v102
    v_mul_f32 v105, v103, v103
    v_fma_f32 v104, v104, s29, 1.0
    v_fma_f32 v105, v105, s29, 1.0
    v_mul_f32 v104, v104, v102
    v_mul_f32 v105, v105, v103
    v_mul_f32 v104, s30, v104
    v_mul_f32 v105, s30, v105
    v_exp_f32 v104, v104
    v_exp_f32 v105, v105
    v_add_f32 v104, 1.0, v104
    v_add_f32 v105, 1.0, v105
    v_rcp_f32 v104, v104
    v_rcp_f32 v105, v105
    v_mul_f32 v102, v102, v104
    v_mul_f32 v103, v103, v105
    v_cvt_pk_bf16_f32 v101, v102, v103
    buffer_store_dwordx2 v[100:101], v8, s[16:19], s52 offen offset:0
    s_branch L_w10_kernel_end
L_w10_kernel_end:
    s_nop 1
L_w10_kernel_done:
    s_endpgm
.globl w20_kernel
.p2align 8
.type w20_kernel,@function
w20_kernel:
    s_cmp_ge_u32 s2, 256
    s_cbranch_scc1 L_w20_kernel_done
    s_load_dwordx4 s[32:35], s[0:1], 0
    s_load_dwordx4 s[36:39], s[0:1], 64
    s_load_dwordx2 s[40:41], s[0:1], 80
    v_lshrrev_b32 v4, 6, v0
    v_and_b32 v1, 63, v0
    v_readfirstlane_b32 s3, v4
    s_lshr_b32 s7, s2, 3
    s_mul_hi_u32 s4, s7, 0x40000000
    s_mul_i32 s42, s4, 4
    s_sub_u32 s5, s7, s42
    s_and_b32 s7, s2, 7
    s_mul_i32 s7, s7, 8
    s_add_u32 s4, s4, s7
    s_mul_i32 s6, s4, 32
    v_and_b32 v2, 15, v1
    v_lshrrev_b32 v3, 4, v1
    s_mov_b32 s28, 0x3f803f80
    s_mov_b32 s29, 0x3d372713
    s_mov_b32 s30, 0xc0135761
    s_waitcnt lgkmcnt(0)
    s_mov_b32 s8, s40
    s_mov_b32 s9, s41
    s_and_b32 s9, s9, 0xffff
    s_mov_b32 s10, 0x10000000
    s_mov_b32 s11, 0x00020000
    s_add_u32 s12, s40, 0x10c6000
    s_addc_u32 s13, s41, 0
    s_and_b32 s13, s13, 0xffff
    s_mov_b32 s14, 0x1c0000
    s_mov_b32 s15, 0x00020000
    s_add_u32 s16, s40, 0x1286000
    s_addc_u32 s17, s41, 0
    s_and_b32 s17, s17, 0xffff
    s_mov_b32 s18, 0x1c0000
    s_mov_b32 s19, 0x00020000
    s_add_u32 s20, s40, 0xd46000
    s_addc_u32 s21, s41, 0
    s_and_b32 s21, s21, 0xffff
    s_mov_b32 s22, 0x1c0000
    s_mov_b32 s23, 0x00020000
    s_add_u32 s44, s40, 0x3486000
    s_addc_u32 s45, s41, 0
    s_and_b32 s45, s45, 0xffff
    s_mov_b32 s46, 0x4000
    s_mov_b32 s47, 0x00020000
    v_lshrrev_b32 v82, 4, v1
    v_and_b32 v83, 15, v1
    s_mul_i32 s42, s3, 4
    v_add_u32 v82, s42, v82
    v_mul_u32_u24 v85, 928, v82
    v_lshl_add_u32 v85, v83, 3, v85
    v_add_u32 v85, 256, v85
    v_add_u32 v84, s6, v82
    s_movk_i32 s42, 896
    v_mul_lo_u32 v84, v84, s42
    v_lshl_add_u32 v84, v83, 3, v84
    v_add_u32 v86, 0xfffffc80, v84
    buffer_load_dwordx2 v[68:69], v86, s[12:15], 0 offen
    v_cmp_gt_u32 vcc, 12, v83
    v_mov_b32 v4, 0x400
    v_mov_b32 v5, 0xfffffd00
    v_cndmask_b32 v86, v4, v5, vcc
    v_add_u32 v86, v86, v84
    buffer_load_dwordx2 v[70:71], v86, s[12:15], 0 offen
    v_add_u32 v86, 0x480, v84
    buffer_load_dwordx2 v[72:73], v86, s[12:15], 0 offen
    v_cmp_gt_u32 vcc, 8, v83
    v_mov_b32 v4, 0xfffffa80
    v_mov_b32 v5, 0x500
    v_cndmask_b32 v86, v4, v5, vcc
    v_add_u32 v86, v86, v84
    buffer_load_dwordx2 v[74:75], v86, s[12:15], 0 offen
    v_add_u32 v86, 0xfffffb00, v84
    buffer_load_dwordx2 v[76:77], v86, s[12:15], 0 offen
    v_cmp_gt_u32 vcc, 4, v83
    v_mov_b32 v4, 0x980
    v_mov_b32 v5, 0xfffffb80
    v_cndmask_b32 v86, v4, v5, vcc
    v_add_u32 v86, v86, v84
    buffer_load_dwordx2 v[78:79], v86, s[12:15], 0 offen
    v_add_u32 v86, 0xa00, v84
    buffer_load_dwordx2 v[80:81], v86, s[12:15], 0 offen
    v_lshlrev_b32 v6, 4, v1
    s_mov_b32 s43, 0
    s_cmp_eq_u32 s3, 1
    s_cselect_b32 s43, 1, s43
    s_cmp_eq_u32 s3, 2
    s_cselect_b32 s43, 2, s43
    s_cmp_eq_u32 s3, 3
    s_cselect_b32 s43, 3, s43
    s_cmp_eq_u32 s3, 4
    s_cselect_b32 s43, 4, s43
    s_cmp_eq_u32 s3, 5
    s_cselect_b32 s43, 5, s43
    s_cmp_eq_u32 s3, 6
    s_cselect_b32 s43, 6, s43
    s_mul_i32 s48, s5, 7
    s_add_u32 s48, s48, s43
    s_mul_i32 s48, s48, 14336
    s_add_u32 s48, s48, 0x214000
    s_barrier
    buffer_load_dwordx4 v[12:15], v6, s[8:11], s48 offen offset:0
    buffer_load_dwordx4 v[16:19], v6, s[8:11], s48 offen offset:1024
    buffer_load_dwordx4 v[20:23], v6, s[8:11], s48 offen offset:2048
    buffer_load_dwordx4 v[24:27], v6, s[8:11], s48 offen offset:3072
    s_add_u32 s49, s48, 0x1000
    buffer_load_dwordx4 v[28:31], v6, s[8:11], s49 offen offset:0
    s_add_u32 s49, s48, 0x1000
    buffer_load_dwordx4 v[32:35], v6, s[8:11], s49 offen offset:1024
    s_add_u32 s49, s48, 0x1000
    buffer_load_dwordx4 v[36:39], v6, s[8:11], s49 offen offset:2048
    s_add_u32 s49, s48, 0x1000
    buffer_load_dwordx4 v[40:43], v6, s[8:11], s49 offen offset:3072
    s_add_u32 s49, s48, 0x2000
    buffer_load_dwordx4 v[44:47], v6, s[8:11], s49 offen offset:0
    s_add_u32 s49, s48, 0x2000
    buffer_load_dwordx4 v[48:51], v6, s[8:11], s49 offen offset:1024
    s_add_u32 s49, s48, 0x2000
    buffer_load_dwordx4 v[52:55], v6, s[8:11], s49 offen offset:2048
    s_add_u32 s49, s48, 0x2000
    buffer_load_dwordx4 v[56:59], v6, s[8:11], s49 offen offset:3072
    s_add_u32 s49, s48, 0x3000
    buffer_load_dwordx4 v[60:63], v6, s[8:11], s49 offen offset:0
    s_add_u32 s49, s48, 0x3000
    buffer_load_dwordx4 v[64:67], v6, s[8:11], s49 offen offset:1024
    s_waitcnt vmcnt(14)
    ds_write_b64 v85, v[68:69] offset:0
    ds_write_b64 v85, v[70:71] offset:128
    ds_write_b64 v85, v[72:73] offset:256
    ds_write_b64 v85, v[74:75] offset:384
    ds_write_b64 v85, v[76:77] offset:512
    ds_write_b64 v85, v[78:79] offset:640
    ds_write_b64 v85, v[80:81] offset:768
    s_waitcnt lgkmcnt(0)
    s_barrier
    v_mul_u32_u24 v7, 928, v2
    v_lshl_add_u32 v7, v3, 4, v7
    v_add_u32 v7, 256, v7
    s_movk_i32 s42, 896
    v_mul_lo_u32 v8, v2, s42
    v_lshl_add_u32 v8, v3, 3, v8
    v_lshlrev_b32 v9, 3, v2
    s_cmp_eq_u32 s3, 0
    s_cbranch_scc1 L_w20_kernel_var_1
    s_cmp_eq_u32 s3, 1
    s_cbranch_scc1 L_w20_kernel_var_1
    s_cmp_eq_u32 s3, 2
    s_cbranch_scc1 L_w20_kernel_var_1
    s_cmp_eq_u32 s3, 3
    s_cbranch_scc1 L_w20_kernel_var_1
    s_cmp_eq_u32 s3, 4
    s_cbranch_scc1 L_w20_kernel_var_1
    s_cmp_eq_u32 s3, 5
    s_cbranch_scc1 L_w20_kernel_var_1
    s_cmp_eq_u32 s3, 6
    s_cbranch_scc1 L_w20_kernel_var_1
    s_branch L_w20_kernel_end
L_w20_kernel_var_1:
    s_nop 4
    v_mov_b32 v68, 0
    v_mov_b32 v69, 0
    v_mov_b32 v70, 0
    v_mov_b32 v71, 0
    v_mov_b32 v72, 0
    v_mov_b32 v73, 0
    v_mov_b32 v74, 0
    v_mov_b32 v75, 0
    s_mul_i32 s50, s6, 896
    s_mul_i32 s51, s5, 224
    s_add_u32 s50, s50, s51
    s_lshl_b32 s51, s43, 5
    s_add_u32 s50, s50, s51
    buffer_load_dwordx2 v[92:93], v8, s[20:23], s50 offen offset:0
    s_add_u32 s52, s50, 14336
    buffer_load_dwordx2 v[94:95], v8, s[20:23], s52 offen offset:0
    v_add_u32 v100, s6, v2
    v_lshlrev_b32 v100, 3, v100
    buffer_load_dwordx2 v[96:97], v100, s[44:47], 0 offen offset:0
    buffer_load_dwordx2 v[98:99], v100, s[44:47], 0 offen offset:128
    ds_read_b128 v[76:79], v7 offset:0
    ds_read_b128 v[80:83], v7 offset:14848
    ds_read_b128 v[84:87], v7 offset:64
    ds_read_b128 v[88:91], v7 offset:14912
    s_waitcnt lgkmcnt(2)
    s_waitcnt vmcnt(17)
    v_mfma_f32_16x16x32_bf16 v[68:71], v[12:15], v[76:79], v[68:71]
    v_mfma_f32_16x16x32_bf16 v[72:75], v[12:15], v[80:83], v[72:75]
    ds_read_b128 v[76:79], v7 offset:128
    ds_read_b128 v[80:83], v7 offset:14976
    s_waitcnt lgkmcnt(2)
    s_waitcnt vmcnt(16)
    v_mfma_f32_16x16x32_bf16 v[68:71], v[16:19], v[84:87], v[68:71]
    v_mfma_f32_16x16x32_bf16 v[72:75], v[16:19], v[88:91], v[72:75]
    ds_read_b128 v[84:87], v7 offset:192
    ds_read_b128 v[88:91], v7 offset:15040
    s_waitcnt lgkmcnt(2)
    s_waitcnt vmcnt(15)
    v_mfma_f32_16x16x32_bf16 v[68:71], v[20:23], v[76:79], v[68:71]
    v_mfma_f32_16x16x32_bf16 v[72:75], v[20:23], v[80:83], v[72:75]
    ds_read_b128 v[76:79], v7 offset:256
    ds_read_b128 v[80:83], v7 offset:15104
    s_waitcnt lgkmcnt(2)
    s_waitcnt vmcnt(14)
    v_mfma_f32_16x16x32_bf16 v[68:71], v[24:27], v[84:87], v[68:71]
    v_mfma_f32_16x16x32_bf16 v[72:75], v[24:27], v[88:91], v[72:75]
    ds_read_b128 v[84:87], v7 offset:320
    ds_read_b128 v[88:91], v7 offset:15168
    s_waitcnt lgkmcnt(2)
    s_waitcnt vmcnt(13)
    v_mfma_f32_16x16x32_bf16 v[68:71], v[28:31], v[76:79], v[68:71]
    v_mfma_f32_16x16x32_bf16 v[72:75], v[28:31], v[80:83], v[72:75]
    ds_read_b128 v[76:79], v7 offset:384
    ds_read_b128 v[80:83], v7 offset:15232
    s_waitcnt lgkmcnt(2)
    s_waitcnt vmcnt(12)
    v_mfma_f32_16x16x32_bf16 v[68:71], v[32:35], v[84:87], v[68:71]
    v_mfma_f32_16x16x32_bf16 v[72:75], v[32:35], v[88:91], v[72:75]
    ds_read_b128 v[84:87], v7 offset:448
    ds_read_b128 v[88:91], v7 offset:15296
    s_waitcnt lgkmcnt(2)
    s_waitcnt vmcnt(11)
    v_mfma_f32_16x16x32_bf16 v[68:71], v[36:39], v[76:79], v[68:71]
    v_mfma_f32_16x16x32_bf16 v[72:75], v[36:39], v[80:83], v[72:75]
    ds_read_b128 v[76:79], v7 offset:512
    ds_read_b128 v[80:83], v7 offset:15360
    s_waitcnt lgkmcnt(2)
    s_waitcnt vmcnt(10)
    v_mfma_f32_16x16x32_bf16 v[68:71], v[40:43], v[84:87], v[68:71]
    v_mfma_f32_16x16x32_bf16 v[72:75], v[40:43], v[88:91], v[72:75]
    ds_read_b128 v[84:87], v7 offset:576
    ds_read_b128 v[88:91], v7 offset:15424
    s_waitcnt lgkmcnt(2)
    s_waitcnt vmcnt(9)
    v_mfma_f32_16x16x32_bf16 v[68:71], v[44:47], v[76:79], v[68:71]
    v_mfma_f32_16x16x32_bf16 v[72:75], v[44:47], v[80:83], v[72:75]
    ds_read_b128 v[76:79], v7 offset:640
    ds_read_b128 v[80:83], v7 offset:15488
    s_waitcnt lgkmcnt(2)
    s_waitcnt vmcnt(8)
    v_mfma_f32_16x16x32_bf16 v[68:71], v[48:51], v[84:87], v[68:71]
    v_mfma_f32_16x16x32_bf16 v[72:75], v[48:51], v[88:91], v[72:75]
    ds_read_b128 v[84:87], v7 offset:704
    ds_read_b128 v[88:91], v7 offset:15552
    s_waitcnt lgkmcnt(2)
    s_waitcnt vmcnt(7)
    v_mfma_f32_16x16x32_bf16 v[68:71], v[52:55], v[76:79], v[68:71]
    v_mfma_f32_16x16x32_bf16 v[72:75], v[52:55], v[80:83], v[72:75]
    ds_read_b128 v[76:79], v7 offset:768
    ds_read_b128 v[80:83], v7 offset:15616
    s_waitcnt lgkmcnt(2)
    s_waitcnt vmcnt(6)
    v_mfma_f32_16x16x32_bf16 v[68:71], v[56:59], v[84:87], v[68:71]
    v_mfma_f32_16x16x32_bf16 v[72:75], v[56:59], v[88:91], v[72:75]
    ds_read_b128 v[84:87], v7 offset:832
    ds_read_b128 v[88:91], v7 offset:15680
    s_waitcnt lgkmcnt(2)
    s_waitcnt vmcnt(5)
    v_mfma_f32_16x16x32_bf16 v[68:71], v[60:63], v[76:79], v[68:71]
    v_mfma_f32_16x16x32_bf16 v[72:75], v[60:63], v[80:83], v[72:75]
    s_waitcnt lgkmcnt(0)
    s_waitcnt vmcnt(4)
    v_mfma_f32_16x16x32_bf16 v[68:71], v[64:67], v[84:87], v[68:71]
    v_mfma_f32_16x16x32_bf16 v[72:75], v[64:67], v[88:91], v[72:75]
    s_waitcnt vmcnt(0)
    s_nop 5
    v_cvt_pk_bf16_f32 v102, v68, v69
    v_cvt_pk_bf16_f32 v103, v70, v71
    v_lshlrev_b32 v106, 16, v92
    v_and_b32 v107, 0xffff0000, v92
    v_sub_f32 v106, v106, v96
    v_sub_f32 v107, v107, v96
    v_cvt_pk_bf16_f32 v104, v106, v107
    v_lshlrev_b32 v106, 16, v104
    v_and_b32 v107, 0xffff0000, v104
    v_mul_f32 v106, v106, v97
    v_mul_f32 v107, v107, v97
    v_cvt_pk_bf16_f32 v104, v106, v107
    v_lshlrev_b32 v106, 16, v104
    v_and_b32 v107, 0xffff0000, v104
    v_lshlrev_b32 v104, 16, v102
    v_and_b32 v105, 0xffff0000, v102
    v_add_f32 v104, v104, v106
    v_add_f32 v105, v105, v107
    v_cvt_pk_bf16_f32 v102, v104, v105
    v_lshlrev_b32 v106, 16, v93
    v_and_b32 v107, 0xffff0000, v93
    v_sub_f32 v106, v106, v96
    v_sub_f32 v107, v107, v96
    v_cvt_pk_bf16_f32 v104, v106, v107
    v_lshlrev_b32 v106, 16, v104
    v_and_b32 v107, 0xffff0000, v104
    v_mul_f32 v106, v106, v97
    v_mul_f32 v107, v107, v97
    v_cvt_pk_bf16_f32 v104, v106, v107
    v_lshlrev_b32 v106, 16, v104
    v_and_b32 v107, 0xffff0000, v104
    v_lshlrev_b32 v104, 16, v103
    v_and_b32 v105, 0xffff0000, v103
    v_add_f32 v104, v104, v106
    v_add_f32 v105, v105, v107
    v_cvt_pk_bf16_f32 v103, v104, v105
    buffer_store_dwordx2 v[102:103], v8, s[16:19], s50 offen offset:0
    s_add_u32 s52, s50, 14336
    v_cvt_pk_bf16_f32 v102, v72, v73
    v_cvt_pk_bf16_f32 v103, v74, v75
    v_lshlrev_b32 v106, 16, v94
    v_and_b32 v107, 0xffff0000, v94
    v_sub_f32 v106, v106, v98
    v_sub_f32 v107, v107, v98
    v_cvt_pk_bf16_f32 v104, v106, v107
    v_lshlrev_b32 v106, 16, v104
    v_and_b32 v107, 0xffff0000, v104
    v_mul_f32 v106, v106, v99
    v_mul_f32 v107, v107, v99
    v_cvt_pk_bf16_f32 v104, v106, v107
    v_lshlrev_b32 v106, 16, v104
    v_and_b32 v107, 0xffff0000, v104
    v_lshlrev_b32 v104, 16, v102
    v_and_b32 v105, 0xffff0000, v102
    v_add_f32 v104, v104, v106
    v_add_f32 v105, v105, v107
    v_cvt_pk_bf16_f32 v102, v104, v105
    v_lshlrev_b32 v106, 16, v95
    v_and_b32 v107, 0xffff0000, v95
    v_sub_f32 v106, v106, v98
    v_sub_f32 v107, v107, v98
    v_cvt_pk_bf16_f32 v104, v106, v107
    v_lshlrev_b32 v106, 16, v104
    v_and_b32 v107, 0xffff0000, v104
    v_mul_f32 v106, v106, v99
    v_mul_f32 v107, v107, v99
    v_cvt_pk_bf16_f32 v104, v106, v107
    v_lshlrev_b32 v106, 16, v104
    v_and_b32 v107, 0xffff0000, v104
    v_lshlrev_b32 v104, 16, v103
    v_and_b32 v105, 0xffff0000, v103
    v_add_f32 v104, v104, v106
    v_add_f32 v105, v105, v107
    v_cvt_pk_bf16_f32 v103, v104, v105
    buffer_store_dwordx2 v[102:103], v8, s[16:19], s52 offen offset:0
    s_branch L_w20_kernel_end
L_w20_kernel_end:
    s_nop 1
L_w20_kernel_done:
    s_endpgm
.globl w30_kernel
.p2align 8
.type w30_kernel,@function
w30_kernel:
    s_cmp_ge_u32 s2, 224
    s_cbranch_scc1 L_w30_kernel_done
    s_load_dwordx4 s[32:35], s[0:1], 0
    s_load_dwordx4 s[36:39], s[0:1], 64
    s_load_dwordx2 s[40:41], s[0:1], 80
    v_lshrrev_b32 v4, 6, v0
    v_and_b32 v1, 63, v0
    v_readfirstlane_b32 s3, v4
    s_lshr_b32 s7, s2, 3
    s_mul_hi_u32 s4, s7, 0x24924925
    s_mul_i32 s42, s4, 7
    s_sub_u32 s5, s7, s42
    s_and_b32 s7, s2, 7
    s_mul_i32 s7, s7, 4
    s_add_u32 s4, s4, s7
    s_mul_i32 s6, s4, 64
    v_and_b32 v2, 15, v1
    v_lshrrev_b32 v3, 4, v1
    s_mov_b32 s28, 0x3f803f80
    s_mov_b32 s29, 0x3d372713
    s_mov_b32 s30, 0xc0135761
    s_waitcnt lgkmcnt(0)
    s_mov_b32 s8, s40
    s_mov_b32 s9, s41
    s_and_b32 s9, s9, 0xffff
    s_mov_b32 s10, 0x10000000
    s_mov_b32 s11, 0x00020000
    s_add_u32 s12, s40, 0x1286000
    s_addc_u32 s13, s41, 0
    s_and_b32 s13, s13, 0xffff
    s_mov_b32 s14, 0x1c0000
    s_mov_b32 s15, 0x00020000
    s_add_u32 s16, s40, 0x1606000
    s_addc_u32 s17, s41, 0
    s_and_b32 s17, s17, 0xffff
    s_mov_b32 s18, 0x700000
    s_mov_b32 s19, 0x00020000
    v_lshrrev_b32 v156, 3, v1
    v_and_b32 v157, 7, v1
    s_mul_i32 s42, s3, 8
    v_add_u32 v156, s42, v156
    v_mul_u32_u24 v159, 928, v156
    v_lshl_add_u32 v159, v157, 4, v159
    v_add_u32 v159, 512, v159
    v_add_u32 v158, s6, v156
    s_movk_i32 s42, 896
    v_mul_lo_u32 v158, v158, s42
    v_lshl_add_u32 v158, v157, 4, v158
    buffer_load_dwordx4 v[128:131], v158, s[12:15], 0 offen offset:0
    buffer_load_dwordx4 v[132:135], v158, s[12:15], 0 offen offset:128
    buffer_load_dwordx4 v[136:139], v158, s[12:15], 0 offen offset:256
    buffer_load_dwordx4 v[140:143], v158, s[12:15], 0 offen offset:384
    buffer_load_dwordx4 v[144:147], v158, s[12:15], 0 offen offset:512
    buffer_load_dwordx4 v[148:151], v158, s[12:15], 0 offen offset:640
    buffer_load_dwordx4 v[152:155], v158, s[12:15], 0 offen offset:768
    v_lshlrev_b32 v6, 4, v1
    s_mov_b32 s43, 0
    s_cmp_eq_u32 s3, 1
    s_cselect_b32 s43, 2, s43
    s_cmp_eq_u32 s3, 2
    s_cselect_b32 s43, 4, s43
    s_cmp_eq_u32 s3, 3
    s_cselect_b32 s43, 6, s43
    s_cmp_eq_u32 s3, 4
    s_cselect_b32 s43, 8, s43
    s_cmp_eq_u32 s3, 5
    s_cselect_b32 s43, 10, s43
    s_cmp_eq_u32 s3, 6
    s_cselect_b32 s43, 12, s43
    s_cmp_eq_u32 s3, 7
    s_cselect_b32 s43, 14, s43
    s_mul_i32 s48, s5, 16
    s_add_u32 s48, s48, s43
    s_mul_i32 s48, s48, 14336
    s_add_u32 s48, s48, 0x276000
    s_barrier
    buffer_load_dwordx4 v[16:19], v6, s[8:11], s48 offen offset:0
    s_add_u32 s49, s48, 0x3000
    buffer_load_dwordx4 v[72:75], v6, s[8:11], s49 offen offset:2048
    buffer_load_dwordx4 v[20:23], v6, s[8:11], s48 offen offset:1024
    s_add_u32 s49, s48, 0x3000
    buffer_load_dwordx4 v[76:79], v6, s[8:11], s49 offen offset:3072
    buffer_load_dwordx4 v[24:27], v6, s[8:11], s48 offen offset:2048
    s_add_u32 s49, s48, 0x4000
    buffer_load_dwordx4 v[80:83], v6, s[8:11], s49 offen offset:0
    buffer_load_dwordx4 v[28:31], v6, s[8:11], s48 offen offset:3072
    s_add_u32 s49, s48, 0x4000
    buffer_load_dwordx4 v[84:87], v6, s[8:11], s49 offen offset:1024
    s_add_u32 s49, s48, 0x1000
    buffer_load_dwordx4 v[32:35], v6, s[8:11], s49 offen offset:0
    s_add_u32 s49, s48, 0x4000
    buffer_load_dwordx4 v[88:91], v6, s[8:11], s49 offen offset:2048
    s_add_u32 s49, s48, 0x1000
    buffer_load_dwordx4 v[36:39], v6, s[8:11], s49 offen offset:1024
    s_add_u32 s49, s48, 0x4000
    buffer_load_dwordx4 v[92:95], v6, s[8:11], s49 offen offset:3072
    s_add_u32 s49, s48, 0x1000
    buffer_load_dwordx4 v[40:43], v6, s[8:11], s49 offen offset:2048
    s_add_u32 s49, s48, 0x5000
    buffer_load_dwordx4 v[96:99], v6, s[8:11], s49 offen offset:0
    s_add_u32 s49, s48, 0x1000
    buffer_load_dwordx4 v[44:47], v6, s[8:11], s49 offen offset:3072
    s_add_u32 s49, s48, 0x5000
    buffer_load_dwordx4 v[100:103], v6, s[8:11], s49 offen offset:1024
    s_add_u32 s49, s48, 0x2000
    buffer_load_dwordx4 v[48:51], v6, s[8:11], s49 offen offset:0
    s_add_u32 s49, s48, 0x5000
    buffer_load_dwordx4 v[104:107], v6, s[8:11], s49 offen offset:2048
    s_add_u32 s49, s48, 0x2000
    buffer_load_dwordx4 v[52:55], v6, s[8:11], s49 offen offset:1024
    s_add_u32 s49, s48, 0x5000
    buffer_load_dwordx4 v[108:111], v6, s[8:11], s49 offen offset:3072
    s_add_u32 s49, s48, 0x2000
    buffer_load_dwordx4 v[56:59], v6, s[8:11], s49 offen offset:2048
    s_add_u32 s49, s48, 0x6000
    buffer_load_dwordx4 v[112:115], v6, s[8:11], s49 offen offset:0
    s_add_u32 s49, s48, 0x2000
    buffer_load_dwordx4 v[60:63], v6, s[8:11], s49 offen offset:3072
    s_add_u32 s49, s48, 0x6000
    buffer_load_dwordx4 v[116:119], v6, s[8:11], s49 offen offset:1024
    s_add_u32 s49, s48, 0x3000
    buffer_load_dwordx4 v[64:67], v6, s[8:11], s49 offen offset:0
    s_add_u32 s49, s48, 0x6000
    buffer_load_dwordx4 v[120:123], v6, s[8:11], s49 offen offset:2048
    s_add_u32 s49, s48, 0x3000
    buffer_load_dwordx4 v[68:71], v6, s[8:11], s49 offen offset:1024
    s_add_u32 s49, s48, 0x6000
    buffer_load_dwordx4 v[124:127], v6, s[8:11], s49 offen offset:3072
    s_waitcnt vmcnt(28)
    v_mov_b32 v164, 0
    v_mov_b32 v165, 0
    v_mov_b32 v168, 0
    v_mov_b32 v169, 0
    v_dot2_f32_bf16 v164, v128, s28, v164
    v_dot2_f32_bf16 v165, v128, v128, v165
    v_dot2_f32_bf16 v168, v129, s28, v168
    v_dot2_f32_bf16 v169, v129, v129, v169
    v_dot2_f32_bf16 v164, v130, s28, v164
    v_dot2_f32_bf16 v165, v130, v130, v165
    v_dot2_f32_bf16 v168, v131, s28, v168
    v_dot2_f32_bf16 v169, v131, v131, v169
    v_dot2_f32_bf16 v164, v132, s28, v164
    v_dot2_f32_bf16 v165, v132, v132, v165
    v_dot2_f32_bf16 v168, v133, s28, v168
    v_dot2_f32_bf16 v169, v133, v133, v169
    v_dot2_f32_bf16 v164, v134, s28, v164
    v_dot2_f32_bf16 v165, v134, v134, v165
    v_dot2_f32_bf16 v168, v135, s28, v168
    v_dot2_f32_bf16 v169, v135, v135, v169
    v_dot2_f32_bf16 v164, v136, s28, v164
    v_dot2_f32_bf16 v165, v136, v136, v165
    v_dot2_f32_bf16 v168, v137, s28, v168
    v_dot2_f32_bf16 v169, v137, v137, v169
    v_dot2_f32_bf16 v164, v138, s28, v164
    v_dot2_f32_bf16 v165, v138, v138, v165
    v_dot2_f32_bf16 v168, v139, s28, v168
    v_dot2_f32_bf16 v169, v139, v139, v169
    v_dot2_f32_bf16 v164, v140, s28, v164
    v_dot2_f32_bf16 v165, v140, v140, v165
    v_dot2_f32_bf16 v168, v141, s28, v168
    v_dot2_f32_bf16 v169, v141, v141, v169
    v_dot2_f32_bf16 v164, v142, s28, v164
    v_dot2_f32_bf16 v165, v142, v142, v165
    v_dot2_f32_bf16 v168, v143, s28, v168
    v_dot2_f32_bf16 v169, v143, v143, v169
    v_dot2_f32_bf16 v164, v144, s28, v164
    v_dot2_f32_bf16 v165, v144, v144, v165
    v_dot2_f32_bf16 v168, v145, s28, v168
    v_dot2_f32_bf16 v169, v145, v145, v169
    v_dot2_f32_bf16 v164, v146, s28, v164
    v_dot2_f32_bf16 v165, v146, v146, v165
    v_dot2_f32_bf16 v168, v147, s28, v168
    v_dot2_f32_bf16 v169, v147, v147, v169
    v_dot2_f32_bf16 v164, v148, s28, v164
    v_dot2_f32_bf16 v165, v148, v148, v165
    v_dot2_f32_bf16 v168, v149, s28, v168
    v_dot2_f32_bf16 v169, v149, v149, v169
    v_dot2_f32_bf16 v164, v150, s28, v164
    v_dot2_f32_bf16 v165, v150, v150, v165
    v_dot2_f32_bf16 v168, v151, s28, v168
    v_dot2_f32_bf16 v169, v151, v151, v169
    v_dot2_f32_bf16 v164, v152, s28, v164
    v_dot2_f32_bf16 v165, v152, v152, v165
    v_dot2_f32_bf16 v168, v153, s28, v168
    v_dot2_f32_bf16 v169, v153, v153, v169
    v_dot2_f32_bf16 v164, v154, s28, v164
    v_dot2_f32_bf16 v165, v154, v154, v165
    v_dot2_f32_bf16 v168, v155, s28, v168
    v_dot2_f32_bf16 v169, v155, v155, v169
    s_nop 1
    v_add_f32 v164, v164, v168
    v_add_f32 v165, v165, v169
    s_nop 0
    v_add_f32_dpp v166, v164, v164 quad_perm:[1,0,3,2] row_mask:0xf bank_mask:0xf
    s_nop 1
    v_add_f32_dpp v164, v166, v166 quad_perm:[2,3,0,1] row_mask:0xf bank_mask:0xf
    s_nop 1
    v_add_f32_dpp v166, v164, v164 row_half_mirror row_mask:0xf bank_mask:0xf
    v_mov_b32 v164, v166
    v_add_f32_dpp v166, v165, v165 quad_perm:[1,0,3,2] row_mask:0xf bank_mask:0xf
    s_nop 1
    v_add_f32_dpp v165, v166, v166 quad_perm:[2,3,0,1] row_mask:0xf bank_mask:0xf
    s_nop 1
    v_add_f32_dpp v166, v165, v165 row_half_mirror row_mask:0xf bank_mask:0xf
    v_mov_b32 v165, v166
    v_mul_f32 v164, 0x3b124925, v164
    v_mul_f32 v165, 0x3b124925, v165
    v_fma_f32 v165, -v164, v164, v165
    v_max_f32 v165, 0, v165
    v_cvt_pk_bf16_f32 v166, v164, v164
    v_lshlrev_b32 v162, 16, v166
    v_cvt_pk_bf16_f32 v166, v165, v165
    v_lshlrev_b32 v167, 16, v166
    v_add_f32 v167, 0x3727c5ac, v167
    v_cvt_pk_bf16_f32 v166, v167, v167
    v_lshlrev_b32 v167, 16, v166
    v_sqrt_f32 v167, v167
    s_nop 0
    v_cvt_pk_bf16_f32 v166, v167, v167
    v_lshlrev_b32 v167, 16, v166
    v_rcp_f32 v163, v167
    s_nop 0
    v_fma_f32 v166, -v167, v163, 2.0
    v_mul_f32 v163, v163, v166
    v_mov_b32 v160, v163
    v_mul_f32 v161, v162, v163
    v_lshlrev_b32 v170, 3, v156
    ds_write_b64 v170, v[160:161] offset:0
    ds_write_b128 v159, v[128:131] offset:0
    ds_write_b128 v159, v[132:135] offset:128
    ds_write_b128 v159, v[136:139] offset:256
    ds_write_b128 v159, v[140:143] offset:384
    ds_write_b128 v159, v[144:147] offset:512
    ds_write_b128 v159, v[148:151] offset:640
    ds_write_b128 v159, v[152:155] offset:768
    s_waitcnt lgkmcnt(0)
    s_barrier
    v_mul_u32_u24 v7, 928, v2
    v_lshl_add_u32 v7, v3, 4, v7
    v_add_u32 v7, 512, v7
    s_movk_i32 s42, 3584
    v_mul_lo_u32 v8, v2, s42
    v_lshl_add_u32 v8, v3, 3, v8
    v_mov_b32 v12, s28
    v_mov_b32 v13, s28
    v_mov_b32 v14, s28
    v_mov_b32 v15, s28
    v_lshlrev_b32 v9, 3, v2
    s_cmp_eq_u32 s3, 0
    s_cbranch_scc1 L_w30_kernel_var_1
    s_cmp_eq_u32 s3, 1
    s_cbranch_scc1 L_w30_kernel_var_1
    s_cmp_eq_u32 s3, 2
    s_cbranch_scc1 L_w30_kernel_var_1
    s_cmp_eq_u32 s3, 3
    s_cbranch_scc1 L_w30_kernel_var_1
    s_cmp_eq_u32 s3, 4
    s_cbranch_scc1 L_w30_kernel_var_1
    s_cmp_eq_u32 s3, 5
    s_cbranch_scc1 L_w30_kernel_var_1
    s_cmp_eq_u32 s3, 6
    s_cbranch_scc1 L_w30_kernel_var_1
    s_cmp_eq_u32 s3, 7
    s_cbranch_scc1 L_w30_kernel_var_1
    s_branch L_w30_kernel_end
L_w30_kernel_var_1:
    s_nop 4
    v_mov_b32 v128, 0
    v_mov_b32 v129, 0
    v_mov_b32 v130, 0
    v_mov_b32 v131, 0
    v_mov_b32 v132, 0
    v_mov_b32 v133, 0
    v_mov_b32 v134, 0
    v_mov_b32 v135, 0
    v_mov_b32 v136, 0
    v_mov_b32 v137, 0
    v_mov_b32 v138, 0
    v_mov_b32 v139, 0
    v_mov_b32 v140, 0
    v_mov_b32 v141, 0
    v_mov_b32 v142, 0
    v_mov_b32 v143, 0
    v_mov_b32 v144, 0
    v_mov_b32 v145, 0
    v_mov_b32 v146, 0
    v_mov_b32 v147, 0
    v_mov_b32 v148, 0
    v_mov_b32 v149, 0
    v_mov_b32 v150, 0
    v_mov_b32 v151, 0
    v_mov_b32 v152, 0
    v_mov_b32 v153, 0
    v_mov_b32 v154, 0
    v_mov_b32 v155, 0
    v_mov_b32 v156, 0
    v_mov_b32 v157, 0
    v_mov_b32 v158, 0
    v_mov_b32 v159, 0
    v_mov_b32 v192, 0
    v_mov_b32 v193, 0
    v_mov_b32 v194, 0
    v_mov_b32 v195, 0
    v_mov_b32 v196, 0
    v_mov_b32 v197, 0
    v_mov_b32 v198, 0
    v_mov_b32 v199, 0
    s_mul_i32 s50, s6, 3584
    s_mul_i32 s51, s5, 512
    s_add_u32 s50, s50, s51
    s_lshl_b32 s51, s43, 5
    s_add_u32 s50, s50, s51
    ds_read_b128 v[160:163], v7 offset:0
    ds_read_b128 v[164:167], v7 offset:14848
    ds_read_b128 v[168:171], v7 offset:29696
    ds_read_b128 v[172:175], v7 offset:44544
    ds_read_b128 v[176:179], v7 offset:64
    ds_read_b128 v[180:183], v7 offset:14912
    ds_read_b128 v[184:187], v7 offset:29760
    ds_read_b128 v[188:191], v7 offset:44608
    s_waitcnt lgkmcnt(4)
    s_waitcnt vmcnt(27)
    s_waitcnt vmcnt(26)
    v_mfma_f32_16x16x32_bf16 v[128:131], v[16:19], v[160:163], v[128:131]
    v_mfma_f32_16x16x32_bf16 v[136:139], v[16:19], v[164:167], v[136:139]
    v_mfma_f32_16x16x32_bf16 v[144:147], v[16:19], v[168:171], v[144:147]
    v_mfma_f32_16x16x32_bf16 v[152:155], v[16:19], v[172:175], v[152:155]
    v_mfma_f32_16x16x32_bf16 v[192:195], v[16:19], v[12:15], v[192:195]
    v_mfma_f32_16x16x32_bf16 v[132:135], v[72:75], v[160:163], v[132:135]
    v_mfma_f32_16x16x32_bf16 v[140:143], v[72:75], v[164:167], v[140:143]
    v_mfma_f32_16x16x32_bf16 v[148:151], v[72:75], v[168:171], v[148:151]
    v_mfma_f32_16x16x32_bf16 v[156:159], v[72:75], v[172:175], v[156:159]
    v_mfma_f32_16x16x32_bf16 v[196:199], v[72:75], v[12:15], v[196:199]
    ds_read_b128 v[160:163], v7 offset:128
    ds_read_b128 v[164:167], v7 offset:14976
    ds_read_b128 v[168:171], v7 offset:29824
    ds_read_b128 v[172:175], v7 offset:44672
    s_waitcnt lgkmcnt(4)
    s_waitcnt vmcnt(25)
    s_waitcnt vmcnt(24)
    v_mfma_f32_16x16x32_bf16 v[128:131], v[20:23], v[176:179], v[128:131]
    v_mfma_f32_16x16x32_bf16 v[136:139], v[20:23], v[180:183], v[136:139]
    v_mfma_f32_16x16x32_bf16 v[144:147], v[20:23], v[184:187], v[144:147]
    v_mfma_f32_16x16x32_bf16 v[152:155], v[20:23], v[188:191], v[152:155]
    v_mfma_f32_16x16x32_bf16 v[192:195], v[20:23], v[12:15], v[192:195]
    v_mfma_f32_16x16x32_bf16 v[132:135], v[76:79], v[176:179], v[132:135]
    v_mfma_f32_16x16x32_bf16 v[140:143], v[76:79], v[180:183], v[140:143]
    v_mfma_f32_16x16x32_bf16 v[148:151], v[76:79], v[184:187], v[148:151]
    v_mfma_f32_16x16x32_bf16 v[156:159], v[76:79], v[188:191], v[156:159]
    v_mfma_f32_16x16x32_bf16 v[196:199], v[76:79], v[12:15], v[196:199]
    ds_read_b128 v[176:179], v7 offset:192
    ds_read_b128 v[180:183], v7 offset:15040
    ds_read_b128 v[184:187], v7 offset:29888
    ds_read_b128 v[188:191], v7 offset:44736
    s_waitcnt lgkmcnt(4)
    s_waitcnt vmcnt(23)
    s_waitcnt vmcnt(22)
    v_mfma_f32_16x16x32_bf16 v[128:131], v[24:27], v[160:163], v[128:131]
    v_mfma_f32_16x16x32_bf16 v[136:139], v[24:27], v[164:167], v[136:139]
    v_mfma_f32_16x16x32_bf16 v[144:147], v[24:27], v[168:171], v[144:147]
    v_mfma_f32_16x16x32_bf16 v[152:155], v[24:27], v[172:175], v[152:155]
    v_mfma_f32_16x16x32_bf16 v[192:195], v[24:27], v[12:15], v[192:195]
    v_mfma_f32_16x16x32_bf16 v[132:135], v[80:83], v[160:163], v[132:135]
    v_mfma_f32_16x16x32_bf16 v[140:143], v[80:83], v[164:167], v[140:143]
    v_mfma_f32_16x16x32_bf16 v[148:151], v[80:83], v[168:171], v[148:151]
    v_mfma_f32_16x16x32_bf16 v[156:159], v[80:83], v[172:175], v[156:159]
    v_mfma_f32_16x16x32_bf16 v[196:199], v[80:83], v[12:15], v[196:199]
    ds_read_b128 v[160:163], v7 offset:256
    ds_read_b128 v[164:167], v7 offset:15104
    ds_read_b128 v[168:171], v7 offset:29952
    ds_read_b128 v[172:175], v7 offset:44800
    s_waitcnt lgkmcnt(4)
    s_waitcnt vmcnt(21)
    s_waitcnt vmcnt(20)
    v_mfma_f32_16x16x32_bf16 v[128:131], v[28:31], v[176:179], v[128:131]
    v_mfma_f32_16x16x32_bf16 v[136:139], v[28:31], v[180:183], v[136:139]
    v_mfma_f32_16x16x32_bf16 v[144:147], v[28:31], v[184:187], v[144:147]
    v_mfma_f32_16x16x32_bf16 v[152:155], v[28:31], v[188:191], v[152:155]
    v_mfma_f32_16x16x32_bf16 v[192:195], v[28:31], v[12:15], v[192:195]
    v_mfma_f32_16x16x32_bf16 v[132:135], v[84:87], v[176:179], v[132:135]
    v_mfma_f32_16x16x32_bf16 v[140:143], v[84:87], v[180:183], v[140:143]
    v_mfma_f32_16x16x32_bf16 v[148:151], v[84:87], v[184:187], v[148:151]
    v_mfma_f32_16x16x32_bf16 v[156:159], v[84:87], v[188:191], v[156:159]
    v_mfma_f32_16x16x32_bf16 v[196:199], v[84:87], v[12:15], v[196:199]
    ds_read_b128 v[176:179], v7 offset:320
    ds_read_b128 v[180:183], v7 offset:15168
    ds_read_b128 v[184:187], v7 offset:30016
    ds_read_b128 v[188:191], v7 offset:44864
    s_waitcnt lgkmcnt(4)
    s_waitcnt vmcnt(19)
    s_waitcnt vmcnt(18)
    v_mfma_f32_16x16x32_bf16 v[128:131], v[32:35], v[160:163], v[128:131]
    v_mfma_f32_16x16x32_bf16 v[136:139], v[32:35], v[164:167], v[136:139]
    v_mfma_f32_16x16x32_bf16 v[144:147], v[32:35], v[168:171], v[144:147]
    v_mfma_f32_16x16x32_bf16 v[152:155], v[32:35], v[172:175], v[152:155]
    v_mfma_f32_16x16x32_bf16 v[192:195], v[32:35], v[12:15], v[192:195]
    v_mfma_f32_16x16x32_bf16 v[132:135], v[88:91], v[160:163], v[132:135]
    v_mfma_f32_16x16x32_bf16 v[140:143], v[88:91], v[164:167], v[140:143]
    v_mfma_f32_16x16x32_bf16 v[148:151], v[88:91], v[168:171], v[148:151]
    v_mfma_f32_16x16x32_bf16 v[156:159], v[88:91], v[172:175], v[156:159]
    v_mfma_f32_16x16x32_bf16 v[196:199], v[88:91], v[12:15], v[196:199]
    ds_read_b128 v[160:163], v7 offset:384
    ds_read_b128 v[164:167], v7 offset:15232
    ds_read_b128 v[168:171], v7 offset:30080
    ds_read_b128 v[172:175], v7 offset:44928
    s_waitcnt lgkmcnt(4)
    s_waitcnt vmcnt(17)
    s_waitcnt vmcnt(16)
    v_mfma_f32_16x16x32_bf16 v[128:131], v[36:39], v[176:179], v[128:131]
    v_mfma_f32_16x16x32_bf16 v[136:139], v[36:39], v[180:183], v[136:139]
    v_mfma_f32_16x16x32_bf16 v[144:147], v[36:39], v[184:187], v[144:147]
    v_mfma_f32_16x16x32_bf16 v[152:155], v[36:39], v[188:191], v[152:155]
    v_mfma_f32_16x16x32_bf16 v[192:195], v[36:39], v[12:15], v[192:195]
    v_mfma_f32_16x16x32_bf16 v[132:135], v[92:95], v[176:179], v[132:135]
    v_mfma_f32_16x16x32_bf16 v[140:143], v[92:95], v[180:183], v[140:143]
    v_mfma_f32_16x16x32_bf16 v[148:151], v[92:95], v[184:187], v[148:151]
    v_mfma_f32_16x16x32_bf16 v[156:159], v[92:95], v[188:191], v[156:159]
    v_mfma_f32_16x16x32_bf16 v[196:199], v[92:95], v[12:15], v[196:199]
    ds_read_b128 v[176:179], v7 offset:448
    ds_read_b128 v[180:183], v7 offset:15296
    ds_read_b128 v[184:187], v7 offset:30144
    ds_read_b128 v[188:191], v7 offset:44992
    s_waitcnt lgkmcnt(4)
    s_waitcnt vmcnt(15)
    s_waitcnt vmcnt(14)
    v_mfma_f32_16x16x32_bf16 v[128:131], v[40:43], v[160:163], v[128:131]
    v_mfma_f32_16x16x32_bf16 v[136:139], v[40:43], v[164:167], v[136:139]
    v_mfma_f32_16x16x32_bf16 v[144:147], v[40:43], v[168:171], v[144:147]
    v_mfma_f32_16x16x32_bf16 v[152:155], v[40:43], v[172:175], v[152:155]
    v_mfma_f32_16x16x32_bf16 v[192:195], v[40:43], v[12:15], v[192:195]
    v_mfma_f32_16x16x32_bf16 v[132:135], v[96:99], v[160:163], v[132:135]
    v_mfma_f32_16x16x32_bf16 v[140:143], v[96:99], v[164:167], v[140:143]
    v_mfma_f32_16x16x32_bf16 v[148:151], v[96:99], v[168:171], v[148:151]
    v_mfma_f32_16x16x32_bf16 v[156:159], v[96:99], v[172:175], v[156:159]
    v_mfma_f32_16x16x32_bf16 v[196:199], v[96:99], v[12:15], v[196:199]
    ds_read_b128 v[160:163], v7 offset:512
    ds_read_b128 v[164:167], v7 offset:15360
    ds_read_b128 v[168:171], v7 offset:30208
    ds_read_b128 v[172:175], v7 offset:45056
    s_waitcnt lgkmcnt(4)
    s_waitcnt vmcnt(13)
    s_waitcnt vmcnt(12)
    v_mfma_f32_16x16x32_bf16 v[128:131], v[44:47], v[176:179], v[128:131]
    v_mfma_f32_16x16x32_bf16 v[136:139], v[44:47], v[180:183], v[136:139]
    v_mfma_f32_16x16x32_bf16 v[144:147], v[44:47], v[184:187], v[144:147]
    v_mfma_f32_16x16x32_bf16 v[152:155], v[44:47], v[188:191], v[152:155]
    v_mfma_f32_16x16x32_bf16 v[192:195], v[44:47], v[12:15], v[192:195]
    v_mfma_f32_16x16x32_bf16 v[132:135], v[100:103], v[176:179], v[132:135]
    v_mfma_f32_16x16x32_bf16 v[140:143], v[100:103], v[180:183], v[140:143]
    v_mfma_f32_16x16x32_bf16 v[148:151], v[100:103], v[184:187], v[148:151]
    v_mfma_f32_16x16x32_bf16 v[156:159], v[100:103], v[188:191], v[156:159]
    v_mfma_f32_16x16x32_bf16 v[196:199], v[100:103], v[12:15], v[196:199]
    ds_read_b128 v[176:179], v7 offset:576
    ds_read_b128 v[180:183], v7 offset:15424
    ds_read_b128 v[184:187], v7 offset:30272
    ds_read_b128 v[188:191], v7 offset:45120
    s_waitcnt lgkmcnt(4)
    s_waitcnt vmcnt(11)
    s_waitcnt vmcnt(10)
    v_mfma_f32_16x16x32_bf16 v[128:131], v[48:51], v[160:163], v[128:131]
    v_mfma_f32_16x16x32_bf16 v[136:139], v[48:51], v[164:167], v[136:139]
    v_mfma_f32_16x16x32_bf16 v[144:147], v[48:51], v[168:171], v[144:147]
    v_mfma_f32_16x16x32_bf16 v[152:155], v[48:51], v[172:175], v[152:155]
    v_mfma_f32_16x16x32_bf16 v[192:195], v[48:51], v[12:15], v[192:195]
    v_mfma_f32_16x16x32_bf16 v[132:135], v[104:107], v[160:163], v[132:135]
    v_mfma_f32_16x16x32_bf16 v[140:143], v[104:107], v[164:167], v[140:143]
    v_mfma_f32_16x16x32_bf16 v[148:151], v[104:107], v[168:171], v[148:151]
    v_mfma_f32_16x16x32_bf16 v[156:159], v[104:107], v[172:175], v[156:159]
    v_mfma_f32_16x16x32_bf16 v[196:199], v[104:107], v[12:15], v[196:199]
    ds_read_b128 v[160:163], v7 offset:640
    ds_read_b128 v[164:167], v7 offset:15488
    ds_read_b128 v[168:171], v7 offset:30336
    ds_read_b128 v[172:175], v7 offset:45184
    s_waitcnt lgkmcnt(4)
    s_waitcnt vmcnt(9)
    s_waitcnt vmcnt(8)
    v_mfma_f32_16x16x32_bf16 v[128:131], v[52:55], v[176:179], v[128:131]
    v_mfma_f32_16x16x32_bf16 v[136:139], v[52:55], v[180:183], v[136:139]
    v_mfma_f32_16x16x32_bf16 v[144:147], v[52:55], v[184:187], v[144:147]
    v_mfma_f32_16x16x32_bf16 v[152:155], v[52:55], v[188:191], v[152:155]
    v_mfma_f32_16x16x32_bf16 v[192:195], v[52:55], v[12:15], v[192:195]
    v_mfma_f32_16x16x32_bf16 v[132:135], v[108:111], v[176:179], v[132:135]
    v_mfma_f32_16x16x32_bf16 v[140:143], v[108:111], v[180:183], v[140:143]
    v_mfma_f32_16x16x32_bf16 v[148:151], v[108:111], v[184:187], v[148:151]
    v_mfma_f32_16x16x32_bf16 v[156:159], v[108:111], v[188:191], v[156:159]
    v_mfma_f32_16x16x32_bf16 v[196:199], v[108:111], v[12:15], v[196:199]
    ds_read_b128 v[176:179], v7 offset:704
    ds_read_b128 v[180:183], v7 offset:15552
    ds_read_b128 v[184:187], v7 offset:30400
    ds_read_b128 v[188:191], v7 offset:45248
    s_waitcnt lgkmcnt(4)
    s_waitcnt vmcnt(7)
    s_waitcnt vmcnt(6)
    v_mfma_f32_16x16x32_bf16 v[128:131], v[56:59], v[160:163], v[128:131]
    v_mfma_f32_16x16x32_bf16 v[136:139], v[56:59], v[164:167], v[136:139]
    v_mfma_f32_16x16x32_bf16 v[144:147], v[56:59], v[168:171], v[144:147]
    v_mfma_f32_16x16x32_bf16 v[152:155], v[56:59], v[172:175], v[152:155]
    v_mfma_f32_16x16x32_bf16 v[192:195], v[56:59], v[12:15], v[192:195]
    v_mfma_f32_16x16x32_bf16 v[132:135], v[112:115], v[160:163], v[132:135]
    v_mfma_f32_16x16x32_bf16 v[140:143], v[112:115], v[164:167], v[140:143]
    v_mfma_f32_16x16x32_bf16 v[148:151], v[112:115], v[168:171], v[148:151]
    v_mfma_f32_16x16x32_bf16 v[156:159], v[112:115], v[172:175], v[156:159]
    v_mfma_f32_16x16x32_bf16 v[196:199], v[112:115], v[12:15], v[196:199]
    ds_read_b128 v[160:163], v7 offset:768
    ds_read_b128 v[164:167], v7 offset:15616
    ds_read_b128 v[168:171], v7 offset:30464
    ds_read_b128 v[172:175], v7 offset:45312
    s_waitcnt lgkmcnt(4)
    s_waitcnt vmcnt(5)
    s_waitcnt vmcnt(4)
    v_mfma_f32_16x16x32_bf16 v[128:131], v[60:63], v[176:179], v[128:131]
    v_mfma_f32_16x16x32_bf16 v[136:139], v[60:63], v[180:183], v[136:139]
    v_mfma_f32_16x16x32_bf16 v[144:147], v[60:63], v[184:187], v[144:147]
    v_mfma_f32_16x16x32_bf16 v[152:155], v[60:63], v[188:191], v[152:155]
    v_mfma_f32_16x16x32_bf16 v[192:195], v[60:63], v[12:15], v[192:195]
    v_mfma_f32_16x16x32_bf16 v[132:135], v[116:119], v[176:179], v[132:135]
    v_mfma_f32_16x16x32_bf16 v[140:143], v[116:119], v[180:183], v[140:143]
    v_mfma_f32_16x16x32_bf16 v[148:151], v[116:119], v[184:187], v[148:151]
    v_mfma_f32_16x16x32_bf16 v[156:159], v[116:119], v[188:191], v[156:159]
    v_mfma_f32_16x16x32_bf16 v[196:199], v[116:119], v[12:15], v[196:199]
    ds_read_b128 v[176:179], v7 offset:832
    ds_read_b128 v[180:183], v7 offset:15680
    ds_read_b128 v[184:187], v7 offset:30528
    ds_read_b128 v[188:191], v7 offset:45376
    s_waitcnt lgkmcnt(4)
    s_waitcnt vmcnt(3)
    s_waitcnt vmcnt(2)
    v_mfma_f32_16x16x32_bf16 v[128:131], v[64:67], v[160:163], v[128:131]
    v_mfma_f32_16x16x32_bf16 v[136:139], v[64:67], v[164:167], v[136:139]
    v_mfma_f32_16x16x32_bf16 v[144:147], v[64:67], v[168:171], v[144:147]
    v_mfma_f32_16x16x32_bf16 v[152:155], v[64:67], v[172:175], v[152:155]
    v_mfma_f32_16x16x32_bf16 v[192:195], v[64:67], v[12:15], v[192:195]
    v_mfma_f32_16x16x32_bf16 v[132:135], v[120:123], v[160:163], v[132:135]
    v_mfma_f32_16x16x32_bf16 v[140:143], v[120:123], v[164:167], v[140:143]
    v_mfma_f32_16x16x32_bf16 v[148:151], v[120:123], v[168:171], v[148:151]
    v_mfma_f32_16x16x32_bf16 v[156:159], v[120:123], v[172:175], v[156:159]
    v_mfma_f32_16x16x32_bf16 v[196:199], v[120:123], v[12:15], v[196:199]
    s_waitcnt lgkmcnt(0)
    s_waitcnt vmcnt(1)
    s_waitcnt vmcnt(0)
    v_mfma_f32_16x16x32_bf16 v[128:131], v[68:71], v[176:179], v[128:131]
    v_mfma_f32_16x16x32_bf16 v[136:139], v[68:71], v[180:183], v[136:139]
    v_mfma_f32_16x16x32_bf16 v[144:147], v[68:71], v[184:187], v[144:147]
    v_mfma_f32_16x16x32_bf16 v[152:155], v[68:71], v[188:191], v[152:155]
    v_mfma_f32_16x16x32_bf16 v[192:195], v[68:71], v[12:15], v[192:195]
    v_mfma_f32_16x16x32_bf16 v[132:135], v[124:127], v[176:179], v[132:135]
    v_mfma_f32_16x16x32_bf16 v[140:143], v[124:127], v[180:183], v[140:143]
    v_mfma_f32_16x16x32_bf16 v[148:151], v[124:127], v[184:187], v[148:151]
    v_mfma_f32_16x16x32_bf16 v[156:159], v[124:127], v[188:191], v[156:159]
    v_mfma_f32_16x16x32_bf16 v[196:199], v[124:127], v[12:15], v[196:199]
    ds_read_b64 v[208:209], v9 offset:0
    ds_read_b64 v[210:211], v9 offset:128
    ds_read_b64 v[212:213], v9 offset:256
    ds_read_b64 v[214:215], v9 offset:384
    s_waitcnt lgkmcnt(0)
    v_mul_f32 v202, v192, v209
    v_fma_f32 v128, v128, v208, -v202
    v_mul_f32 v202, v193, v209
    v_fma_f32 v129, v129, v208, -v202
    v_mul_f32 v202, v194, v209
    v_fma_f32 v130, v130, v208, -v202
    v_mul_f32 v202, v195, v209
    v_fma_f32 v131, v131, v208, -v202
    v_cvt_pk_bf16_f32 v200, v128, v129
    v_cvt_pk_bf16_f32 v201, v130, v131
    v_lshlrev_b32 v202, 16, v200
    v_and_b32 v203, 0xffff0000, v200
    v_mul_f32 v204, v202, v202
    v_mul_f32 v205, v203, v203
    v_fma_f32 v204, v204, s29, 1.0
    v_fma_f32 v205, v205, s29, 1.0
    v_mul_f32 v204, v204, v202
    v_mul_f32 v205, v205, v203
    v_mul_f32 v204, s30, v204
    v_mul_f32 v205, s30, v205
    v_exp_f32 v204, v204
    v_exp_f32 v205, v205
    v_add_f32 v204, 1.0, v204
    v_add_f32 v205, 1.0, v205
    v_rcp_f32 v204, v204
    v_rcp_f32 v205, v205
    v_mul_f32 v202, v202, v204
    v_mul_f32 v203, v203, v205
    v_cvt_pk_bf16_f32 v200, v202, v203
    v_lshlrev_b32 v202, 16, v201
    v_and_b32 v203, 0xffff0000, v201
    v_mul_f32 v204, v202, v202
    v_mul_f32 v205, v203, v203
    v_fma_f32 v204, v204, s29, 1.0
    v_fma_f32 v205, v205, s29, 1.0
    v_mul_f32 v204, v204, v202
    v_mul_f32 v205, v205, v203
    v_mul_f32 v204, s30, v204
    v_mul_f32 v205, s30, v205
    v_exp_f32 v204, v204
    v_exp_f32 v205, v205
    v_add_f32 v204, 1.0, v204
    v_add_f32 v205, 1.0, v205
    v_rcp_f32 v204, v204
    v_rcp_f32 v205, v205
    v_mul_f32 v202, v202, v204
    v_mul_f32 v203, v203, v205
    v_cvt_pk_bf16_f32 v201, v202, v203
    buffer_store_dwordx2 v[200:201], v8, s[16:19], s50 offen offset:0
    v_mul_f32 v202, v196, v209
    v_fma_f32 v132, v132, v208, -v202
    v_mul_f32 v202, v197, v209
    v_fma_f32 v133, v133, v208, -v202
    v_mul_f32 v202, v198, v209
    v_fma_f32 v134, v134, v208, -v202
    v_mul_f32 v202, v199, v209
    v_fma_f32 v135, v135, v208, -v202
    v_cvt_pk_bf16_f32 v200, v132, v133
    v_cvt_pk_bf16_f32 v201, v134, v135
    v_lshlrev_b32 v202, 16, v200
    v_and_b32 v203, 0xffff0000, v200
    v_mul_f32 v204, v202, v202
    v_mul_f32 v205, v203, v203
    v_fma_f32 v204, v204, s29, 1.0
    v_fma_f32 v205, v205, s29, 1.0
    v_mul_f32 v204, v204, v202
    v_mul_f32 v205, v205, v203
    v_mul_f32 v204, s30, v204
    v_mul_f32 v205, s30, v205
    v_exp_f32 v204, v204
    v_exp_f32 v205, v205
    v_add_f32 v204, 1.0, v204
    v_add_f32 v205, 1.0, v205
    v_rcp_f32 v204, v204
    v_rcp_f32 v205, v205
    v_mul_f32 v202, v202, v204
    v_mul_f32 v203, v203, v205
    v_cvt_pk_bf16_f32 v200, v202, v203
    v_lshlrev_b32 v202, 16, v201
    v_and_b32 v203, 0xffff0000, v201
    v_mul_f32 v204, v202, v202
    v_mul_f32 v205, v203, v203
    v_fma_f32 v204, v204, s29, 1.0
    v_fma_f32 v205, v205, s29, 1.0
    v_mul_f32 v204, v204, v202
    v_mul_f32 v205, v205, v203
    v_mul_f32 v204, s30, v204
    v_mul_f32 v205, s30, v205
    v_exp_f32 v204, v204
    v_exp_f32 v205, v205
    v_add_f32 v204, 1.0, v204
    v_add_f32 v205, 1.0, v205
    v_rcp_f32 v204, v204
    v_rcp_f32 v205, v205
    v_mul_f32 v202, v202, v204
    v_mul_f32 v203, v203, v205
    v_cvt_pk_bf16_f32 v201, v202, v203
    buffer_store_dwordx2 v[200:201], v8, s[16:19], s50 offen offset:32
    s_add_u32 s52, s50, 57344
    v_mul_f32 v202, v192, v211
    v_fma_f32 v136, v136, v210, -v202
    v_mul_f32 v202, v193, v211
    v_fma_f32 v137, v137, v210, -v202
    v_mul_f32 v202, v194, v211
    v_fma_f32 v138, v138, v210, -v202
    v_mul_f32 v202, v195, v211
    v_fma_f32 v139, v139, v210, -v202
    v_cvt_pk_bf16_f32 v200, v136, v137
    v_cvt_pk_bf16_f32 v201, v138, v139
    v_lshlrev_b32 v202, 16, v200
    v_and_b32 v203, 0xffff0000, v200
    v_mul_f32 v204, v202, v202
    v_mul_f32 v205, v203, v203
    v_fma_f32 v204, v204, s29, 1.0
    v_fma_f32 v205, v205, s29, 1.0
    v_mul_f32 v204, v204, v202
    v_mul_f32 v205, v205, v203
    v_mul_f32 v204, s30, v204
    v_mul_f32 v205, s30, v205
    v_exp_f32 v204, v204
    v_exp_f32 v205, v205
    v_add_f32 v204, 1.0, v204
    v_add_f32 v205, 1.0, v205
    v_rcp_f32 v204, v204
    v_rcp_f32 v205, v205
    v_mul_f32 v202, v202, v204
    v_mul_f32 v203, v203, v205
    v_cvt_pk_bf16_f32 v200, v202, v203
    v_lshlrev_b32 v202, 16, v201
    v_and_b32 v203, 0xffff0000, v201
    v_mul_f32 v204, v202, v202
    v_mul_f32 v205, v203, v203
    v_fma_f32 v204, v204, s29, 1.0
    v_fma_f32 v205, v205, s29, 1.0
    v_mul_f32 v204, v204, v202
    v_mul_f32 v205, v205, v203
    v_mul_f32 v204, s30, v204
    v_mul_f32 v205, s30, v205
    v_exp_f32 v204, v204
    v_exp_f32 v205, v205
    v_add_f32 v204, 1.0, v204
    v_add_f32 v205, 1.0, v205
    v_rcp_f32 v204, v204
    v_rcp_f32 v205, v205
    v_mul_f32 v202, v202, v204
    v_mul_f32 v203, v203, v205
    v_cvt_pk_bf16_f32 v201, v202, v203
    buffer_store_dwordx2 v[200:201], v8, s[16:19], s52 offen offset:0
    v_mul_f32 v202, v196, v211
    v_fma_f32 v140, v140, v210, -v202
    v_mul_f32 v202, v197, v211
    v_fma_f32 v141, v141, v210, -v202
    v_mul_f32 v202, v198, v211
    v_fma_f32 v142, v142, v210, -v202
    v_mul_f32 v202, v199, v211
    v_fma_f32 v143, v143, v210, -v202
    v_cvt_pk_bf16_f32 v200, v140, v141
    v_cvt_pk_bf16_f32 v201, v142, v143
    v_lshlrev_b32 v202, 16, v200
    v_and_b32 v203, 0xffff0000, v200
    v_mul_f32 v204, v202, v202
    v_mul_f32 v205, v203, v203
    v_fma_f32 v204, v204, s29, 1.0
    v_fma_f32 v205, v205, s29, 1.0
    v_mul_f32 v204, v204, v202
    v_mul_f32 v205, v205, v203
    v_mul_f32 v204, s30, v204
    v_mul_f32 v205, s30, v205
    v_exp_f32 v204, v204
    v_exp_f32 v205, v205
    v_add_f32 v204, 1.0, v204
    v_add_f32 v205, 1.0, v205
    v_rcp_f32 v204, v204
    v_rcp_f32 v205, v205
    v_mul_f32 v202, v202, v204
    v_mul_f32 v203, v203, v205
    v_cvt_pk_bf16_f32 v200, v202, v203
    v_lshlrev_b32 v202, 16, v201
    v_and_b32 v203, 0xffff0000, v201
    v_mul_f32 v204, v202, v202
    v_mul_f32 v205, v203, v203
    v_fma_f32 v204, v204, s29, 1.0
    v_fma_f32 v205, v205, s29, 1.0
    v_mul_f32 v204, v204, v202
    v_mul_f32 v205, v205, v203
    v_mul_f32 v204, s30, v204
    v_mul_f32 v205, s30, v205
    v_exp_f32 v204, v204
    v_exp_f32 v205, v205
    v_add_f32 v204, 1.0, v204
    v_add_f32 v205, 1.0, v205
    v_rcp_f32 v204, v204
    v_rcp_f32 v205, v205
    v_mul_f32 v202, v202, v204
    v_mul_f32 v203, v203, v205
    v_cvt_pk_bf16_f32 v201, v202, v203
    buffer_store_dwordx2 v[200:201], v8, s[16:19], s52 offen offset:32
    s_add_u32 s52, s50, 114688
    v_mul_f32 v202, v192, v213
    v_fma_f32 v144, v144, v212, -v202
    v_mul_f32 v202, v193, v213
    v_fma_f32 v145, v145, v212, -v202
    v_mul_f32 v202, v194, v213
    v_fma_f32 v146, v146, v212, -v202
    v_mul_f32 v202, v195, v213
    v_fma_f32 v147, v147, v212, -v202
    v_cvt_pk_bf16_f32 v200, v144, v145
    v_cvt_pk_bf16_f32 v201, v146, v147
    v_lshlrev_b32 v202, 16, v200
    v_and_b32 v203, 0xffff0000, v200
    v_mul_f32 v204, v202, v202
    v_mul_f32 v205, v203, v203
    v_fma_f32 v204, v204, s29, 1.0
    v_fma_f32 v205, v205, s29, 1.0
    v_mul_f32 v204, v204, v202
    v_mul_f32 v205, v205, v203
    v_mul_f32 v204, s30, v204
    v_mul_f32 v205, s30, v205
    v_exp_f32 v204, v204
    v_exp_f32 v205, v205
    v_add_f32 v204, 1.0, v204
    v_add_f32 v205, 1.0, v205
    v_rcp_f32 v204, v204
    v_rcp_f32 v205, v205
    v_mul_f32 v202, v202, v204
    v_mul_f32 v203, v203, v205
    v_cvt_pk_bf16_f32 v200, v202, v203
    v_lshlrev_b32 v202, 16, v201
    v_and_b32 v203, 0xffff0000, v201
    v_mul_f32 v204, v202, v202
    v_mul_f32 v205, v203, v203
    v_fma_f32 v204, v204, s29, 1.0
    v_fma_f32 v205, v205, s29, 1.0
    v_mul_f32 v204, v204, v202
    v_mul_f32 v205, v205, v203
    v_mul_f32 v204, s30, v204
    v_mul_f32 v205, s30, v205
    v_exp_f32 v204, v204
    v_exp_f32 v205, v205
    v_add_f32 v204, 1.0, v204
    v_add_f32 v205, 1.0, v205
    v_rcp_f32 v204, v204
    v_rcp_f32 v205, v205
    v_mul_f32 v202, v202, v204
    v_mul_f32 v203, v203, v205
    v_cvt_pk_bf16_f32 v201, v202, v203
    buffer_store_dwordx2 v[200:201], v8, s[16:19], s52 offen offset:0
    v_mul_f32 v202, v196, v213
    v_fma_f32 v148, v148, v212, -v202
    v_mul_f32 v202, v197, v213
    v_fma_f32 v149, v149, v212, -v202
    v_mul_f32 v202, v198, v213
    v_fma_f32 v150, v150, v212, -v202
    v_mul_f32 v202, v199, v213
    v_fma_f32 v151, v151, v212, -v202
    v_cvt_pk_bf16_f32 v200, v148, v149
    v_cvt_pk_bf16_f32 v201, v150, v151
    v_lshlrev_b32 v202, 16, v200
    v_and_b32 v203, 0xffff0000, v200
    v_mul_f32 v204, v202, v202
    v_mul_f32 v205, v203, v203
    v_fma_f32 v204, v204, s29, 1.0
    v_fma_f32 v205, v205, s29, 1.0
    v_mul_f32 v204, v204, v202
    v_mul_f32 v205, v205, v203
    v_mul_f32 v204, s30, v204
    v_mul_f32 v205, s30, v205
    v_exp_f32 v204, v204
    v_exp_f32 v205, v205
    v_add_f32 v204, 1.0, v204
    v_add_f32 v205, 1.0, v205
    v_rcp_f32 v204, v204
    v_rcp_f32 v205, v205
    v_mul_f32 v202, v202, v204
    v_mul_f32 v203, v203, v205
    v_cvt_pk_bf16_f32 v200, v202, v203
    v_lshlrev_b32 v202, 16, v201
    v_and_b32 v203, 0xffff0000, v201
    v_mul_f32 v204, v202, v202
    v_mul_f32 v205, v203, v203
    v_fma_f32 v204, v204, s29, 1.0
    v_fma_f32 v205, v205, s29, 1.0
    v_mul_f32 v204, v204, v202
    v_mul_f32 v205, v205, v203
    v_mul_f32 v204, s30, v204
    v_mul_f32 v205, s30, v205
    v_exp_f32 v204, v204
    v_exp_f32 v205, v205
    v_add_f32 v204, 1.0, v204
    v_add_f32 v205, 1.0, v205
    v_rcp_f32 v204, v204
    v_rcp_f32 v205, v205
    v_mul_f32 v202, v202, v204
    v_mul_f32 v203, v203, v205
    v_cvt_pk_bf16_f32 v201, v202, v203
    buffer_store_dwordx2 v[200:201], v8, s[16:19], s52 offen offset:32
    s_add_u32 s52, s50, 172032
    v_mul_f32 v202, v192, v215
    v_fma_f32 v152, v152, v214, -v202
    v_mul_f32 v202, v193, v215
    v_fma_f32 v153, v153, v214, -v202
    v_mul_f32 v202, v194, v215
    v_fma_f32 v154, v154, v214, -v202
    v_mul_f32 v202, v195, v215
    v_fma_f32 v155, v155, v214, -v202
    v_cvt_pk_bf16_f32 v200, v152, v153
    v_cvt_pk_bf16_f32 v201, v154, v155
    v_lshlrev_b32 v202, 16, v200
    v_and_b32 v203, 0xffff0000, v200
    v_mul_f32 v204, v202, v202
    v_mul_f32 v205, v203, v203
    v_fma_f32 v204, v204, s29, 1.0
    v_fma_f32 v205, v205, s29, 1.0
    v_mul_f32 v204, v204, v202
    v_mul_f32 v205, v205, v203
    v_mul_f32 v204, s30, v204
    v_mul_f32 v205, s30, v205
    v_exp_f32 v204, v204
    v_exp_f32 v205, v205
    v_add_f32 v204, 1.0, v204
    v_add_f32 v205, 1.0, v205
    v_rcp_f32 v204, v204
    v_rcp_f32 v205, v205
    v_mul_f32 v202, v202, v204
    v_mul_f32 v203, v203, v205
    v_cvt_pk_bf16_f32 v200, v202, v203
    v_lshlrev_b32 v202, 16, v201
    v_and_b32 v203, 0xffff0000, v201
    v_mul_f32 v204, v202, v202
    v_mul_f32 v205, v203, v203
    v_fma_f32 v204, v204, s29, 1.0
    v_fma_f32 v205, v205, s29, 1.0
    v_mul_f32 v204, v204, v202
    v_mul_f32 v205, v205, v203
    v_mul_f32 v204, s30, v204
    v_mul_f32 v205, s30, v205
    v_exp_f32 v204, v204
    v_exp_f32 v205, v205
    v_add_f32 v204, 1.0, v204
    v_add_f32 v205, 1.0, v205
    v_rcp_f32 v204, v204
    v_rcp_f32 v205, v205
    v_mul_f32 v202, v202, v204
    v_mul_f32 v203, v203, v205
    v_cvt_pk_bf16_f32 v201, v202, v203
    buffer_store_dwordx2 v[200:201], v8, s[16:19], s52 offen offset:0
    v_mul_f32 v202, v196, v215
    v_fma_f32 v156, v156, v214, -v202
    v_mul_f32 v202, v197, v215
    v_fma_f32 v157, v157, v214, -v202
    v_mul_f32 v202, v198, v215
    v_fma_f32 v158, v158, v214, -v202
    v_mul_f32 v202, v199, v215
    v_fma_f32 v159, v159, v214, -v202
    v_cvt_pk_bf16_f32 v200, v156, v157
    v_cvt_pk_bf16_f32 v201, v158, v159
    v_lshlrev_b32 v202, 16, v200
    v_and_b32 v203, 0xffff0000, v200
    v_mul_f32 v204, v202, v202
    v_mul_f32 v205, v203, v203
    v_fma_f32 v204, v204, s29, 1.0
    v_fma_f32 v205, v205, s29, 1.0
    v_mul_f32 v204, v204, v202
    v_mul_f32 v205, v205, v203
    v_mul_f32 v204, s30, v204
    v_mul_f32 v205, s30, v205
    v_exp_f32 v204, v204
    v_exp_f32 v205, v205
    v_add_f32 v204, 1.0, v204
    v_add_f32 v205, 1.0, v205
    v_rcp_f32 v204, v204
    v_rcp_f32 v205, v205
    v_mul_f32 v202, v202, v204
    v_mul_f32 v203, v203, v205
    v_cvt_pk_bf16_f32 v200, v202, v203
    v_lshlrev_b32 v202, 16, v201
    v_and_b32 v203, 0xffff0000, v201
    v_mul_f32 v204, v202, v202
    v_mul_f32 v205, v203, v203
    v_fma_f32 v204, v204, s29, 1.0
    v_fma_f32 v205, v205, s29, 1.0
    v_mul_f32 v204, v204, v202
    v_mul_f32 v205, v205, v203
    v_mul_f32 v204, s30, v204
    v_mul_f32 v205, s30, v205
    v_exp_f32 v204, v204
    v_exp_f32 v205, v205
    v_add_f32 v204, 1.0, v204
    v_add_f32 v205, 1.0, v205
    v_rcp_f32 v204, v204
    v_rcp_f32 v205, v205
    v_mul_f32 v202, v202, v204
    v_mul_f32 v203, v203, v205
    v_cvt_pk_bf16_f32 v201, v202, v203
    buffer_store_dwordx2 v[200:201], v8, s[16:19], s52 offen offset:32
    s_branch L_w30_kernel_end
L_w30_kernel_end:
    s_nop 1
L_w30_kernel_done:
    s_endpgm
.globl w40_kernel
.p2align 8
.type w40_kernel,@function
w40_kernel:
    s_cmp_ge_u32 s2, 256
    s_cbranch_scc1 L_w40_kernel_done
    s_load_dwordx4 s[32:35], s[0:1], 0
    s_load_dwordx4 s[36:39], s[0:1], 64
    s_load_dwordx2 s[40:41], s[0:1], 80
    v_lshrrev_b32 v4, 6, v0
    v_and_b32 v1, 63, v0
    v_readfirstlane_b32 s3, v4
    s_lshr_b32 s7, s2, 3
    s_mul_hi_u32 s4, s7, 0x40000000
    s_mul_i32 s42, s4, 4
    s_sub_u32 s5, s7, s42
    s_and_b32 s7, s2, 7
    s_mul_i32 s7, s7, 8
    s_add_u32 s4, s4, s7
    s_mul_i32 s6, s4, 32
    v_and_b32 v2, 15, v1
    v_lshrrev_b32 v3, 4, v1
    s_mov_b32 s28, 0x3f803f80
    s_mov_b32 s29, 0x3d372713
    s_mov_b32 s30, 0xc0135761
    s_waitcnt lgkmcnt(0)
    s_mov_b32 s8, s40
    s_mov_b32 s9, s41
    s_and_b32 s9, s9, 0xffff
    s_mov_b32 s10, 0x10000000
    s_mov_b32 s11, 0x00020000
    s_add_u32 s12, s40, 0x1606000
    s_addc_u32 s13, s41, 0
    s_and_b32 s13, s13, 0xffff
    s_mov_b32 s14, 0x700000
    s_mov_b32 s15, 0x00020000
    s_add_u32 s16, s40, 0x1446000
    s_addc_u32 s17, s41, 0
    s_and_b32 s17, s17, 0xffff
    s_mov_b32 s18, 0x1c0000
    s_mov_b32 s19, 0x00020000
    s_add_u32 s20, s40, 0x1286000
    s_addc_u32 s21, s41, 0
    s_and_b32 s21, s21, 0xffff
    s_mov_b32 s22, 0x1c0000
    s_mov_b32 s23, 0x00020000
    s_add_u32 s24, s40, 0xd46000
    s_addc_u32 s25, s41, 0
    s_and_b32 s25, s25, 0xffff
    s_mov_b32 s26, 0x1c0000
    s_mov_b32 s27, 0x00020000
    v_lshrrev_b32 v132, 4, v1
    v_and_b32 v133, 15, v1
    s_mul_i32 s42, s3, 4
    v_add_u32 v132, s42, v132
    v_mul_u32_u24 v135, 3616, v132
    v_lshl_add_u32 v135, v133, 4, v135
    v_add_u32 v135, 256, v135
    v_add_u32 v134, s6, v132
    s_movk_i32 s42, 3584
    v_mul_lo_u32 v134, v134, s42
    v_lshl_add_u32 v134, v133, 4, v134
    buffer_load_dwordx4 v[76:79], v134, s[12:15], 0 offen offset:0
    buffer_load_dwordx4 v[80:83], v134, s[12:15], 0 offen offset:256
    buffer_load_dwordx4 v[84:87], v134, s[12:15], 0 offen offset:512
    buffer_load_dwordx4 v[88:91], v134, s[12:15], 0 offen offset:768
    buffer_load_dwordx4 v[92:95], v134, s[12:15], 0 offen offset:1024
    buffer_load_dwordx4 v[96:99], v134, s[12:15], 0 offen offset:1280
    buffer_load_dwordx4 v[100:103], v134, s[12:15], 0 offen offset:1536
    buffer_load_dwordx4 v[104:107], v134, s[12:15], 0 offen offset:1792
    buffer_load_dwordx4 v[108:111], v134, s[12:15], 0 offen offset:2048
    buffer_load_dwordx4 v[112:115], v134, s[12:15], 0 offen offset:2304
    buffer_load_dwordx4 v[116:119], v134, s[12:15], 0 offen offset:2560
    buffer_load_dwordx4 v[120:123], v134, s[12:15], 0 offen offset:2816
    buffer_load_dwordx4 v[124:127], v134, s[12:15], 0 offen offset:3072
    buffer_load_dwordx4 v[128:131], v134, s[12:15], 0 offen offset:3328
    v_lshlrev_b32 v6, 4, v1
    s_mov_b32 s43, 0
    s_cmp_eq_u32 s3, 1
    s_cselect_b32 s43, 1, s43
    s_cmp_eq_u32 s3, 2
    s_cselect_b32 s43, 2, s43
    s_cmp_eq_u32 s3, 3
    s_cselect_b32 s43, 3, s43
    s_cmp_eq_u32 s3, 4
    s_cselect_b32 s43, 4, s43
    s_cmp_eq_u32 s3, 5
    s_cselect_b32 s43, 5, s43
    s_cmp_eq_u32 s3, 6
    s_cselect_b32 s43, 6, s43
    s_mul_i32 s48, s5, 7
    s_add_u32 s48, s48, s43
    s_mul_i32 s48, s48, 57344
    s_add_u32 s48, s48, 0x3fe000
    s_barrier
    buffer_load_dwordx4 v[12:15], v6, s[8:11], s48 offen offset:0
    buffer_load_dwordx4 v[16:19], v6, s[8:11], s48 offen offset:1024
    buffer_load_dwordx4 v[20:23], v6, s[8:11], s48 offen offset:2048
    buffer_load_dwordx4 v[24:27], v6, s[8:11], s48 offen offset:3072
    s_add_u32 s49, s48, 0x1000
    buffer_load_dwordx4 v[28:31], v6, s[8:11], s49 offen offset:0
    s_add_u32 s49, s48, 0x1000
    buffer_load_dwordx4 v[32:35], v6, s[8:11], s49 offen offset:1024
    s_add_u32 s49, s48, 0x1000
    buffer_load_dwordx4 v[36:39], v6, s[8:11], s49 offen offset:2048
    s_add_u32 s49, s48, 0x1000
    buffer_load_dwordx4 v[40:43], v6, s[8:11], s49 offen offset:3072
    s_add_u32 s49, s48, 0x2000
    buffer_load_dwordx4 v[44:47], v6, s[8:11], s49 offen offset:0
    s_add_u32 s49, s48, 0x2000
    buffer_load_dwordx4 v[48:51], v6, s[8:11], s49 offen offset:1024
    s_add_u32 s49, s48, 0x2000
    buffer_load_dwordx4 v[52:55], v6, s[8:11], s49 offen offset:2048
    s_add_u32 s49, s48, 0x2000
    buffer_load_dwordx4 v[56:59], v6, s[8:11], s49 offen offset:3072
    s_add_u32 s49, s48, 0x3000
    buffer_load_dwordx4 v[60:63], v6, s[8:11], s49 offen offset:0
    s_add_u32 s49, s48, 0x3000
    buffer_load_dwordx4 v[64:67], v6, s[8:11], s49 offen offset:1024
    s_add_u32 s49, s48, 0x3000
    buffer_load_dwordx4 v[68:71], v6, s[8:11], s49 offen offset:2048
    s_add_u32 s49, s48, 0x3000
    buffer_load_dwordx4 v[72:75], v6, s[8:11], s49 offen offset:3072
    s_waitcnt vmcnt(16)
    ds_write_b128 v135, v[76:79] offset:0
    ds_write_b128 v135, v[80:83] offset:256
    ds_write_b128 v135, v[84:87] offset:512
    ds_write_b128 v135, v[88:91] offset:768
    ds_write_b128 v135, v[92:95] offset:1024
    ds_write_b128 v135, v[96:99] offset:1280
    ds_write_b128 v135, v[100:103] offset:1536
    ds_write_b128 v135, v[104:107] offset:1792
    ds_write_b128 v135, v[108:111] offset:2048
    ds_write_b128 v135, v[112:115] offset:2304
    ds_write_b128 v135, v[116:119] offset:2560
    ds_write_b128 v135, v[120:123] offset:2816
    ds_write_b128 v135, v[124:127] offset:3072
    ds_write_b128 v135, v[128:131] offset:3328
    s_waitcnt lgkmcnt(0)
    s_barrier
    v_mul_u32_u24 v7, 3616, v2
    v_lshl_add_u32 v7, v3, 4, v7
    v_add_u32 v7, 256, v7
    s_movk_i32 s42, 896
    v_mul_lo_u32 v8, v2, s42
    v_lshl_add_u32 v8, v3, 3, v8
    v_lshlrev_b32 v9, 3, v2
    s_cmp_eq_u32 s3, 0
    s_cbranch_scc1 L_w40_kernel_var_1
    s_cmp_eq_u32 s3, 1
    s_cbranch_scc1 L_w40_kernel_var_1
    s_cmp_eq_u32 s3, 2
    s_cbranch_scc1 L_w40_kernel_var_1
    s_cmp_eq_u32 s3, 3
    s_cbranch_scc1 L_w40_kernel_var_1
    s_cmp_eq_u32 s3, 4
    s_cbranch_scc1 L_w40_kernel_var_1
    s_cmp_eq_u32 s3, 5
    s_cbranch_scc1 L_w40_kernel_var_1
    s_cmp_eq_u32 s3, 6
    s_cbranch_scc1 L_w40_kernel_var_1
    s_branch L_w40_kernel_end
L_w40_kernel_var_1:
    s_nop 4
    v_mov_b32 v76, 0
    v_mov_b32 v77, 0
    v_mov_b32 v78, 0
    v_mov_b32 v79, 0
    v_mov_b32 v80, 0
    v_mov_b32 v81, 0
    v_mov_b32 v82, 0
    v_mov_b32 v83, 0
    s_mul_i32 s50, s6, 896
    s_mul_i32 s51, s5, 224
    s_add_u32 s50, s50, s51
    s_lshl_b32 s51, s43, 5
    s_add_u32 s50, s50, s51
    buffer_load_dwordx2 v[100:101], v8, s[20:23], s50 offen offset:0
    buffer_load_dwordx2 v[102:103], v8, s[24:27], s50 offen offset:0
    s_add_u32 s52, s50, 14336
    buffer_load_dwordx2 v[104:105], v8, s[20:23], s52 offen offset:0
    buffer_load_dwordx2 v[106:107], v8, s[24:27], s52 offen offset:0
    ds_read_b128 v[84:87], v7 offset:0
    ds_read_b128 v[88:91], v7 offset:57856
    ds_read_b128 v[92:95], v7 offset:64
    ds_read_b128 v[96:99], v7 offset:57920
    s_waitcnt lgkmcnt(2)
    s_waitcnt vmcnt(19)
    v_mfma_f32_16x16x32_bf16 v[76:79], v[12:15], v[84:87], v[76:79]
    v_mfma_f32_16x16x32_bf16 v[80:83], v[12:15], v[88:91], v[80:83]
    s_add_u32 s49, s48, 0x4000
    buffer_load_dwordx4 v[12:15], v6, s[8:11], s49 offen offset:0
    ds_read_b128 v[84:87], v7 offset:128
    ds_read_b128 v[88:91], v7 offset:57984
    s_waitcnt lgkmcnt(2)
    s_waitcnt vmcnt(19)
    v_mfma_f32_16x16x32_bf16 v[76:79], v[16:19], v[92:95], v[76:79]
    v_mfma_f32_16x16x32_bf16 v[80:83], v[16:19], v[96:99], v[80:83]
    s_add_u32 s49, s48, 0x4000
    buffer_load_dwordx4 v[16:19], v6, s[8:11], s49 offen offset:1024
    ds_read_b128 v[92:95], v7 offset:192
    ds_read_b128 v[96:99], v7 offset:58048
    s_waitcnt lgkmcnt(2)
    s_waitcnt vmcnt(19)
    v_mfma_f32_16x16x32_bf16 v[76:79], v[20:23], v[84:87], v[76:79]
    v_mfma_f32_16x16x32_bf16 v[80:83], v[20:23], v[88:91], v[80:83]
    s_add_u32 s49, s48, 0x4000
    buffer_load_dwordx4 v[20:23], v6, s[8:11], s49 offen offset:2048
    ds_read_b128 v[84:87], v7 offset:256
    ds_read_b128 v[88:91], v7 offset:58112
    s_waitcnt lgkmcnt(2)
    s_waitcnt vmcnt(19)
    v_mfma_f32_16x16x32_bf16 v[76:79], v[24:27], v[92:95], v[76:79]
    v_mfma_f32_16x16x32_bf16 v[80:83], v[24:27], v[96:99], v[80:83]
    s_add_u32 s49, s48, 0x4000
    buffer_load_dwordx4 v[24:27], v6, s[8:11], s49 offen offset:3072
    ds_read_b128 v[92:95], v7 offset:320
    ds_read_b128 v[96:99], v7 offset:58176
    s_waitcnt lgkmcnt(2)
    s_waitcnt vmcnt(19)
    v_mfma_f32_16x16x32_bf16 v[76:79], v[28:31], v[84:87], v[76:79]
    v_mfma_f32_16x16x32_bf16 v[80:83], v[28:31], v[88:91], v[80:83]
    s_add_u32 s49, s48, 0x5000
    buffer_load_dwordx4 v[28:31], v6, s[8:11], s49 offen offset:0
    ds_read_b128 v[84:87], v7 offset:384
    ds_read_b128 v[88:91], v7 offset:58240
    s_waitcnt lgkmcnt(2)
    s_waitcnt vmcnt(19)
    v_mfma_f32_16x16x32_bf16 v[76:79], v[32:35], v[92:95], v[76:79]
    v_mfma_f32_16x16x32_bf16 v[80:83], v[32:35], v[96:99], v[80:83]
    s_add_u32 s49, s48, 0x5000
    buffer_load_dwordx4 v[32:35], v6, s[8:11], s49 offen offset:1024
    ds_read_b128 v[92:95], v7 offset:448
    ds_read_b128 v[96:99], v7 offset:58304
    s_waitcnt lgkmcnt(2)
    s_waitcnt vmcnt(19)
    v_mfma_f32_16x16x32_bf16 v[76:79], v[36:39], v[84:87], v[76:79]
    v_mfma_f32_16x16x32_bf16 v[80:83], v[36:39], v[88:91], v[80:83]
    s_add_u32 s49, s48, 0x5000
    buffer_load_dwordx4 v[36:39], v6, s[8:11], s49 offen offset:2048
    ds_read_b128 v[84:87], v7 offset:512
    ds_read_b128 v[88:91], v7 offset:58368
    s_waitcnt lgkmcnt(2)
    s_waitcnt vmcnt(19)
    v_mfma_f32_16x16x32_bf16 v[76:79], v[40:43], v[92:95], v[76:79]
    v_mfma_f32_16x16x32_bf16 v[80:83], v[40:43], v[96:99], v[80:83]
    s_add_u32 s49, s48, 0x5000
    buffer_load_dwordx4 v[40:43], v6, s[8:11], s49 offen offset:3072
    ds_read_b128 v[92:95], v7 offset:576
    ds_read_b128 v[96:99], v7 offset:58432
    s_waitcnt lgkmcnt(2)
    s_waitcnt vmcnt(19)
    v_mfma_f32_16x16x32_bf16 v[76:79], v[44:47], v[84:87], v[76:79]
    v_mfma_f32_16x16x32_bf16 v[80:83], v[44:47], v[88:91], v[80:83]
    s_add_u32 s49, s48, 0x6000
    buffer_load_dwordx4 v[44:47], v6, s[8:11], s49 offen offset:0
    ds_read_b128 v[84:87], v7 offset:640
    ds_read_b128 v[88:91], v7 offset:58496
    s_waitcnt lgkmcnt(2)
    s_waitcnt vmcnt(19)
    v_mfma_f32_16x16x32_bf16 v[76:79], v[48:51], v[92:95], v[76:79]
    v_mfma_f32_16x16x32_bf16 v[80:83], v[48:51], v[96:99], v[80:83]
    s_add_u32 s49, s48, 0x6000
    buffer_load_dwordx4 v[48:51], v6, s[8:11], s49 offen offset:1024
    ds_read_b128 v[92:95], v7 offset:704
    ds_read_b128 v[96:99], v7 offset:58560
    s_waitcnt lgkmcnt(2)
    s_waitcnt vmcnt(19)
    v_mfma_f32_16x16x32_bf16 v[76:79], v[52:55], v[84:87], v[76:79]
    v_mfma_f32_16x16x32_bf16 v[80:83], v[52:55], v[88:91], v[80:83]
    s_add_u32 s49, s48, 0x6000
    buffer_load_dwordx4 v[52:55], v6, s[8:11], s49 offen offset:2048
    ds_read_b128 v[84:87], v7 offset:768
    ds_read_b128 v[88:91], v7 offset:58624
    s_waitcnt lgkmcnt(2)
    s_waitcnt vmcnt(19)
    v_mfma_f32_16x16x32_bf16 v[76:79], v[56:59], v[92:95], v[76:79]
    v_mfma_f32_16x16x32_bf16 v[80:83], v[56:59], v[96:99], v[80:83]
    s_add_u32 s49, s48, 0x6000
    buffer_load_dwordx4 v[56:59], v6, s[8:11], s49 offen offset:3072
    ds_read_b128 v[92:95], v7 offset:832
    ds_read_b128 v[96:99], v7 offset:58688
    s_waitcnt lgkmcnt(2)
    s_waitcnt vmcnt(19)
    v_mfma_f32_16x16x32_bf16 v[76:79], v[60:63], v[84:87], v[76:79]
    v_mfma_f32_16x16x32_bf16 v[80:83], v[60:63], v[88:91], v[80:83]
    s_add_u32 s49, s48, 0x7000
    buffer_load_dwordx4 v[60:63], v6, s[8:11], s49 offen offset:0
    ds_read_b128 v[84:87], v7 offset:896
    ds_read_b128 v[88:91], v7 offset:58752
    s_waitcnt lgkmcnt(2)
    s_waitcnt vmcnt(19)
    v_mfma_f32_16x16x32_bf16 v[76:79], v[64:67], v[92:95], v[76:79]
    v_mfma_f32_16x16x32_bf16 v[80:83], v[64:67], v[96:99], v[80:83]
    s_add_u32 s49, s48, 0x7000
    buffer_load_dwordx4 v[64:67], v6, s[8:11], s49 offen offset:1024
    ds_read_b128 v[92:95], v7 offset:960
    ds_read_b128 v[96:99], v7 offset:58816
    s_waitcnt lgkmcnt(2)
    s_waitcnt vmcnt(19)
    v_mfma_f32_16x16x32_bf16 v[76:79], v[68:71], v[84:87], v[76:79]
    v_mfma_f32_16x16x32_bf16 v[80:83], v[68:71], v[88:91], v[80:83]
    s_add_u32 s49, s48, 0x7000
    buffer_load_dwordx4 v[68:71], v6, s[8:11], s49 offen offset:2048
    ds_read_b128 v[84:87], v7 offset:1024
    ds_read_b128 v[88:91], v7 offset:58880
    s_waitcnt lgkmcnt(2)
    s_waitcnt vmcnt(19)
    v_mfma_f32_16x16x32_bf16 v[76:79], v[72:75], v[92:95], v[76:79]
    v_mfma_f32_16x16x32_bf16 v[80:83], v[72:75], v[96:99], v[80:83]
    s_add_u32 s49, s48, 0x7000
    buffer_load_dwordx4 v[72:75], v6, s[8:11], s49 offen offset:3072
    ds_read_b128 v[92:95], v7 offset:1088
    ds_read_b128 v[96:99], v7 offset:58944
    s_waitcnt lgkmcnt(2)
    s_waitcnt vmcnt(15)
    v_mfma_f32_16x16x32_bf16 v[76:79], v[12:15], v[84:87], v[76:79]
    v_mfma_f32_16x16x32_bf16 v[80:83], v[12:15], v[88:91], v[80:83]
    s_add_u32 s49, s48, 0x8000
    buffer_load_dwordx4 v[12:15], v6, s[8:11], s49 offen offset:0
    ds_read_b128 v[84:87], v7 offset:1152
    ds_read_b128 v[88:91], v7 offset:59008
    s_waitcnt lgkmcnt(2)
    s_waitcnt vmcnt(15)
    v_mfma_f32_16x16x32_bf16 v[76:79], v[16:19], v[92:95], v[76:79]
    v_mfma_f32_16x16x32_bf16 v[80:83], v[16:19], v[96:99], v[80:83]
    s_add_u32 s49, s48, 0x8000
    buffer_load_dwordx4 v[16:19], v6, s[8:11], s49 offen offset:1024
    ds_read_b128 v[92:95], v7 offset:1216
    ds_read_b128 v[96:99], v7 offset:59072
    s_waitcnt lgkmcnt(2)
    s_waitcnt vmcnt(15)
    v_mfma_f32_16x16x32_bf16 v[76:79], v[20:23], v[84:87], v[76:79]
    v_mfma_f32_16x16x32_bf16 v[80:83], v[20:23], v[88:91], v[80:83]
    s_add_u32 s49, s48, 0x8000
    buffer_load_dwordx4 v[20:23], v6, s[8:11], s49 offen offset:2048
    ds_read_b128 v[84:87], v7 offset:1280
    ds_read_b128 v[88:91], v7 offset:59136
    s_waitcnt lgkmcnt(2)
    s_waitcnt vmcnt(15)
    v_mfma_f32_16x16x32_bf16 v[76:79], v[24:27], v[92:95], v[76:79]
    v_mfma_f32_16x16x32_bf16 v[80:83], v[24:27], v[96:99], v[80:83]
    s_add_u32 s49, s48, 0x8000
    buffer_load_dwordx4 v[24:27], v6, s[8:11], s49 offen offset:3072
    ds_read_b128 v[92:95], v7 offset:1344
    ds_read_b128 v[96:99], v7 offset:59200
    s_waitcnt lgkmcnt(2)
    s_waitcnt vmcnt(15)
    v_mfma_f32_16x16x32_bf16 v[76:79], v[28:31], v[84:87], v[76:79]
    v_mfma_f32_16x16x32_bf16 v[80:83], v[28:31], v[88:91], v[80:83]
    s_add_u32 s49, s48, 0x9000
    buffer_load_dwordx4 v[28:31], v6, s[8:11], s49 offen offset:0
    ds_read_b128 v[84:87], v7 offset:1408
    ds_read_b128 v[88:91], v7 offset:59264
    s_waitcnt lgkmcnt(2)
    s_waitcnt vmcnt(15)
    v_mfma_f32_16x16x32_bf16 v[76:79], v[32:35], v[92:95], v[76:79]
    v_mfma_f32_16x16x32_bf16 v[80:83], v[32:35], v[96:99], v[80:83]
    s_add_u32 s49, s48, 0x9000
    buffer_load_dwordx4 v[32:35], v6, s[8:11], s49 offen offset:1024
    ds_read_b128 v[92:95], v7 offset:1472
    ds_read_b128 v[96:99], v7 offset:59328
    s_waitcnt lgkmcnt(2)
    s_waitcnt vmcnt(15)
    v_mfma_f32_16x16x32_bf16 v[76:79], v[36:39], v[84:87], v[76:79]
    v_mfma_f32_16x16x32_bf16 v[80:83], v[36:39], v[88:91], v[80:83]
    s_add_u32 s49, s48, 0x9000
    buffer_load_dwordx4 v[36:39], v6, s[8:11], s49 offen offset:2048
    ds_read_b128 v[84:87], v7 offset:1536
    ds_read_b128 v[88:91], v7 offset:59392
    s_waitcnt lgkmcnt(2)
    s_waitcnt vmcnt(15)
    v_mfma_f32_16x16x32_bf16 v[76:79], v[40:43], v[92:95], v[76:79]
    v_mfma_f32_16x16x32_bf16 v[80:83], v[40:43], v[96:99], v[80:83]
    s_add_u32 s49, s48, 0x9000
    buffer_load_dwordx4 v[40:43], v6, s[8:11], s49 offen offset:3072
    ds_read_b128 v[92:95], v7 offset:1600
    ds_read_b128 v[96:99], v7 offset:59456
    s_waitcnt lgkmcnt(2)
    s_waitcnt vmcnt(15)
    v_mfma_f32_16x16x32_bf16 v[76:79], v[44:47], v[84:87], v[76:79]
    v_mfma_f32_16x16x32_bf16 v[80:83], v[44:47], v[88:91], v[80:83]
    s_add_u32 s49, s48, 0xa000
    buffer_load_dwordx4 v[44:47], v6, s[8:11], s49 offen offset:0
    ds_read_b128 v[84:87], v7 offset:1664
    ds_read_b128 v[88:91], v7 offset:59520
    s_waitcnt lgkmcnt(2)
    s_waitcnt vmcnt(15)
    v_mfma_f32_16x16x32_bf16 v[76:79], v[48:51], v[92:95], v[76:79]
    v_mfma_f32_16x16x32_bf16 v[80:83], v[48:51], v[96:99], v[80:83]
    s_add_u32 s49, s48, 0xa000
    buffer_load_dwordx4 v[48:51], v6, s[8:11], s49 offen offset:1024
    ds_read_b128 v[92:95], v7 offset:1728
    ds_read_b128 v[96:99], v7 offset:59584
    s_waitcnt lgkmcnt(2)
    s_waitcnt vmcnt(15)
    v_mfma_f32_16x16x32_bf16 v[76:79], v[52:55], v[84:87], v[76:79]
    v_mfma_f32_16x16x32_bf16 v[80:83], v[52:55], v[88:91], v[80:83]
    s_add_u32 s49, s48, 0xa000
    buffer_load_dwordx4 v[52:55], v6, s[8:11], s49 offen offset:2048
    ds_read_b128 v[84:87], v7 offset:1792
    ds_read_b128 v[88:91], v7 offset:59648
    s_waitcnt lgkmcnt(2)
    s_waitcnt vmcnt(15)
    v_mfma_f32_16x16x32_bf16 v[76:79], v[56:59], v[92:95], v[76:79]
    v_mfma_f32_16x16x32_bf16 v[80:83], v[56:59], v[96:99], v[80:83]
    s_add_u32 s49, s48, 0xa000
    buffer_load_dwordx4 v[56:59], v6, s[8:11], s49 offen offset:3072
    ds_read_b128 v[92:95], v7 offset:1856
    ds_read_b128 v[96:99], v7 offset:59712
    s_waitcnt lgkmcnt(2)
    s_waitcnt vmcnt(15)
    v_mfma_f32_16x16x32_bf16 v[76:79], v[60:63], v[84:87], v[76:79]
    v_mfma_f32_16x16x32_bf16 v[80:83], v[60:63], v[88:91], v[80:83]
    s_add_u32 s49, s48, 0xb000
    buffer_load_dwordx4 v[60:63], v6, s[8:11], s49 offen offset:0
    ds_read_b128 v[84:87], v7 offset:1920
    ds_read_b128 v[88:91], v7 offset:59776
    s_waitcnt lgkmcnt(2)
    s_waitcnt vmcnt(15)
    v_mfma_f32_16x16x32_bf16 v[76:79], v[64:67], v[92:95], v[76:79]
    v_mfma_f32_16x16x32_bf16 v[80:83], v[64:67], v[96:99], v[80:83]
    s_add_u32 s49, s48, 0xb000
    buffer_load_dwordx4 v[64:67], v6, s[8:11], s49 offen offset:1024
    ds_read_b128 v[92:95], v7 offset:1984
    ds_read_b128 v[96:99], v7 offset:59840
    s_waitcnt lgkmcnt(2)
    s_waitcnt vmcnt(15)
    v_mfma_f32_16x16x32_bf16 v[76:79], v[68:71], v[84:87], v[76:79]
    v_mfma_f32_16x16x32_bf16 v[80:83], v[68:71], v[88:91], v[80:83]
    s_add_u32 s49, s48, 0xb000
    buffer_load_dwordx4 v[68:71], v6, s[8:11], s49 offen offset:2048
    ds_read_b128 v[84:87], v7 offset:2048
    ds_read_b128 v[88:91], v7 offset:59904
    s_waitcnt lgkmcnt(2)
    s_waitcnt vmcnt(15)
    v_mfma_f32_16x16x32_bf16 v[76:79], v[72:75], v[92:95], v[76:79]
    v_mfma_f32_16x16x32_bf16 v[80:83], v[72:75], v[96:99], v[80:83]
    s_add_u32 s49, s48, 0xb000
    buffer_load_dwordx4 v[72:75], v6, s[8:11], s49 offen offset:3072
    ds_read_b128 v[92:95], v7 offset:2112
    ds_read_b128 v[96:99], v7 offset:59968
    s_waitcnt lgkmcnt(2)
    s_waitcnt vmcnt(15)
    v_mfma_f32_16x16x32_bf16 v[76:79], v[12:15], v[84:87], v[76:79]
    v_mfma_f32_16x16x32_bf16 v[80:83], v[12:15], v[88:91], v[80:83]
    s_add_u32 s49, s48, 0xc000
    buffer_load_dwordx4 v[12:15], v6, s[8:11], s49 offen offset:0
    ds_read_b128 v[84:87], v7 offset:2176
    ds_read_b128 v[88:91], v7 offset:60032
    s_waitcnt lgkmcnt(2)
    s_waitcnt vmcnt(15)
    v_mfma_f32_16x16x32_bf16 v[76:79], v[16:19], v[92:95], v[76:79]
    v_mfma_f32_16x16x32_bf16 v[80:83], v[16:19], v[96:99], v[80:83]
    s_add_u32 s49, s48, 0xc000
    buffer_load_dwordx4 v[16:19], v6, s[8:11], s49 offen offset:1024
    ds_read_b128 v[92:95], v7 offset:2240
    ds_read_b128 v[96:99], v7 offset:60096
    s_waitcnt lgkmcnt(2)
    s_waitcnt vmcnt(15)
    v_mfma_f32_16x16x32_bf16 v[76:79], v[20:23], v[84:87], v[76:79]
    v_mfma_f32_16x16x32_bf16 v[80:83], v[20:23], v[88:91], v[80:83]
    s_add_u32 s49, s48, 0xc000
    buffer_load_dwordx4 v[20:23], v6, s[8:11], s49 offen offset:2048
    ds_read_b128 v[84:87], v7 offset:2304
    ds_read_b128 v[88:91], v7 offset:60160
    s_waitcnt lgkmcnt(2)
    s_waitcnt vmcnt(15)
    v_mfma_f32_16x16x32_bf16 v[76:79], v[24:27], v[92:95], v[76:79]
    v_mfma_f32_16x16x32_bf16 v[80:83], v[24:27], v[96:99], v[80:83]
    s_add_u32 s49, s48, 0xc000
    buffer_load_dwordx4 v[24:27], v6, s[8:11], s49 offen offset:3072
    ds_read_b128 v[92:95], v7 offset:2368
    ds_read_b128 v[96:99], v7 offset:60224
    s_waitcnt lgkmcnt(2)
    s_waitcnt vmcnt(15)
    v_mfma_f32_16x16x32_bf16 v[76:79], v[28:31], v[84:87], v[76:79]
    v_mfma_f32_16x16x32_bf16 v[80:83], v[28:31], v[88:91], v[80:83]
    s_add_u32 s49, s48, 0xd000
    buffer_load_dwordx4 v[28:31], v6, s[8:11], s49 offen offset:0
    ds_read_b128 v[84:87], v7 offset:2432
    ds_read_b128 v[88:91], v7 offset:60288
    s_waitcnt lgkmcnt(2)
    s_waitcnt vmcnt(15)
    v_mfma_f32_16x16x32_bf16 v[76:79], v[32:35], v[92:95], v[76:79]
    v_mfma_f32_16x16x32_bf16 v[80:83], v[32:35], v[96:99], v[80:83]
    s_add_u32 s49, s48, 0xd000
    buffer_load_dwordx4 v[32:35], v6, s[8:11], s49 offen offset:1024
    ds_read_b128 v[92:95], v7 offset:2496
    ds_read_b128 v[96:99], v7 offset:60352
    s_waitcnt lgkmcnt(2)
    s_waitcnt vmcnt(15)
    v_mfma_f32_16x16x32_bf16 v[76:79], v[36:39], v[84:87], v[76:79]
    v_mfma_f32_16x16x32_bf16 v[80:83], v[36:39], v[88:91], v[80:83]
    s_add_u32 s49, s48, 0xd000
    buffer_load_dwordx4 v[36:39], v6, s[8:11], s49 offen offset:2048
    ds_read_b128 v[84:87], v7 offset:2560
    ds_read_b128 v[88:91], v7 offset:60416
    s_waitcnt lgkmcnt(2)
    s_waitcnt vmcnt(15)
    v_mfma_f32_16x16x32_bf16 v[76:79], v[40:43], v[92:95], v[76:79]
    v_mfma_f32_16x16x32_bf16 v[80:83], v[40:43], v[96:99], v[80:83]
    s_add_u32 s49, s48, 0xd000
    buffer_load_dwordx4 v[40:43], v6, s[8:11], s49 offen offset:3072
    ds_read_b128 v[92:95], v7 offset:2624
    ds_read_b128 v[96:99], v7 offset:60480
    s_waitcnt lgkmcnt(2)
    s_waitcnt vmcnt(15)
    v_mfma_f32_16x16x32_bf16 v[76:79], v[44:47], v[84:87], v[76:79]
    v_mfma_f32_16x16x32_bf16 v[80:83], v[44:47], v[88:91], v[80:83]
    ds_read_b128 v[84:87], v7 offset:2688
    ds_read_b128 v[88:91], v7 offset:60544
    s_waitcnt lgkmcnt(2)
    s_waitcnt vmcnt(14)
    v_mfma_f32_16x16x32_bf16 v[76:79], v[48:51], v[92:95], v[76:79]
    v_mfma_f32_16x16x32_bf16 v[80:83], v[48:51], v[96:99], v[80:83]
    ds_read_b128 v[92:95], v7 offset:2752
    ds_read_b128 v[96:99], v7 offset:60608
    s_waitcnt lgkmcnt(2)
    s_waitcnt vmcnt(13)
    v_mfma_f32_16x16x32_bf16 v[76:79], v[52:55], v[84:87], v[76:79]
    v_mfma_f32_16x16x32_bf16 v[80:83], v[52:55], v[88:91], v[80:83]
    ds_read_b128 v[84:87], v7 offset:2816
    ds_read_b128 v[88:91], v7 offset:60672
    s_waitcnt lgkmcnt(2)
    s_waitcnt vmcnt(12)
    v_mfma_f32_16x16x32_bf16 v[76:79], v[56:59], v[92:95], v[76:79]
    v_mfma_f32_16x16x32_bf16 v[80:83], v[56:59], v[96:99], v[80:83]
    ds_read_b128 v[92:95], v7 offset:2880
    ds_read_b128 v[96:99], v7 offset:60736
    s_waitcnt lgkmcnt(2)
    s_waitcnt vmcnt(11)
    v_mfma_f32_16x16x32_bf16 v[76:79], v[60:63], v[84:87], v[76:79]
    v_mfma_f32_16x16x32_bf16 v[80:83], v[60:63], v[88:91], v[80:83]
    ds_read_b128 v[84:87], v7 offset:2944
    ds_read_b128 v[88:91], v7 offset:60800
    s_waitcnt lgkmcnt(2)
    s_waitcnt vmcnt(10)
    v_mfma_f32_16x16x32_bf16 v[76:79], v[64:67], v[92:95], v[76:79]
    v_mfma_f32_16x16x32_bf16 v[80:83], v[64:67], v[96:99], v[80:83]
    ds_read_b128 v[92:95], v7 offset:3008
    ds_read_b128 v[96:99], v7 offset:60864
    s_waitcnt lgkmcnt(2)
    s_waitcnt vmcnt(9)
    v_mfma_f32_16x16x32_bf16 v[76:79], v[68:71], v[84:87], v[76:79]
    v_mfma_f32_16x16x32_bf16 v[80:83], v[68:71], v[88:91], v[80:83]
    ds_read_b128 v[84:87], v7 offset:3072
    ds_read_b128 v[88:91], v7 offset:60928
    s_waitcnt lgkmcnt(2)
    s_waitcnt vmcnt(8)
    v_mfma_f32_16x16x32_bf16 v[76:79], v[72:75], v[92:95], v[76:79]
    v_mfma_f32_16x16x32_bf16 v[80:83], v[72:75], v[96:99], v[80:83]
    ds_read_b128 v[92:95], v7 offset:3136
    ds_read_b128 v[96:99], v7 offset:60992
    s_waitcnt lgkmcnt(2)
    s_waitcnt vmcnt(7)
    v_mfma_f32_16x16x32_bf16 v[76:79], v[12:15], v[84:87], v[76:79]
    v_mfma_f32_16x16x32_bf16 v[80:83], v[12:15], v[88:91], v[80:83]
    ds_read_b128 v[84:87], v7 offset:3200
    ds_read_b128 v[88:91], v7 offset:61056
    s_waitcnt lgkmcnt(2)
    s_waitcnt vmcnt(6)
    v_mfma_f32_16x16x32_bf16 v[76:79], v[16:19], v[92:95], v[76:79]
    v_mfma_f32_16x16x32_bf16 v[80:83], v[16:19], v[96:99], v[80:83]
    ds_read_b128 v[92:95], v7 offset:3264
    ds_read_b128 v[96:99], v7 offset:61120
    s_waitcnt lgkmcnt(2)
    s_waitcnt vmcnt(5)
    v_mfma_f32_16x16x32_bf16 v[76:79], v[20:23], v[84:87], v[76:79]
    v_mfma_f32_16x16x32_bf16 v[80:83], v[20:23], v[88:91], v[80:83]
    ds_read_b128 v[84:87], v7 offset:3328
    ds_read_b128 v[88:91], v7 offset:61184
    s_waitcnt lgkmcnt(2)
    s_waitcnt vmcnt(4)
    v_mfma_f32_16x16x32_bf16 v[76:79], v[24:27], v[92:95], v[76:79]
    v_mfma_f32_16x16x32_bf16 v[80:83], v[24:27], v[96:99], v[80:83]
    ds_read_b128 v[92:95], v7 offset:3392
    ds_read_b128 v[96:99], v7 offset:61248
    s_waitcnt lgkmcnt(2)
    s_waitcnt vmcnt(3)
    v_mfma_f32_16x16x32_bf16 v[76:79], v[28:31], v[84:87], v[76:79]
    v_mfma_f32_16x16x32_bf16 v[80:83], v[28:31], v[88:91], v[80:83]
    ds_read_b128 v[84:87], v7 offset:3456
    ds_read_b128 v[88:91], v7 offset:61312
    s_waitcnt lgkmcnt(2)
    s_waitcnt vmcnt(2)
    v_mfma_f32_16x16x32_bf16 v[76:79], v[32:35], v[92:95], v[76:79]
    v_mfma_f32_16x16x32_bf16 v[80:83], v[32:35], v[96:99], v[80:83]
    ds_read_b128 v[92:95], v7 offset:3520
    ds_read_b128 v[96:99], v7 offset:61376
    s_waitcnt lgkmcnt(2)
    s_waitcnt vmcnt(1)
    v_mfma_f32_16x16x32_bf16 v[76:79], v[36:39], v[84:87], v[76:79]
    v_mfma_f32_16x16x32_bf16 v[80:83], v[36:39], v[88:91], v[80:83]
    s_waitcnt lgkmcnt(0)
    s_waitcnt vmcnt(0)
    v_mfma_f32_16x16x32_bf16 v[76:79], v[40:43], v[92:95], v[76:79]
    v_mfma_f32_16x16x32_bf16 v[80:83], v[40:43], v[96:99], v[80:83]
    s_waitcnt vmcnt(40)
    s_nop 5
    v_cvt_pk_bf16_f32 v108, v76, v77
    v_cvt_pk_bf16_f32 v109, v78, v79
    v_lshlrev_b32 v112, 16, v100
    v_and_b32 v113, 0xffff0000, v100
    v_lshlrev_b32 v110, 16, v108
    v_and_b32 v111, 0xffff0000, v108
    v_add_f32 v110, v110, v112
    v_add_f32 v111, v111, v113
    v_cvt_pk_bf16_f32 v108, v110, v111
    v_lshlrev_b32 v112, 16, v101
    v_and_b32 v113, 0xffff0000, v101
    v_lshlrev_b32 v110, 16, v109
    v_and_b32 v111, 0xffff0000, v109
    v_add_f32 v110, v110, v112
    v_add_f32 v111, v111, v113
    v_cvt_pk_bf16_f32 v109, v110, v111
    v_lshlrev_b32 v112, 16, v102
    v_and_b32 v113, 0xffff0000, v102
    v_lshlrev_b32 v110, 16, v108
    v_and_b32 v111, 0xffff0000, v108
    v_add_f32 v110, v110, v112
    v_add_f32 v111, v111, v113
    v_cvt_pk_bf16_f32 v108, v110, v111
    v_lshlrev_b32 v112, 16, v103
    v_and_b32 v113, 0xffff0000, v103
    v_lshlrev_b32 v110, 16, v109
    v_and_b32 v111, 0xffff0000, v109
    v_add_f32 v110, v110, v112
    v_add_f32 v111, v111, v113
    v_cvt_pk_bf16_f32 v109, v110, v111
    buffer_store_dwordx2 v[108:109], v8, s[16:19], s50 offen offset:0
    s_add_u32 s52, s50, 14336
    v_cvt_pk_bf16_f32 v108, v80, v81
    v_cvt_pk_bf16_f32 v109, v82, v83
    v_lshlrev_b32 v112, 16, v104
    v_and_b32 v113, 0xffff0000, v104
    v_lshlrev_b32 v110, 16, v108
    v_and_b32 v111, 0xffff0000, v108
    v_add_f32 v110, v110, v112
    v_add_f32 v111, v111, v113
    v_cvt_pk_bf16_f32 v108, v110, v111
    v_lshlrev_b32 v112, 16, v105
    v_and_b32 v113, 0xffff0000, v105
    v_lshlrev_b32 v110, 16, v109
    v_and_b32 v111, 0xffff0000, v109
    v_add_f32 v110, v110, v112
    v_add_f32 v111, v111, v113
    v_cvt_pk_bf16_f32 v109, v110, v111
    v_lshlrev_b32 v112, 16, v106
    v_and_b32 v113, 0xffff0000, v106
    v_lshlrev_b32 v110, 16, v108
    v_and_b32 v111, 0xffff0000, v108
    v_add_f32 v110, v110, v112
    v_add_f32 v111, v111, v113
    v_cvt_pk_bf16_f32 v108, v110, v111
    v_lshlrev_b32 v112, 16, v107
    v_and_b32 v113, 0xffff0000, v107
    v_lshlrev_b32 v110, 16, v109
    v_and_b32 v111, 0xffff0000, v109
    v_add_f32 v110, v110, v112
    v_add_f32 v111, v111, v113
    v_cvt_pk_bf16_f32 v109, v110, v111
    buffer_store_dwordx2 v[108:109], v8, s[16:19], s52 offen offset:0
    s_branch L_w40_kernel_end
L_w40_kernel_end:
    s_nop 1
L_w40_kernel_done:
    s_endpgm
.globl qkv1_kernel
.p2align 8
.type qkv1_kernel,@function
qkv1_kernel:
    s_cmp_ge_u32 s2, 256
    s_cbranch_scc1 L_qkv1_kernel_done
    s_load_dwordx4 s[32:35], s[0:1], 0
    s_load_dwordx4 s[36:39], s[0:1], 64
    s_load_dwordx2 s[40:41], s[0:1], 80
    v_lshrrev_b32 v4, 6, v0
    v_and_b32 v1, 63, v0
    v_readfirstlane_b32 s3, v4
    s_lshr_b32 s7, s2, 3
    s_mul_hi_u32 s4, s7, 0x20000000
    s_mul_i32 s42, s4, 8
    s_sub_u32 s5, s7, s42
    s_and_b32 s7, s2, 7
    s_mul_i32 s7, s7, 4
    s_add_u32 s4, s4, s7
    s_mul_i32 s6, s4, 64
    v_and_b32 v2, 15, v1
    v_lshrrev_b32 v3, 4, v1
    s_mov_b32 s28, 0x3f803f80
    s_mov_b32 s29, 0x3d372713
    s_mov_b32 s30, 0xc0135761
    s_waitcnt lgkmcnt(0)
    s_mov_b32 s8, s40
    s_mov_b32 s9, s41
    s_and_b32 s9, s9, 0xffff
    s_mov_b32 s10, 0x10000000
    s_mov_b32 s11, 0x00020000
    s_add_u32 s12, s40, 0x1446000
    s_addc_u32 s13, s41, 0
    s_and_b32 s13, s13, 0xffff
    s_mov_b32 s14, 0x1c0000
    s_mov_b32 s15, 0x00020000
    s_add_u32 s16, s40, 0x2306000
    s_addc_u32 s17, s41, 0
    s_and_b32 s17, s17, 0xffff
    s_mov_b32 s18, 0x1c0000
    s_mov_b32 s19, 0x00020000
    v_lshrrev_b32 v184, 3, v1
    v_and_b32 v185, 7, v1
    s_mul_i32 s42, s3, 8
    v_add_u32 v184, s42, v184
    v_mul_u32_u24 v187, 928, v184
    v_lshl_add_u32 v187, v185, 4, v187
    v_add_u32 v187, 32000, v187
    v_add_u32 v186, s6, v184
    v_subrev_u32 v186, 16, v186
    s_movk_i32 s42, 896
    v_mul_lo_u32 v186, v186, s42
    v_lshl_add_u32 v186, v185, 4, v186
    buffer_load_dwordx4 v[128:131], v186, s[12:15], 0 offen offset:0
    buffer_load_dwordx4 v[132:135], v186, s[12:15], 0 offen offset:128
    buffer_load_dwordx4 v[136:139], v186, s[12:15], 0 offen offset:256
    buffer_load_dwordx4 v[140:143], v186, s[12:15], 0 offen offset:384
    buffer_load_dwordx4 v[144:147], v186, s[12:15], 0 offen offset:512
    buffer_load_dwordx4 v[148:151], v186, s[12:15], 0 offen offset:640
    buffer_load_dwordx4 v[152:155], v186, s[12:15], 0 offen offset:768
    v_add_u32 v188, 57344, v186
    buffer_load_dwordx4 v[156:159], v188, s[12:15], 0 offen offset:0
    buffer_load_dwordx4 v[160:163], v188, s[12:15], 0 offen offset:128
    buffer_load_dwordx4 v[164:167], v188, s[12:15], 0 offen offset:256
    buffer_load_dwordx4 v[168:171], v188, s[12:15], 0 offen offset:384
    buffer_load_dwordx4 v[172:175], v188, s[12:15], 0 offen offset:512
    buffer_load_dwordx4 v[176:179], v188, s[12:15], 0 offen offset:640
    buffer_load_dwordx4 v[180:183], v188, s[12:15], 0 offen offset:768
    v_lshlrev_b32 v6, 4, v1
    s_mov_b32 s43, 0
    s_cmp_eq_u32 s3, 0
    s_cselect_b32 s43, 4, s43
    s_cmp_eq_u32 s3, 1
    s_cselect_b32 s43, 6, s43
    s_cmp_eq_u32 s3, 2
    s_cselect_b32 s43, 8, s43
    s_cmp_eq_u32 s3, 3
    s_cselect_b32 s43, 10, s43
    s_cmp_eq_u32 s3, 5
    s_cselect_b32 s43, 1, s43
    s_cmp_eq_u32 s3, 6
    s_cselect_b32 s43, 2, s43
    s_cmp_eq_u32 s3, 7
    s_cselect_b32 s43, 3, s43
    s_mul_i32 s48, s5, 12
    s_add_u32 s48, s48, s43
    s_mul_i32 s48, s48, 14336
    s_add_u32 s48, s48, 0x0
    s_barrier
    buffer_load_dwordx4 v[16:19], v6, s[8:11], s48 offen offset:0
    s_add_u32 s49, s48, 0x3000
    buffer_load_dwordx4 v[72:75], v6, s[8:11], s49 offen offset:2048
    buffer_load_dwordx4 v[20:23], v6, s[8:11], s48 offen offset:1024
    s_add_u32 s49, s48, 0x3000
    buffer_load_dwordx4 v[76:79], v6, s[8:11], s49 offen offset:3072
    buffer_load_dwordx4 v[24:27], v6, s[8:11], s48 offen offset:2048
    s_add_u32 s49, s48, 0x4000
    buffer_load_dwordx4 v[80:83], v6, s[8:11], s49 offen offset:0
    buffer_load_dwordx4 v[28:31], v6, s[8:11], s48 offen offset:3072
    s_add_u32 s49, s48, 0x4000
    buffer_load_dwordx4 v[84:87], v6, s[8:11], s49 offen offset:1024
    s_add_u32 s49, s48, 0x1000
    buffer_load_dwordx4 v[32:35], v6, s[8:11], s49 offen offset:0
    s_add_u32 s49, s48, 0x4000
    buffer_load_dwordx4 v[88:91], v6, s[8:11], s49 offen offset:2048
    s_add_u32 s49, s48, 0x1000
    buffer_load_dwordx4 v[36:39], v6, s[8:11], s49 offen offset:1024
    s_add_u32 s49, s48, 0x4000
    buffer_load_dwordx4 v[92:95], v6, s[8:11], s49 offen offset:3072
    s_add_u32 s49, s48, 0x1000
    buffer_load_dwordx4 v[40:43], v6, s[8:11], s49 offen offset:2048
    s_add_u32 s49, s48, 0x5000
    buffer_load_dwordx4 v[96:99], v6, s[8:11], s49 offen offset:0
    s_add_u32 s49, s48, 0x1000
    buffer_load_dwordx4 v[44:47], v6, s[8:11], s49 offen offset:3072
    s_add_u32 s49, s48, 0x5000
    buffer_load_dwordx4 v[100:103], v6, s[8:11], s49 offen offset:1024
    s_add_u32 s49, s48, 0x2000
    buffer_load_dwordx4 v[48:51], v6, s[8:11], s49 offen offset:0
    s_add_u32 s49, s48, 0x5000
    buffer_load_dwordx4 v[104:107], v6, s[8:11], s49 offen offset:2048
    s_add_u32 s49, s48, 0x2000
    buffer_load_dwordx4 v[52:55], v6, s[8:11], s49 offen offset:1024
    s_add_u32 s49, s48, 0x5000
    buffer_load_dwordx4 v[108:111], v6, s[8:11], s49 offen offset:3072
    s_add_u32 s49, s48, 0x2000
    buffer_load_dwordx4 v[56:59], v6, s[8:11], s49 offen offset:2048
    s_add_u32 s49, s48, 0x6000
    buffer_load_dwordx4 v[112:115], v6, s[8:11], s49 offen offset:0
    s_add_u32 s49, s48, 0x2000
    buffer_load_dwordx4 v[60:63], v6, s[8:11], s49 offen offset:3072
    s_add_u32 s49, s48, 0x6000
    buffer_load_dwordx4 v[116:119], v6, s[8:11], s49 offen offset:1024
    s_add_u32 s49, s48, 0x3000
    buffer_load_dwordx4 v[64:67], v6, s[8:11], s49 offen offset:0
    s_add_u32 s49, s48, 0x6000
    buffer_load_dwordx4 v[120:123], v6, s[8:11], s49 offen offset:2048
    s_add_u32 s49, s48, 0x3000
    buffer_load_dwordx4 v[68:71], v6, s[8:11], s49 offen offset:1024
    s_add_u32 s49, s48, 0x6000
    buffer_load_dwordx4 v[124:127], v6, s[8:11], s49 offen offset:3072
    s_waitcnt vmcnt(35)
    v_mov_b32 v194, 0
    v_mov_b32 v195, 0
    v_mov_b32 v198, 0
    v_mov_b32 v199, 0
    v_dot2_f32_bf16 v194, v128, s28, v194
    v_dot2_f32_bf16 v195, v128, v128, v195
    v_dot2_f32_bf16 v198, v129, s28, v198
    v_dot2_f32_bf16 v199, v129, v129, v199
    v_dot2_f32_bf16 v194, v130, s28, v194
    v_dot2_f32_bf16 v195, v130, v130, v195
    v_dot2_f32_bf16 v198, v131, s28, v198
    v_dot2_f32_bf16 v199, v131, v131, v199
    v_dot2_f32_bf16 v194, v132, s28, v194
    v_dot2_f32_bf16 v195, v132, v132, v195
    v_dot2_f32_bf16 v198, v133, s28, v198
    v_dot2_f32_bf16 v199, v133, v133, v199
    v_dot2_f32_bf16 v194, v134, s28, v194
    v_dot2_f32_bf16 v195, v134, v134, v195
    v_dot2_f32_bf16 v198, v135, s28, v198
    v_dot2_f32_bf16 v199, v135, v135, v199
    v_dot2_f32_bf16 v194, v136, s28, v194
    v_dot2_f32_bf16 v195, v136, v136, v195
    v_dot2_f32_bf16 v198, v137, s28, v198
    v_dot2_f32_bf16 v199, v137, v137, v199
    v_dot2_f32_bf16 v194, v138, s28, v194
    v_dot2_f32_bf16 v195, v138, v138, v195
    v_dot2_f32_bf16 v198, v139, s28, v198
    v_dot2_f32_bf16 v199, v139, v139, v199
    v_dot2_f32_bf16 v194, v140, s28, v194
    v_dot2_f32_bf16 v195, v140, v140, v195
    v_dot2_f32_bf16 v198, v141, s28, v198
    v_dot2_f32_bf16 v199, v141, v141, v199
    v_dot2_f32_bf16 v194, v142, s28, v194
    v_dot2_f32_bf16 v195, v142, v142, v195
    v_dot2_f32_bf16 v198, v143, s28, v198
    v_dot2_f32_bf16 v199, v143, v143, v199
    v_dot2_f32_bf16 v194, v144, s28, v194
    v_dot2_f32_bf16 v195, v144, v144, v195
    v_dot2_f32_bf16 v198, v145, s28, v198
    v_dot2_f32_bf16 v199, v145, v145, v199
    v_dot2_f32_bf16 v194, v146, s28, v194
    v_dot2_f32_bf16 v195, v146, v146, v195
    v_dot2_f32_bf16 v198, v147, s28, v198
    v_dot2_f32_bf16 v199, v147, v147, v199
    v_dot2_f32_bf16 v194, v148, s28, v194
    v_dot2_f32_bf16 v195, v148, v148, v195
    v_dot2_f32_bf16 v198, v149, s28, v198
    v_dot2_f32_bf16 v199, v149, v149, v199
    v_dot2_f32_bf16 v194, v150, s28, v194
    v_dot2_f32_bf16 v195, v150, v150, v195
    v_dot2_f32_bf16 v198, v151, s28, v198
    v_dot2_f32_bf16 v199, v151, v151, v199
    v_dot2_f32_bf16 v194, v152, s28, v194
    v_dot2_f32_bf16 v195, v152, v152, v195
    v_dot2_f32_bf16 v198, v153, s28, v198
    v_dot2_f32_bf16 v199, v153, v153, v199
    v_dot2_f32_bf16 v194, v154, s28, v194
    v_dot2_f32_bf16 v195, v154, v154, v195
    v_dot2_f32_bf16 v198, v155, s28, v198
    v_dot2_f32_bf16 v199, v155, v155, v199
    s_nop 1
    v_add_f32 v194, v194, v198
    v_add_f32 v195, v195, v199
    s_nop 0
    v_add_f32_dpp v196, v194, v194 quad_perm:[1,0,3,2] row_mask:0xf bank_mask:0xf
    s_nop 1
    v_add_f32_dpp v194, v196, v196 quad_perm:[2,3,0,1] row_mask:0xf bank_mask:0xf
    s_nop 1
    v_add_f32_dpp v196, v194, v194 row_half_mirror row_mask:0xf bank_mask:0xf
    v_mov_b32 v194, v196
    v_add_f32_dpp v196, v195, v195 quad_perm:[1,0,3,2] row_mask:0xf bank_mask:0xf
    s_nop 1
    v_add_f32_dpp v195, v196, v196 quad_perm:[2,3,0,1] row_mask:0xf bank_mask:0xf
    s_nop 1
    v_add_f32_dpp v196, v195, v195 row_half_mirror row_mask:0xf bank_mask:0xf
    v_mov_b32 v195, v196
    v_mul_f32 v194, 0x3b124925, v194
    v_mul_f32 v195, 0x3b124925, v195
    v_fma_f32 v195, -v194, v194, v195
    v_max_f32 v195, 0, v195
    v_cvt_pk_bf16_f32 v196, v194, v194
    v_lshlrev_b32 v192, 16, v196
    v_cvt_pk_bf16_f32 v196, v195, v195
    v_lshlrev_b32 v197, 16, v196
    v_add_f32 v197, 0x3727c5ac, v197
    v_cvt_pk_bf16_f32 v196, v197, v197
    v_lshlrev_b32 v197, 16, v196
    v_sqrt_f32 v197, v197
    s_nop 0
    v_cvt_pk_bf16_f32 v196, v197, v197
    v_lshlrev_b32 v197, 16, v196
    v_rcp_f32 v193, v197
    s_nop 0
    v_fma_f32 v196, -v197, v193, 2.0
    v_mul_f32 v193, v193, v196
    v_mov_b32 v190, v193
    v_mul_f32 v191, v192, v193
    v_lshlrev_b32 v200, 3, v184
    ds_write_b64 v200, v[190:191] offset:0
    ds_write_b128 v187, v[128:131] offset:0
    ds_write_b128 v187, v[132:135] offset:128
    ds_write_b128 v187, v[136:139] offset:256
    ds_write_b128 v187, v[140:143] offset:384
    ds_write_b128 v187, v[144:147] offset:512
    ds_write_b128 v187, v[148:151] offset:640
    ds_write_b128 v187, v[152:155] offset:768
    s_cmp_ge_u32 s3, 2
    s_cbranch_scc1 L_qkv1_kernel_nohalo_1
    s_waitcnt vmcnt(28)
    v_mov_b32 v194, 0
    v_mov_b32 v195, 0
    v_mov_b32 v198, 0
    v_mov_b32 v199, 0
    v_dot2_f32_bf16 v194, v156, s28, v194
    v_dot2_f32_bf16 v195, v156, v156, v195
    v_dot2_f32_bf16 v198, v157, s28, v198
    v_dot2_f32_bf16 v199, v157, v157, v199
    v_dot2_f32_bf16 v194, v158, s28, v194
    v_dot2_f32_bf16 v195, v158, v158, v195
    v_dot2_f32_bf16 v198, v159, s28, v198
    v_dot2_f32_bf16 v199, v159, v159, v199
    v_dot2_f32_bf16 v194, v160, s28, v194
    v_dot2_f32_bf16 v195, v160, v160, v195
    v_dot2_f32_bf16 v198, v161, s28, v198
    v_dot2_f32_bf16 v199, v161, v161, v199
    v_dot2_f32_bf16 v194, v162, s28, v194
    v_dot2_f32_bf16 v195, v162, v162, v195
    v_dot2_f32_bf16 v198, v163, s28, v198
    v_dot2_f32_bf16 v199, v163, v163, v199
    v_dot2_f32_bf16 v194, v164, s28, v194
    v_dot2_f32_bf16 v195, v164, v164, v195
    v_dot2_f32_bf16 v198, v165, s28, v198
    v_dot2_f32_bf16 v199, v165, v165, v199
    v_dot2_f32_bf16 v194, v166, s28, v194
    v_dot2_f32_bf16 v195, v166, v166, v195
    v_dot2_f32_bf16 v198, v167, s28, v198
    v_dot2_f32_bf16 v199, v167, v167, v199
    v_dot2_f32_bf16 v194, v168, s28, v194
    v_dot2_f32_bf16 v195, v168, v168, v195
    v_dot2_f32_bf16 v198, v169, s28, v198
    v_dot2_f32_bf16 v199, v169, v169, v199
    v_dot2_f32_bf16 v194, v170, s28, v194
    v_dot2_f32_bf16 v195, v170, v170, v195
    v_dot2_f32_bf16 v198, v171, s28, v198
    v_dot2_f32_bf16 v199, v171, v171, v199
    v_dot2_f32_bf16 v194, v172, s28, v194
    v_dot2_f32_bf16 v195, v172, v172, v195
    v_dot2_f32_bf16 v198, v173, s28, v198
    v_dot2_f32_bf16 v199, v173, v173, v199
    v_dot2_f32_bf16 v194, v174, s28, v194
    v_dot2_f32_bf16 v195, v174, v174, v195
    v_dot2_f32_bf16 v198, v175, s28, v198
    v_dot2_f32_bf16 v199, v175, v175, v199
    v_dot2_f32_bf16 v194, v176, s28, v194
    v_dot2_f32_bf16 v195, v176, v176, v195
    v_dot2_f32_bf16 v198, v177, s28, v198
    v_dot2_f32_bf16 v199, v177, v177, v199
    v_dot2_f32_bf16 v194, v178, s28, v194
    v_dot2_f32_bf16 v195, v178, v178, v195
    v_dot2_f32_bf16 v198, v179, s28, v198
    v_dot2_f32_bf16 v199, v179, v179, v199
    v_dot2_f32_bf16 v194, v180, s28, v194
    v_dot2_f32_bf16 v195, v180, v180, v195
    v_dot2_f32_bf16 v198, v181, s28, v198
    v_dot2_f32_bf16 v199, v181, v181, v199
    v_dot2_f32_bf16 v194, v182, s28, v194
    v_dot2_f32_bf16 v195, v182, v182, v195
    v_dot2_f32_bf16 v198, v183, s28, v198
    v_dot2_f32_bf16 v199, v183, v183, v199
    s_nop 1
    v_add_f32 v194, v194, v198
    v_add_f32 v195, v195, v199
    s_nop 0
    v_add_f32_dpp v196, v194, v194 quad_perm:[1,0,3,2] row_mask:0xf bank_mask:0xf
    s_nop 1
    v_add_f32_dpp v194, v196, v196 quad_perm:[2,3,0,1] row_mask:0xf bank_mask:0xf
    s_nop 1
    v_add_f32_dpp v196, v194, v194 row_half_mirror row_mask:0xf bank_mask:0xf
    v_mov_b32 v194, v196
    v_add_f32_dpp v196, v195, v195 quad_perm:[1,0,3,2] row_mask:0xf bank_mask:0xf
    s_nop 1
    v_add_f32_dpp v195, v196, v196 quad_perm:[2,3,0,1] row_mask:0xf bank_mask:0xf
    s_nop 1
    v_add_f32_dpp v196, v195, v195 row_half_mirror row_mask:0xf bank_mask:0xf
    v_mov_b32 v195, v196
    v_mul_f32 v194, 0x3b124925, v194
    v_mul_f32 v195, 0x3b124925, v195
    v_fma_f32 v195, -v194, v194, v195
    v_max_f32 v195, 0, v195
    v_cvt_pk_bf16_f32 v196, v194, v194
    v_lshlrev_b32 v192, 16, v196
    v_cvt_pk_bf16_f32 v196, v195, v195
    v_lshlrev_b32 v197, 16, v196
    v_add_f32 v197, 0x3727c5ac, v197
    v_cvt_pk_bf16_f32 v196, v197, v197
    v_lshlrev_b32 v197, 16, v196
    v_sqrt_f32 v197, v197
    s_nop 0
    v_cvt_pk_bf16_f32 v196, v197, v197
    v_lshlrev_b32 v197, 16, v196
    v_rcp_f32 v193, v197
    s_nop 0
    v_fma_f32 v196, -v197, v193, 2.0
    v_mul_f32 v193, v193, v196
    v_mov_b32 v190, v193
    v_mul_f32 v191, v192, v193
    ds_write_b64 v200, v[190:191] offset:512
    ds_write_b128 v187, v[156:159] offset:59392
    ds_write_b128 v187, v[160:163] offset:59520
    ds_write_b128 v187, v[164:167] offset:59648
    ds_write_b128 v187, v[168:171] offset:59776
    ds_write_b128 v187, v[172:175] offset:59904
    ds_write_b128 v187, v[176:179] offset:60032
    ds_write_b128 v187, v[180:183] offset:60160
L_qkv1_kernel_nohalo_1:
    s_nop 1
    s_waitcnt lgkmcnt(0)
    s_barrier
    v_mul_u32_u24 v7, 928, v2
    v_lshl_add_u32 v7, v3, 4, v7
    v_add_u32 v7, 32000, v7
    s_movk_i32 s42, 896
    v_mul_lo_u32 v8, v2, s42
    v_lshl_add_u32 v8, v3, 3, v8
    v_mov_b32 v12, s28
    v_mov_b32 v13, s28
    v_mov_b32 v14, s28
    v_mov_b32 v15, s28
    v_lshlrev_b32 v9, 3, v2
    s_cmp_eq_u32 s3, 0
    s_cbranch_scc1 L_qkv1_kernel_var_2
    s_cmp_eq_u32 s3, 1
    s_cbranch_scc1 L_qkv1_kernel_var_2
    s_cmp_eq_u32 s3, 2
    s_cbranch_scc1 L_qkv1_kernel_var_2
    s_cmp_eq_u32 s3, 3
    s_cbranch_scc1 L_qkv1_kernel_var_2
    s_cmp_eq_u32 s3, 4
    s_cbranch_scc1 L_qkv1_kernel_var_3
    s_cmp_eq_u32 s3, 5
    s_cbranch_scc1 L_qkv1_kernel_var_3
    s_cmp_eq_u32 s3, 6
    s_cbranch_scc1 L_qkv1_kernel_var_3
    s_cmp_eq_u32 s3, 7
    s_cbranch_scc1 L_qkv1_kernel_var_3
    s_branch L_qkv1_kernel_end
L_qkv1_kernel_var_2:
    s_nop 4
    v_mov_b32 v128, 0
    v_mov_b32 v129, 0
    v_mov_b32 v130, 0
    v_mov_b32 v131, 0
    v_mov_b32 v132, 0
    v_mov_b32 v133, 0
    v_mov_b32 v134, 0
    v_mov_b32 v135, 0
    v_mov_b32 v136, 0
    v_mov_b32 v137, 0
    v_mov_b32 v138, 0
    v_mov_b32 v139, 0
    v_mov_b32 v140, 0
    v_mov_b32 v141, 0
    v_mov_b32 v142, 0
    v_mov_b32 v143, 0
    v_mov_b32 v144, 0
    v_mov_b32 v145, 0
    v_mov_b32 v146, 0
    v_mov_b32 v147, 0
    v_mov_b32 v148, 0
    v_mov_b32 v149, 0
    v_mov_b32 v150, 0
    v_mov_b32 v151, 0
    v_mov_b32 v152, 0
    v_mov_b32 v153, 0
    v_mov_b32 v154, 0
    v_mov_b32 v155, 0
    v_mov_b32 v156, 0
    v_mov_b32 v157, 0
    v_mov_b32 v158, 0
    v_mov_b32 v159, 0
    v_mov_b32 v160, 0
    v_mov_b32 v161, 0
    v_mov_b32 v162, 0
    v_mov_b32 v163, 0
    v_mov_b32 v164, 0
    v_mov_b32 v165, 0
    v_mov_b32 v166, 0
    v_mov_b32 v167, 0
    v_mov_b32 v208, 0
    v_mov_b32 v209, 0
    v_mov_b32 v210, 0
    v_mov_b32 v211, 0
    v_mov_b32 v212, 0
    v_mov_b32 v213, 0
    v_mov_b32 v214, 0
    v_mov_b32 v215, 0
    s_mul_i32 s50, s6, 896
    s_mul_i32 s51, s5, 384
    s_add_u32 s50, s50, s51
    s_lshl_b32 s51, s43, 5
    s_add_u32 s50, s50, s51
    ds_read_b128 v[168:171], v7 offset:0
    ds_read_b128 v[172:175], v7 offset:14848
    ds_read_b128 v[176:179], v7 offset:29696
    ds_read_b128 v[180:183], v7 offset:44544
    ds_read_b128 v[184:187], v7 offset:59392
    ds_read_b128 v[188:191], v7 offset:64
    ds_read_b128 v[192:195], v7 offset:14912
    ds_read_b128 v[196:199], v7 offset:29760
    ds_read_b128 v[200:203], v7 offset:44608
    ds_read_b128 v[204:207], v7 offset:59456
    s_waitcnt lgkmcnt(5)
    s_waitcnt vmcnt(27)
    s_waitcnt vmcnt(26)
    v_mfma_f32_16x16x32_bf16 v[128:131], v[16:19], v[168:171], v[128:131]
    v_mfma_f32_16x16x32_bf16 v[136:139], v[16:19], v[172:175], v[136:139]
    v_mfma_f32_16x16x32_bf16 v[144:147], v[16:19], v[176:179], v[144:147]
    v_mfma_f32_16x16x32_bf16 v[152:155], v[16:19], v[180:183], v[152:155]
    v_mfma_f32_16x16x32_bf16 v[160:163], v[16:19], v[184:187], v[160:163]
    v_mfma_f32_16x16x32_bf16 v[208:211], v[16:19], v[12:15], v[208:211]
    v_mfma_f32_16x16x32_bf16 v[132:135], v[72:75], v[168:171], v[132:135]
    v_mfma_f32_16x16x32_bf16 v[140:143], v[72:75], v[172:175], v[140:143]
    v_mfma_f32_16x16x32_bf16 v[148:151], v[72:75], v[176:179], v[148:151]
    v_mfma_f32_16x16x32_bf16 v[156:159], v[72:75], v[180:183], v[156:159]
    v_mfma_f32_16x16x32_bf16 v[164:167], v[72:75], v[184:187], v[164:167]
    v_mfma_f32_16x16x32_bf16 v[212:215], v[72:75], v[12:15], v[212:215]
    ds_read_b128 v[168:171], v7 offset:128
    ds_read_b128 v[172:175], v7 offset:14976
    ds_read_b128 v[176:179], v7 offset:29824
    ds_read_b128 v[180:183], v7 offset:44672
    ds_read_b128 v[184:187], v7 offset:59520
    s_waitcnt lgkmcnt(5)
    s_waitcnt vmcnt(25)
    s_waitcnt vmcnt(24)
    v_mfma_f32_16x16x32_bf16 v[128:131], v[20:23], v[188:191], v[128:131]
    v_mfma_f32_16x16x32_bf16 v[136:139], v[20:23], v[192:195], v[136:139]
    v_mfma_f32_16x16x32_bf16 v[144:147], v[20:23], v[196:199], v[144:147]
    v_mfma_f32_16x16x32_bf16 v[152:155], v[20:23], v[200:203], v[152:155]
    v_mfma_f32_16x16x32_bf16 v[160:163], v[20:23], v[204:207], v[160:163]
    v_mfma_f32_16x16x32_bf16 v[208:211], v[20:23], v[12:15], v[208:211]
    v_mfma_f32_16x16x32_bf16 v[132:135], v[76:79], v[188:191], v[132:135]
    v_mfma_f32_16x16x32_bf16 v[140:143], v[76:79], v[192:195], v[140:143]
    v_mfma_f32_16x16x32_bf16 v[148:151], v[76:79], v[196:199], v[148:151]
    v_mfma_f32_16x16x32_bf16 v[156:159], v[76:79], v[200:203], v[156:159]
    v_mfma_f32_16x16x32_bf16 v[164:167], v[76:79], v[204:207], v[164:167]
    v_mfma_f32_16x16x32_bf16 v[212:215], v[76:79], v[12:15], v[212:215]
    ds_read_b128 v[188:191], v7 offset:192
    ds_read_b128 v[192:195], v7 offset:15040
    ds_read_b128 v[196:199], v7 offset:29888
    ds_read_b128 v[200:203], v7 offset:44736
    ds_read_b128 v[204:207], v7 offset:59584
    s_waitcnt lgkmcnt(5)
    s_waitcnt vmcnt(23)
    s_waitcnt vmcnt(22)
    v_mfma_f32_16x16x32_bf16 v[128:131], v[24:27], v[168:171], v[128:131]
    v_mfma_f32_16x16x32_bf16 v[136:139], v[24:27], v[172:175], v[136:139]
    v_mfma_f32_16x16x32_bf16 v[144:147], v[24:27], v[176:179], v[144:147]
    v_mfma_f32_16x16x32_bf16 v[152:155], v[24:27], v[180:183], v[152:155]
    v_mfma_f32_16x16x32_bf16 v[160:163], v[24:27], v[184:187], v[160:163]
    v_mfma_f32_16x16x32_bf16 v[208:211], v[24:27], v[12:15], v[208:211]
    v_mfma_f32_16x16x32_bf16 v[132:135], v[80:83], v[168:171], v[132:135]
    v_mfma_f32_16x16x32_bf16 v[140:143], v[80:83], v[172:175], v[140:143]
    v_mfma_f32_16x16x32_bf16 v[148:151], v[80:83], v[176:179], v[148:151]
    v_mfma_f32_16x16x32_bf16 v[156:159], v[80:83], v[180:183], v[156:159]
    v_mfma_f32_16x16x32_bf16 v[164:167], v[80:83], v[184:187], v[164:167]
    v_mfma_f32_16x16x32_bf16 v[212:215], v[80:83], v[12:15], v[212:215]
    ds_read_b128 v[168:171], v7 offset:256
    ds_read_b128 v[172:175], v7 offset:15104
    ds_read_b128 v[176:179], v7 offset:29952
    ds_read_b128 v[180:183], v7 offset:44800
    ds_read_b128 v[184:187], v7 offset:59648
    s_waitcnt lgkmcnt(5)
    s_waitcnt vmcnt(21)
    s_waitcnt vmcnt(20)
    v_mfma_f32_16x16x32_bf16 v[128:131], v[28:31], v[188:191], v[128:131]
    v_mfma_f32_16x16x32_bf16 v[136:139], v[28:31], v[192:195], v[136:139]
    v_mfma_f32_16x16x32_bf16 v[144:147], v[28:31], v[196:199], v[144:147]
    v_mfma_f32_16x16x32_bf16 v[152:155], v[28:31], v[200:203], v[152:155]
    v_mfma_f32_16x16x32_bf16 v[160:163], v[28:31], v[204:207], v[160:163]
    v_mfma_f32_16x16x32_bf16 v[208:211], v[28:31], v[12:15], v[208:211]
    v_mfma_f32_16x16x32_bf16 v[132:135], v[84:87], v[188:191], v[132:135]
    v_mfma_f32_16x16x32_bf16 v[140:143], v[84:87], v[192:195], v[140:143]
    v_mfma_f32_16x16x32_bf16 v[148:151], v[84:87], v[196:199], v[148:151]
    v_mfma_f32_16x16x32_bf16 v[156:159], v[84:87], v[200:203], v[156:159]
    v_mfma_f32_16x16x32_bf16 v[164:167], v[84:87], v[204:207], v[164:167]
    v_mfma_f32_16x16x32_bf16 v[212:215], v[84:87], v[12:15], v[212:215]
    ds_read_b128 v[188:191], v7 offset:320
    ds_read_b128 v[192:195], v7 offset:15168
    ds_read_b128 v[196:199], v7 offset:30016
    ds_read_b128 v[200:203], v7 offset:44864
    ds_read_b128 v[204:207], v7 offset:59712
    s_waitcnt lgkmcnt(5)
    s_waitcnt vmcnt(19)
    s_waitcnt vmcnt(18)
    v_mfma_f32_16x16x32_bf16 v[128:131], v[32:35], v[168:171], v[128:131]
    v_mfma_f32_16x16x32_bf16 v[136:139], v[32:35], v[172:175], v[136:139]
    v_mfma_f32_16x16x32_bf16 v[144:147], v[32:35], v[176:179], v[144:147]
    v_mfma_f32_16x16x32_bf16 v[152:155], v[32:35], v[180:183], v[152:155]
    v_mfma_f32_16x16x32_bf16 v[160:163], v[32:35], v[184:187], v[160:163]
    v_mfma_f32_16x16x32_bf16 v[208:211], v[32:35], v[12:15], v[208:211]
    v_mfma_f32_16x16x32_bf16 v[132:135], v[88:91], v[168:171], v[132:135]
    v_mfma_f32_16x16x32_bf16 v[140:143], v[88:91], v[172:175], v[140:143]
    v_mfma_f32_16x16x32_bf16 v[148:151], v[88:91], v[176:179], v[148:151]
    v_mfma_f32_16x16x32_bf16 v[156:159], v[88:91], v[180:183], v[156:159]
    v_mfma_f32_16x16x32_bf16 v[164:167], v[88:91], v[184:187], v[164:167]
    v_mfma_f32_16x16x32_bf16 v[212:215], v[88:91], v[12:15], v[212:215]
    ds_read_b128 v[168:171], v7 offset:384
    ds_read_b128 v[172:175], v7 offset:15232
    ds_read_b128 v[176:179], v7 offset:30080
    ds_read_b128 v[180:183], v7 offset:44928
    ds_read_b128 v[184:187], v7 offset:59776
    s_waitcnt lgkmcnt(5)
    s_waitcnt vmcnt(17)
    s_waitcnt vmcnt(16)
    v_mfma_f32_16x16x32_bf16 v[128:131], v[36:39], v[188:191], v[128:131]
    v_mfma_f32_16x16x32_bf16 v[136:139], v[36:39], v[192:195], v[136:139]
    v_mfma_f32_16x16x32_bf16 v[144:147], v[36:39], v[196:199], v[144:147]
    v_mfma_f32_16x16x32_bf16 v[152:155], v[36:39], v[200:203], v[152:155]
    v_mfma_f32_16x16x32_bf16 v[160:163], v[36:39], v[204:207], v[160:163]
    v_mfma_f32_16x16x32_bf16 v[208:211], v[36:39], v[12:15], v[208:211]
    v_mfma_f32_16x16x32_bf16 v[132:135], v[92:95], v[188:191], v[132:135]
    v_mfma_f32_16x16x32_bf16 v[140:143], v[92:95], v[192:195], v[140:143]
    v_mfma_f32_16x16x32_bf16 v[148:151], v[92:95], v[196:199], v[148:151]
    v_mfma_f32_16x16x32_bf16 v[156:159], v[92:95], v[200:203], v[156:159]
    v_mfma_f32_16x16x32_bf16 v[164:167], v[92:95], v[204:207], v[164:167]
    v_mfma_f32_16x16x32_bf16 v[212:215], v[92:95], v[12:15], v[212:215]
    ds_read_b128 v[188:191], v7 offset:448
    ds_read_b128 v[192:195], v7 offset:15296
    ds_read_b128 v[196:199], v7 offset:30144
    ds_read_b128 v[200:203], v7 offset:44992
    ds_read_b128 v[204:207], v7 offset:59840
    s_waitcnt lgkmcnt(5)
    s_waitcnt vmcnt(15)
    s_waitcnt vmcnt(14)
    v_mfma_f32_16x16x32_bf16 v[128:131], v[40:43], v[168:171], v[128:131]
    v_mfma_f32_16x16x32_bf16 v[136:139], v[40:43], v[172:175], v[136:139]
    v_mfma_f32_16x16x32_bf16 v[144:147], v[40:43], v[176:179], v[144:147]
    v_mfma_f32_16x16x32_bf16 v[152:155], v[40:43], v[180:183], v[152:155]
    v_mfma_f32_16x16x32_bf16 v[160:163], v[40:43], v[184:187], v[160:163]
    v_mfma_f32_16x16x32_bf16 v[208:211], v[40:43], v[12:15], v[208:211]
    v_mfma_f32_16x16x32_bf16 v[132:135], v[96:99], v[168:171], v[132:135]
    v_mfma_f32_16x16x32_bf16 v[140:143], v[96:99], v[172:175], v[140:143]
    v_mfma_f32_16x16x32_bf16 v[148:151], v[96:99], v[176:179], v[148:151]
    v_mfma_f32_16x16x32_bf16 v[156:159], v[96:99], v[180:183], v[156:159]
    v_mfma_f32_16x16x32_bf16 v[164:167], v[96:99], v[184:187], v[164:167]
    v_mfma_f32_16x16x32_bf16 v[212:215], v[96:99], v[12:15], v[212:215]
    ds_read_b128 v[168:171], v7 offset:512
    ds_read_b128 v[172:175], v7 offset:15360
    ds_read_b128 v[176:179], v7 offset:30208
    ds_read_b128 v[180:183], v7 offset:45056
    ds_read_b128 v[184:187], v7 offset:59904
    s_waitcnt lgkmcnt(5)
    s_waitcnt vmcnt(13)
    s_waitcnt vmcnt(12)
    v_mfma_f32_16x16x32_bf16 v[128:131], v[44:47], v[188:191], v[128:131]
    v_mfma_f32_16x16x32_bf16 v[136:139], v[44:47], v[192:195], v[136:139]
    v_mfma_f32_16x16x32_bf16 v[144:147], v[44:47], v[196:199], v[144:147]
    v_mfma_f32_16x16x32_bf16 v[152:155], v[44:47], v[200:203], v[152:155]
    v_mfma_f32_16x16x32_bf16 v[160:163], v[44:47], v[204:207], v[160:163]
    v_mfma_f32_16x16x32_bf16 v[208:211], v[44:47], v[12:15], v[208:211]
    v_mfma_f32_16x16x32_bf16 v[132:135], v[100:103], v[188:191], v[132:135]
    v_mfma_f32_16x16x32_bf16 v[140:143], v[100:103], v[192:195], v[140:143]
    v_mfma_f32_16x16x32_bf16 v[148:151], v[100:103], v[196:199], v[148:151]
    v_mfma_f32_16x16x32_bf16 v[156:159], v[100:103], v[200:203], v[156:159]
    v_mfma_f32_16x16x32_bf16 v[164:167], v[100:103], v[204:207], v[164:167]
    v_mfma_f32_16x16x32_bf16 v[212:215], v[100:103], v[12:15], v[212:215]
    ds_read_b128 v[188:191], v7 offset:576
    ds_read_b128 v[192:195], v7 offset:15424
    ds_read_b128 v[196:199], v7 offset:30272
    ds_read_b128 v[200:203], v7 offset:45120
    ds_read_b128 v[204:207], v7 offset:59968
    s_waitcnt lgkmcnt(5)
    s_waitcnt vmcnt(11)
    s_waitcnt vmcnt(10)
    v_mfma_f32_16x16x32_bf16 v[128:131], v[48:51], v[168:171], v[128:131]
    v_mfma_f32_16x16x32_bf16 v[136:139], v[48:51], v[172:175], v[136:139]
    v_mfma_f32_16x16x32_bf16 v[144:147], v[48:51], v[176:179], v[144:147]
    v_mfma_f32_16x16x32_bf16 v[152:155], v[48:51], v[180:183], v[152:155]
    v_mfma_f32_16x16x32_bf16 v[160:163], v[48:51], v[184:187], v[160:163]
    v_mfma_f32_16x16x32_bf16 v[208:211], v[48:51], v[12:15], v[208:211]
    v_mfma_f32_16x16x32_bf16 v[132:135], v[104:107], v[168:171], v[132:135]
    v_mfma_f32_16x16x32_bf16 v[140:143], v[104:107], v[172:175], v[140:143]
    v_mfma_f32_16x16x32_bf16 v[148:151], v[104:107], v[176:179], v[148:151]
    v_mfma_f32_16x16x32_bf16 v[156:159], v[104:107], v[180:183], v[156:159]
    v_mfma_f32_16x16x32_bf16 v[164:167], v[104:107], v[184:187], v[164:167]
    v_mfma_f32_16x16x32_bf16 v[212:215], v[104:107], v[12:15], v[212:215]
    ds_read_b128 v[168:171], v7 offset:640
    ds_read_b128 v[172:175], v7 offset:15488
    ds_read_b128 v[176:179], v7 offset:30336
    ds_read_b128 v[180:183], v7 offset:45184
    ds_read_b128 v[184:187], v7 offset:60032
    s_waitcnt lgkmcnt(5)
    s_waitcnt vmcnt(9)
    s_waitcnt vmcnt(8)
    v_mfma_f32_16x16x32_bf16 v[128:131], v[52:55], v[188:191], v[128:131]
    v_mfma_f32_16x16x32_bf16 v[136:139], v[52:55], v[192:195], v[136:139]
    v_mfma_f32_16x16x32_bf16 v[144:147], v[52:55], v[196:199], v[144:147]
    v_mfma_f32_16x16x32_bf16 v[152:155], v[52:55], v[200:203], v[152:155]
    v_mfma_f32_16x16x32_bf16 v[160:163], v[52:55], v[204:207], v[160:163]
    v_mfma_f32_16x16x32_bf16 v[208:211], v[52:55], v[12:15], v[208:211]
    v_mfma_f32_16x16x32_bf16 v[132:135], v[108:111], v[188:191], v[132:135]
    v_mfma_f32_16x16x32_bf16 v[140:143], v[108:111], v[192:195], v[140:143]
    v_mfma_f32_16x16x32_bf16 v[148:151], v[108:111], v[196:199], v[148:151]
    v_mfma_f32_16x16x32_bf16 v[156:159], v[108:111], v[200:203], v[156:159]
    v_mfma_f32_16x16x32_bf16 v[164:167], v[108:111], v[204:207], v[164:167]
    v_mfma_f32_16x16x32_bf16 v[212:215], v[108:111], v[12:15], v[212:215]
    ds_read_b128 v[188:191], v7 offset:704
    ds_read_b128 v[192:195], v7 offset:15552
    ds_read_b128 v[196:199], v7 offset:30400
    ds_read_b128 v[200:203], v7 offset:45248
    ds_read_b128 v[204:207], v7 offset:60096
    s_waitcnt lgkmcnt(5)
    s_waitcnt vmcnt(7)
    s_waitcnt vmcnt(6)
    v_mfma_f32_16x16x32_bf16 v[128:131], v[56:59], v[168:171], v[128:131]
    v_mfma_f32_16x16x32_bf16 v[136:139], v[56:59], v[172:175], v[136:139]
    v_mfma_f32_16x16x32_bf16 v[144:147], v[56:59], v[176:179], v[144:147]
    v_mfma_f32_16x16x32_bf16 v[152:155], v[56:59], v[180:183], v[152:155]
    v_mfma_f32_16x16x32_bf16 v[160:163], v[56:59], v[184:187], v[160:163]
    v_mfma_f32_16x16x32_bf16 v[208:211], v[56:59], v[12:15], v[208:211]
    v_mfma_f32_16x16x32_bf16 v[132:135], v[112:115], v[168:171], v[132:135]
    v_mfma_f32_16x16x32_bf16 v[140:143], v[112:115], v[172:175], v[140:143]
    v_mfma_f32_16x16x32_bf16 v[148:151], v[112:115], v[176:179], v[148:151]
    v_mfma_f32_16x16x32_bf16 v[156:159], v[112:115], v[180:183], v[156:159]
    v_mfma_f32_16x16x32_bf16 v[164:167], v[112:115], v[184:187], v[164:167]
    v_mfma_f32_16x16x32_bf16 v[212:215], v[112:115], v[12:15], v[212:215]
    ds_read_b128 v[168:171], v7 offset:768
    ds_read_b128 v[172:175], v7 offset:15616
    ds_read_b128 v[176:179], v7 offset:30464
    ds_read_b128 v[180:183], v7 offset:45312
    ds_read_b128 v[184:187], v7 offset:60160
    s_waitcnt lgkmcnt(5)
    s_waitcnt vmcnt(5)
    s_waitcnt vmcnt(4)
    v_mfma_f32_16x16x32_bf16 v[128:131], v[60:63], v[188:191], v[128:131]
    v_mfma_f32_16x16x32_bf16 v[136:139], v[60:63], v[192:195], v[136:139]
    v_mfma_f32_16x16x32_bf16 v[144:147], v[60:63], v[196:199], v[144:147]
    v_mfma_f32_16x16x32_bf16 v[152:155], v[60:63], v[200:203], v[152:155]
    v_mfma_f32_16x16x32_bf16 v[160:163], v[60:63], v[204:207], v[160:163]
    v_mfma_f32_16x16x32_bf16 v[208:211], v[60:63], v[12:15], v[208:211]
    v_mfma_f32_16x16x32_bf16 v[132:135], v[116:119], v[188:191], v[132:135]
    v_mfma_f32_16x16x32_bf16 v[140:143], v[116:119], v[192:195], v[140:143]
    v_mfma_f32_16x16x32_bf16 v[148:151], v[116:119], v[196:199], v[148:151]
    v_mfma_f32_16x16x32_bf16 v[156:159], v[116:119], v[200:203], v[156:159]
    v_mfma_f32_16x16x32_bf16 v[164:167], v[116:119], v[204:207], v[164:167]
    v_mfma_f32_16x16x32_bf16 v[212:215], v[116:119], v[12:15], v[212:215]
    ds_read_b128 v[188:191], v7 offset:832
    ds_read_b128 v[192:195], v7 offset:15680
    ds_read_b128 v[196:199], v7 offset:30528
    ds_read_b128 v[200:203], v7 offset:45376
    ds_read_b128 v[204:207], v7 offset:60224
    s_waitcnt lgkmcnt(5)
    s_waitcnt vmcnt(3)
    s_waitcnt vmcnt(2)
    v_mfma_f32_16x16x32_bf16 v[128:131], v[64:67], v[168:171], v[128:131]
    v_mfma_f32_16x16x32_bf16 v[136:139], v[64:67], v[172:175], v[136:139]
    v_mfma_f32_16x16x32_bf16 v[144:147], v[64:67], v[176:179], v[144:147]
    v_mfma_f32_16x16x32_bf16 v[152:155], v[64:67], v[180:183], v[152:155]
    v_mfma_f32_16x16x32_bf16 v[160:163], v[64:67], v[184:187], v[160:163]
    v_mfma_f32_16x16x32_bf16 v[208:211], v[64:67], v[12:15], v[208:211]
    v_mfma_f32_16x16x32_bf16 v[132:135], v[120:123], v[168:171], v[132:135]
    v_mfma_f32_16x16x32_bf16 v[140:143], v[120:123], v[172:175], v[140:143]
    v_mfma_f32_16x16x32_bf16 v[148:151], v[120:123], v[176:179], v[148:151]
    v_mfma_f32_16x16x32_bf16 v[156:159], v[120:123], v[180:183], v[156:159]
    v_mfma_f32_16x16x32_bf16 v[164:167], v[120:123], v[184:187], v[164:167]
    v_mfma_f32_16x16x32_bf16 v[212:215], v[120:123], v[12:15], v[212:215]
    s_waitcnt lgkmcnt(0)
    s_waitcnt vmcnt(1)
    s_waitcnt vmcnt(0)
    v_mfma_f32_16x16x32_bf16 v[128:131], v[68:71], v[188:191], v[128:131]
    v_mfma_f32_16x16x32_bf16 v[136:139], v[68:71], v[192:195], v[136:139]
    v_mfma_f32_16x16x32_bf16 v[144:147], v[68:71], v[196:199], v[144:147]
    v_mfma_f32_16x16x32_bf16 v[152:155], v[68:71], v[200:203], v[152:155]
    v_mfma_f32_16x16x32_bf16 v[160:163], v[68:71], v[204:207], v[160:163]
    v_mfma_f32_16x16x32_bf16 v[208:211], v[68:71], v[12:15], v[208:211]
    v_mfma_f32_16x16x32_bf16 v[132:135], v[124:127], v[188:191], v[132:135]
    v_mfma_f32_16x16x32_bf16 v[140:143], v[124:127], v[192:195], v[140:143]
    v_mfma_f32_16x16x32_bf16 v[148:151], v[124:127], v[196:199], v[148:151]
    v_mfma_f32_16x16x32_bf16 v[156:159], v[124:127], v[200:203], v[156:159]
    v_mfma_f32_16x16x32_bf16 v[164:167], v[124:127], v[204:207], v[164:167]
    v_mfma_f32_16x16x32_bf16 v[212:215], v[124:127], v[12:15], v[212:215]
    ds_read_b64 v[224:225], v9 offset:0
    ds_read_b64 v[226:227], v9 offset:128
    ds_read_b64 v[228:229], v9 offset:256
    ds_read_b64 v[230:231], v9 offset:384
    ds_read_b64 v[232:233], v9 offset:512
    s_waitcnt lgkmcnt(0)
    v_mul_u32_u24 v234, 392, v2
    v_lshl_add_u32 v234, v3, 3, v234
    s_lshr_b32 s52, s43, 2
    s_lshl_b32 s52, s52, 7
    s_and_b32 s53, s43, 3
    s_lshl_b32 s53, s53, 5
    s_add_u32 s52, s52, s53
    v_add_u32 v234, s52, v234
    v_mul_f32 v218, v208, v225
    v_fma_f32 v128, v128, v224, -v218
    v_mul_f32 v218, v209, v225
    v_fma_f32 v129, v129, v224, -v218
    v_mul_f32 v218, v210, v225
    v_fma_f32 v130, v130, v224, -v218
    v_mul_f32 v218, v211, v225
    v_fma_f32 v131, v131, v224, -v218
    v_cvt_pk_bf16_f32 v216, v128, v129
    v_cvt_pk_bf16_f32 v217, v130, v131
    ds_write_b64 v234, v[216:217] offset:640
    v_mul_f32 v218, v212, v225
    v_fma_f32 v132, v132, v224, -v218
    v_mul_f32 v218, v213, v225
    v_fma_f32 v133, v133, v224, -v218
    v_mul_f32 v218, v214, v225
    v_fma_f32 v134, v134, v224, -v218
    v_mul_f32 v218, v215, v225
    v_fma_f32 v135, v135, v224, -v218
    v_cvt_pk_bf16_f32 v216, v132, v133
    v_cvt_pk_bf16_f32 v217, v134, v135
    ds_write_b64 v234, v[216:217] offset:672
    v_mul_f32 v218, v208, v227
    v_fma_f32 v136, v136, v226, -v218
    v_mul_f32 v218, v209, v227
    v_fma_f32 v137, v137, v226, -v218
    v_mul_f32 v218, v210, v227
    v_fma_f32 v138, v138, v226, -v218
    v_mul_f32 v218, v211, v227
    v_fma_f32 v139, v139, v226, -v218
    v_cvt_pk_bf16_f32 v216, v136, v137
    v_cvt_pk_bf16_f32 v217, v138, v139
    ds_write_b64 v234, v[216:217] offset:6912
    v_mul_f32 v218, v212, v227
    v_fma_f32 v140, v140, v226, -v218
    v_mul_f32 v218, v213, v227
    v_fma_f32 v141, v141, v226, -v218
    v_mul_f32 v218, v214, v227
    v_fma_f32 v142, v142, v226, -v218
    v_mul_f32 v218, v215, v227
    v_fma_f32 v143, v143, v226, -v218
    v_cvt_pk_bf16_f32 v216, v140, v141
    v_cvt_pk_bf16_f32 v217, v142, v143
    ds_write_b64 v234, v[216:217] offset:6944
    v_mul_f32 v218, v208, v229
    v_fma_f32 v144, v144, v228, -v218
    v_mul_f32 v218, v209, v229
    v_fma_f32 v145, v145, v228, -v218
    v_mul_f32 v218, v210, v229
    v_fma_f32 v146, v146, v228, -v218
    v_mul_f32 v218, v211, v229
    v_fma_f32 v147, v147, v228, -v218
    v_cvt_pk_bf16_f32 v216, v144, v145
    v_cvt_pk_bf16_f32 v217, v146, v147
    ds_write_b64 v234, v[216:217] offset:13184
    v_mul_f32 v218, v212, v229
    v_fma_f32 v148, v148, v228, -v218
    v_mul_f32 v218, v213, v229
    v_fma_f32 v149, v149, v228, -v218
    v_mul_f32 v218, v214, v229
    v_fma_f32 v150, v150, v228, -v218
    v_mul_f32 v218, v215, v229
    v_fma_f32 v151, v151, v228, -v218
    v_cvt_pk_bf16_f32 v216, v148, v149
    v_cvt_pk_bf16_f32 v217, v150, v151
    ds_write_b64 v234, v[216:217] offset:13216
    v_mul_f32 v218, v208, v231
    v_fma_f32 v152, v152, v230, -v218
    v_mul_f32 v218, v209, v231
    v_fma_f32 v153, v153, v230, -v218
    v_mul_f32 v218, v210, v231
    v_fma_f32 v154, v154, v230, -v218
    v_mul_f32 v218, v211, v231
    v_fma_f32 v155, v155, v230, -v218
    v_cvt_pk_bf16_f32 v216, v152, v153
    v_cvt_pk_bf16_f32 v217, v154, v155
    ds_write_b64 v234, v[216:217] offset:19456
    v_mul_f32 v218, v212, v231
    v_fma_f32 v156, v156, v230, -v218
    v_mul_f32 v218, v213, v231
    v_fma_f32 v157, v157, v230, -v218
    v_mul_f32 v218, v214, v231
    v_fma_f32 v158, v158, v230, -v218
    v_mul_f32 v218, v215, v231
    v_fma_f32 v159, v159, v230, -v218
    v_cvt_pk_bf16_f32 v216, v156, v157
    v_cvt_pk_bf16_f32 v217, v158, v159
    ds_write_b64 v234, v[216:217] offset:19488
    v_mul_f32 v218, v208, v233
    v_fma_f32 v160, v160, v232, -v218
    v_mul_f32 v218, v209, v233
    v_fma_f32 v161, v161, v232, -v218
    v_mul_f32 v218, v210, v233
    v_fma_f32 v162, v162, v232, -v218
    v_mul_f32 v218, v211, v233
    v_fma_f32 v163, v163, v232, -v218
    v_cvt_pk_bf16_f32 v216, v160, v161
    v_cvt_pk_bf16_f32 v217, v162, v163
    ds_write_b64 v234, v[216:217] offset:25728
    v_mul_f32 v218, v212, v233
    v_fma_f32 v164, v164, v232, -v218
    v_mul_f32 v218, v213, v233
    v_fma_f32 v165, v165, v232, -v218
    v_mul_f32 v218, v214, v233
    v_fma_f32 v166, v166, v232, -v218
    v_mul_f32 v218, v215, v233
    v_fma_f32 v167, v167, v232, -v218
    v_cvt_pk_bf16_f32 v216, v164, v165
    v_cvt_pk_bf16_f32 v217, v166, v167
    ds_write_b64 v234, v[216:217] offset:25760
    s_branch L_qkv1_kernel_end
L_qkv1_kernel_var_3:
    s_nop 4
    v_mov_b32 v128, 0
    v_mov_b32 v129, 0
    v_mov_b32 v130, 0
    v_mov_b32 v131, 0
    v_mov_b32 v132, 0
    v_mov_b32 v133, 0
    v_mov_b32 v134, 0
    v_mov_b32 v135, 0
    v_mov_b32 v136, 0
    v_mov_b32 v137, 0
    v_mov_b32 v138, 0
    v_mov_b32 v139, 0
    v_mov_b32 v140, 0
    v_mov_b32 v141, 0
    v_mov_b32 v142, 0
    v_mov_b32 v143, 0
    v_mov_b32 v176, 0
    v_mov_b32 v177, 0
    v_mov_b32 v178, 0
    v_mov_b32 v179, 0
    s_mul_i32 s50, s6, 896
    s_mul_i32 s51, s5, 384
    s_add_u32 s50, s50, s51
    s_lshl_b32 s51, s43, 5
    s_add_u32 s50, s50, s51
    ds_read_b128 v[144:147], v7 offset:14848
    ds_read_b128 v[148:151], v7 offset:29696
    ds_read_b128 v[152:155], v7 offset:44544
    ds_read_b128 v[156:159], v7 offset:59392
    ds_read_b128 v[160:163], v7 offset:14912
    ds_read_b128 v[164:167], v7 offset:29760
    ds_read_b128 v[168:171], v7 offset:44608
    ds_read_b128 v[172:175], v7 offset:59456
    s_waitcnt lgkmcnt(4)
    s_waitcnt vmcnt(27)
    v_mfma_f32_16x16x32_bf16 v[128:131], v[16:19], v[144:147], v[128:131]
    v_mfma_f32_16x16x32_bf16 v[132:135], v[16:19], v[148:151], v[132:135]
    v_mfma_f32_16x16x32_bf16 v[136:139], v[16:19], v[152:155], v[136:139]
    v_mfma_f32_16x16x32_bf16 v[140:143], v[16:19], v[156:159], v[140:143]
    v_mfma_f32_16x16x32_bf16 v[176:179], v[16:19], v[12:15], v[176:179]
    ds_read_b128 v[144:147], v7 offset:14976
    ds_read_b128 v[148:151], v7 offset:29824
    ds_read_b128 v[152:155], v7 offset:44672
    ds_read_b128 v[156:159], v7 offset:59520
    s_waitcnt lgkmcnt(4)
    s_waitcnt vmcnt(25)
    v_mfma_f32_16x16x32_bf16 v[128:131], v[20:23], v[160:163], v[128:131]
    v_mfma_f32_16x16x32_bf16 v[132:135], v[20:23], v[164:167], v[132:135]
    v_mfma_f32_16x16x32_bf16 v[136:139], v[20:23], v[168:171], v[136:139]
    v_mfma_f32_16x16x32_bf16 v[140:143], v[20:23], v[172:175], v[140:143]
    v_mfma_f32_16x16x32_bf16 v[176:179], v[20:23], v[12:15], v[176:179]
    ds_read_b128 v[160:163], v7 offset:15040
    ds_read_b128 v[164:167], v7 offset:29888
    ds_read_b128 v[168:171], v7 offset:44736
    ds_read_b128 v[172:175], v7 offset:59584
    s_waitcnt lgkmcnt(4)
    s_waitcnt vmcnt(23)
    v_mfma_f32_16x16x32_bf16 v[128:131], v[24:27], v[144:147], v[128:131]
    v_mfma_f32_16x16x32_bf16 v[132:135], v[24:27], v[148:151], v[132:135]
    v_mfma_f32_16x16x32_bf16 v[136:139], v[24:27], v[152:155], v[136:139]
    v_mfma_f32_16x16x32_bf16 v[140:143], v[24:27], v[156:159], v[140:143]
    v_mfma_f32_16x16x32_bf16 v[176:179], v[24:27], v[12:15], v[176:179]
    ds_read_b128 v[144:147], v7 offset:15104
    ds_read_b128 v[148:151], v7 offset:29952
    ds_read_b128 v[152:155], v7 offset:44800
    ds_read_b128 v[156:159], v7 offset:59648
    s_waitcnt lgkmcnt(4)
    s_waitcnt vmcnt(21)
    v_mfma_f32_16x16x32_bf16 v[128:131], v[28:31], v[160:163], v[128:131]
    v_mfma_f32_16x16x32_bf16 v[132:135], v[28:31], v[164:167], v[132:135]
    v_mfma_f32_16x16x32_bf16 v[136:139], v[28:31], v[168:171], v[136:139]
    v_mfma_f32_16x16x32_bf16 v[140:143], v[28:31], v[172:175], v[140:143]
    v_mfma_f32_16x16x32_bf16 v[176:179], v[28:31], v[12:15], v[176:179]
    ds_read_b128 v[160:163], v7 offset:15168
    ds_read_b128 v[164:167], v7 offset:30016
    ds_read_b128 v[168:171], v7 offset:44864
    ds_read_b128 v[172:175], v7 offset:59712
    s_waitcnt lgkmcnt(4)
    s_waitcnt vmcnt(19)
    v_mfma_f32_16x16x32_bf16 v[128:131], v[32:35], v[144:147], v[128:131]
    v_mfma_f32_16x16x32_bf16 v[132:135], v[32:35], v[148:151], v[132:135]
    v_mfma_f32_16x16x32_bf16 v[136:139], v[32:35], v[152:155], v[136:139]
    v_mfma_f32_16x16x32_bf16 v[140:143], v[32:35], v[156:159], v[140:143]
    v_mfma_f32_16x16x32_bf16 v[176:179], v[32:35], v[12:15], v[176:179]
    ds_read_b128 v[144:147], v7 offset:15232
    ds_read_b128 v[148:151], v7 offset:30080
    ds_read_b128 v[152:155], v7 offset:44928
    ds_read_b128 v[156:159], v7 offset:59776
    s_waitcnt lgkmcnt(4)
    s_waitcnt vmcnt(17)
    v_mfma_f32_16x16x32_bf16 v[128:131], v[36:39], v[160:163], v[128:131]
    v_mfma_f32_16x16x32_bf16 v[132:135], v[36:39], v[164:167], v[132:135]
    v_mfma_f32_16x16x32_bf16 v[136:139], v[36:39], v[168:171], v[136:139]
    v_mfma_f32_16x16x32_bf16 v[140:143], v[36:39], v[172:175], v[140:143]
    v_mfma_f32_16x16x32_bf16 v[176:179], v[36:39], v[12:15], v[176:179]
    ds_read_b128 v[160:163], v7 offset:15296
    ds_read_b128 v[164:167], v7 offset:30144
    ds_read_b128 v[168:171], v7 offset:44992
    ds_read_b128 v[172:175], v7 offset:59840
    s_waitcnt lgkmcnt(4)
    s_waitcnt vmcnt(15)
    v_mfma_f32_16x16x32_bf16 v[128:131], v[40:43], v[144:147], v[128:131]
    v_mfma_f32_16x16x32_bf16 v[132:135], v[40:43], v[148:151], v[132:135]
    v_mfma_f32_16x16x32_bf16 v[136:139], v[40:43], v[152:155], v[136:139]
    v_mfma_f32_16x16x32_bf16 v[140:143], v[40:43], v[156:159], v[140:143]
    v_mfma_f32_16x16x32_bf16 v[176:179], v[40:43], v[12:15], v[176:179]
    ds_read_b128 v[144:147], v7 offset:15360
    ds_read_b128 v[148:151], v7 offset:30208
    ds_read_b128 v[152:155], v7 offset:45056
    ds_read_b128 v[156:159], v7 offset:59904
    s_waitcnt lgkmcnt(4)
    s_waitcnt vmcnt(13)
    v_mfma_f32_16x16x32_bf16 v[128:131], v[44:47], v[160:163], v[128:131]
    v_mfma_f32_16x16x32_bf16 v[132:135], v[44:47], v[164:167], v[132:135]
    v_mfma_f32_16x16x32_bf16 v[136:139], v[44:47], v[168:171], v[136:139]
    v_mfma_f32_16x16x32_bf16 v[140:143], v[44:47], v[172:175], v[140:143]
    v_mfma_f32_16x16x32_bf16 v[176:179], v[44:47], v[12:15], v[176:179]
    ds_read_b128 v[160:163], v7 offset:15424
    ds_read_b128 v[164:167], v7 offset:30272
    ds_read_b128 v[168:171], v7 offset:45120
    ds_read_b128 v[172:175], v7 offset:59968
    s_waitcnt lgkmcnt(4)
    s_waitcnt vmcnt(11)
    v_mfma_f32_16x16x32_bf16 v[128:131], v[48:51], v[144:147], v[128:131]
    v_mfma_f32_16x16x32_bf16 v[132:135], v[48:51], v[148:151], v[132:135]
    v_mfma_f32_16x16x32_bf16 v[136:139], v[48:51], v[152:155], v[136:139]
    v_mfma_f32_16x16x32_bf16 v[140:143], v[48:51], v[156:159], v[140:143]
    v_mfma_f32_16x16x32_bf16 v[176:179], v[48:51], v[12:15], v[176:179]
    ds_read_b128 v[144:147], v7 offset:15488
    ds_read_b128 v[148:151], v7 offset:30336
    ds_read_b128 v[152:155], v7 offset:45184
    ds_read_b128 v[156:159], v7 offset:60032
    s_waitcnt lgkmcnt(4)
    s_waitcnt vmcnt(9)
    v_mfma_f32_16x16x32_bf16 v[128:131], v[52:55], v[160:163], v[128:131]
    v_mfma_f32_16x16x32_bf16 v[132:135], v[52:55], v[164:167], v[132:135]
    v_mfma_f32_16x16x32_bf16 v[136:139], v[52:55], v[168:171], v[136:139]
    v_mfma_f32_16x16x32_bf16 v[140:143], v[52:55], v[172:175], v[140:143]
    v_mfma_f32_16x16x32_bf16 v[176:179], v[52:55], v[12:15], v[176:179]
    ds_read_b128 v[160:163], v7 offset:15552
    ds_read_b128 v[164:167], v7 offset:30400
    ds_read_b128 v[168:171], v7 offset:45248
    ds_read_b128 v[172:175], v7 offset:60096
    s_waitcnt lgkmcnt(4)
    s_waitcnt vmcnt(7)
    v_mfma_f32_16x16x32_bf16 v[128:131], v[56:59], v[144:147], v[128:131]
    v_mfma_f32_16x16x32_bf16 v[132:135], v[56:59], v[148:151], v[132:135]
    v_mfma_f32_16x16x32_bf16 v[136:139], v[56:59], v[152:155], v[136:139]
    v_mfma_f32_16x16x32_bf16 v[140:143], v[56:59], v[156:159], v[140:143]
    v_mfma_f32_16x16x32_bf16 v[176:179], v[56:59], v[12:15], v[176:179]
    ds_read_b128 v[144:147], v7 offset:15616
    ds_read_b128 v[148:151], v7 offset:30464
    ds_read_b128 v[152:155], v7 offset:45312
    ds_read_b128 v[156:159], v7 offset:60160
    s_waitcnt lgkmcnt(4)
    s_waitcnt vmcnt(5)
    v_mfma_f32_16x16x32_bf16 v[128:131], v[60:63], v[160:163], v[128:131]
    v_mfma_f32_16x16x32_bf16 v[132:135], v[60:63], v[164:167], v[132:135]
    v_mfma_f32_16x16x32_bf16 v[136:139], v[60:63], v[168:171], v[136:139]
    v_mfma_f32_16x16x32_bf16 v[140:143], v[60:63], v[172:175], v[140:143]
    v_mfma_f32_16x16x32_bf16 v[176:179], v[60:63], v[12:15], v[176:179]
    ds_read_b128 v[160:163], v7 offset:15680
    ds_read_b128 v[164:167], v7 offset:30528
    ds_read_b128 v[168:171], v7 offset:45376
    ds_read_b128 v[172:175], v7 offset:60224
    s_waitcnt lgkmcnt(4)
    s_waitcnt vmcnt(3)
    v_mfma_f32_16x16x32_bf16 v[128:131], v[64:67], v[144:147], v[128:131]
    v_mfma_f32_16x16x32_bf16 v[132:135], v[64:67], v[148:151], v[132:135]
    v_mfma_f32_16x16x32_bf16 v[136:139], v[64:67], v[152:155], v[136:139]
    v_mfma_f32_16x16x32_bf16 v[140:143], v[64:67], v[156:159], v[140:143]
    v_mfma_f32_16x16x32_bf16 v[176:179], v[64:67], v[12:15], v[176:179]
    s_waitcnt lgkmcnt(0)
    s_waitcnt vmcnt(1)
    v_mfma_f32_16x16x32_bf16 v[128:131], v[68:71], v[160:163], v[128:131]
    v_mfma_f32_16x16x32_bf16 v[132:135], v[68:71], v[164:167], v[132:135]
    v_mfma_f32_16x16x32_bf16 v[136:139], v[68:71], v[168:171], v[136:139]
    v_mfma_f32_16x16x32_bf16 v[140:143], v[68:71], v[172:175], v[140:143]
    v_mfma_f32_16x16x32_bf16 v[176:179], v[68:71], v[12:15], v[176:179]
    ds_read_b64 v[188:189], v9 offset:128
    ds_read_b64 v[190:191], v9 offset:256
    ds_read_b64 v[192:193], v9 offset:384
    ds_read_b64 v[194:195], v9 offset:512
    s_waitcnt lgkmcnt(0)
    v_mul_u32_u24 v196, 392, v2
    v_lshl_add_u32 v196, v3, 3, v196
    s_lshr_b32 s52, s43, 2
    s_lshl_b32 s52, s52, 7
    s_and_b32 s53, s43, 3
    s_lshl_b32 s53, s53, 5
    s_add_u32 s52, s52, s53
    v_add_u32 v196, s52, v196
    v_mul_f32 v182, v176, v189
    v_fma_f32 v128, v128, v188, -v182
    v_mul_f32 v182, v177, v189
    v_fma_f32 v129, v129, v188, -v182
    v_mul_f32 v182, v178, v189
    v_fma_f32 v130, v130, v188, -v182
    v_mul_f32 v182, v179, v189
    v_fma_f32 v131, v131, v188, -v182
    v_cvt_pk_bf16_f32 v180, v128, v129
    v_cvt_pk_bf16_f32 v181, v130, v131
    ds_write_b64 v196, v[180:181] offset:6912
    v_mul_f32 v182, v176, v191
    v_fma_f32 v132, v132, v190, -v182
    v_mul_f32 v182, v177, v191
    v_fma_f32 v133, v133, v190, -v182
    v_mul_f32 v182, v178, v191
    v_fma_f32 v134, v134, v190, -v182
    v_mul_f32 v182, v179, v191
    v_fma_f32 v135, v135, v190, -v182
    v_cvt_pk_bf16_f32 v180, v132, v133
    v_cvt_pk_bf16_f32 v181, v134, v135
    ds_write_b64 v196, v[180:181] offset:13184
    v_mul_f32 v182, v176, v193
    v_fma_f32 v136, v136, v192, -v182
    v_mul_f32 v182, v177, v193
    v_fma_f32 v137, v137, v192, -v182
    v_mul_f32 v182, v178, v193
    v_fma_f32 v138, v138, v192, -v182
    v_mul_f32 v182, v179, v193
    v_fma_f32 v139, v139, v192, -v182
    v_cvt_pk_bf16_f32 v180, v136, v137
    v_cvt_pk_bf16_f32 v181, v138, v139
    ds_write_b64 v196, v[180:181] offset:19456
    v_mul_f32 v182, v176, v195
    v_fma_f32 v140, v140, v194, -v182
    v_mul_f32 v182, v177, v195
    v_fma_f32 v141, v141, v194, -v182
    v_mul_f32 v182, v178, v195
    v_fma_f32 v142, v142, v194, -v182
    v_mul_f32 v182, v179, v195
    v_fma_f32 v143, v143, v194, -v182
    v_cvt_pk_bf16_f32 v180, v140, v141
    v_cvt_pk_bf16_f32 v181, v142, v143
    ds_write_b64 v196, v[180:181] offset:25728
    s_branch L_qkv1_kernel_end
L_qkv1_kernel_end:
    s_nop 1
    s_waitcnt lgkmcnt(0)
    s_barrier
    v_and_b32 v128, 3, v0
    v_bfe_u32 v129, v0, 2, 1
    v_lshrrev_b32 v130, 3, v0
    v_mul_u32_u24 v131, 392, v130
    v_mul_u32_u24 v134, 56, v129
    v_add_u32 v131, v131, v134
    v_add_u32 v131, 6912, v131
    v_mul_u32_u24 v134, 1568, v128
    v_sub_u32 v132, v131, v134
    v_add_u32 v132, 0xfffffd70, v132
    v_lshlrev_b32 v134, 4, v128
    v_add_u32 v133, v131, v134
    v_add_u32 v133, 0xffffeb90, v133
    ds_read_b64 v[138:139], v131 offset:0
    ds_read_b64 v[140:141], v131 offset:8
    ds_read_b64 v[142:143], v131 offset:16
    ds_read_b64 v[144:145], v131 offset:24
    ds_read_b64 v[146:147], v131 offset:32
    ds_read_b64 v[148:149], v131 offset:40
    ds_read_b64 v[150:151], v131 offset:48
    ds_read_b64 v[152:153], v132 offset:784
    ds_read_b64 v[154:155], v132 offset:792
    ds_read_b64 v[156:157], v132 offset:800
    ds_read_b64 v[158:159], v132 offset:808
    ds_read_b64 v[160:161], v132 offset:816
    ds_read_b64 v[162:163], v132 offset:824
    ds_read_b64 v[164:165], v132 offset:832
    ds_read_b64 v[166:167], v132 offset:0
    ds_read_b64 v[168:169], v132 offset:8
    ds_read_b64 v[170:171], v132 offset:16
    ds_read_b64 v[172:173], v132 offset:24
    ds_read_b64 v[174:175], v132 offset:32
    ds_read_b64 v[176:177], v132 offset:40
    ds_read_b64 v[178:179], v132 offset:48
    ds_read_b64 v[180:181], v133 offset:5488
    ds_read_b64 v[182:183], v133 offset:5496
    ds_read_b64 v[184:185], v133 offset:4704
    ds_read_b64 v[186:187], v133 offset:4712
    ds_read_b64 v[188:189], v133 offset:3920
    ds_read_b64 v[190:191], v133 offset:3928
    ds_read_b64 v[192:193], v133 offset:3136
    ds_read_b64 v[194:195], v133 offset:3144
    ds_read_b64 v[196:197], v133 offset:2352
    ds_read_b64 v[198:199], v133 offset:2360
    ds_read_b64 v[200:201], v133 offset:1568
    ds_read_b64 v[202:203], v133 offset:1576
    ds_read_b64 v[204:205], v133 offset:784
    ds_read_b64 v[206:207], v133 offset:792
    ds_read_b64 v[208:209], v133 offset:0
    ds_read_b64 v[210:211], v133 offset:8
    v_mov_b32 v212, 0
    v_mov_b32 v213, 0
    s_waitcnt lgkmcnt(0)
    v_dot2_f32_bf16 v212, v138, v152, v212
    v_dot2_f32_bf16 v213, v138, v166, v213
    v_dot2_f32_bf16 v212, v139, v153, v212
    v_dot2_f32_bf16 v213, v139, v167, v213
    v_dot2_f32_bf16 v212, v140, v154, v212
    v_dot2_f32_bf16 v213, v140, v168, v213
    v_dot2_f32_bf16 v212, v141, v155, v212
    v_dot2_f32_bf16 v213, v141, v169, v213
    v_dot2_f32_bf16 v212, v142, v156, v212
    v_dot2_f32_bf16 v213, v142, v170, v213
    v_dot2_f32_bf16 v212, v143, v157, v212
    v_dot2_f32_bf16 v213, v143, v171, v213
    v_dot2_f32_bf16 v212, v144, v158, v212
    v_dot2_f32_bf16 v213, v144, v172, v213
    v_dot2_f32_bf16 v212, v145, v159, v212
    v_dot2_f32_bf16 v213, v145, v173, v213
    v_dot2_f32_bf16 v212, v146, v160, v212
    v_dot2_f32_bf16 v213, v146, v174, v213
    v_dot2_f32_bf16 v212, v147, v161, v212
    v_dot2_f32_bf16 v213, v147, v175, v213
    v_dot2_f32_bf16 v212, v148, v162, v212
    v_dot2_f32_bf16 v213, v148, v176, v213
    v_dot2_f32_bf16 v212, v149, v163, v212
    v_dot2_f32_bf16 v213, v149, v177, v213
    v_dot2_f32_bf16 v212, v150, v164, v212
    v_dot2_f32_bf16 v213, v150, v178, v213
    v_dot2_f32_bf16 v212, v151, v165, v212
    v_dot2_f32_bf16 v213, v151, v179, v213
    s_nop 2
    v_cvt_pk_bf16_f32 v134, v212, v213
    v_lshlrev_b32 v212, 16, v134
    v_and_b32 v213, 0xffff0000, v134
    v_mul_f32 v212, 0x3e41848f, v212
    v_mul_f32 v213, 0x3e41848f, v213
    v_cvt_pk_bf16_f32 v134, v212, v213
    v_lshlrev_b32 v212, 16, v134
    v_and_b32 v213, 0xffff0000, v134
    v_add_u32 v135, s6, v130
    v_lshlrev_b32 v136, 2, v128
    v_sub_u32 v135, v135, v136
    v_mov_b32 v137, 0xce6e6b28
    v_cmp_gt_i32 vcc, 0, v135
    s_nop 1
    v_cndmask_b32 v212, v212, v137, vcc
    v_cmp_gt_i32 vcc, 2, v135
    s_nop 1
    v_cndmask_b32 v213, v213, v137, vcc
    v_max_f32 v134, v212, v213
    s_nop 1
    v_max_f32_dpp v135, v134, v134 quad_perm:[1,0,3,2] row_mask:0xf bank_mask:0xf
    s_nop 1
    v_max_f32_dpp v134, v135, v135 quad_perm:[2,3,0,1] row_mask:0xf bank_mask:0xf
    v_sub_f32 v212, v212, v134
    v_sub_f32 v213, v213, v134
    v_mul_f32 v212, 0x3fb8aa3b, v212
    v_mul_f32 v213, 0x3fb8aa3b, v213
    v_exp_f32 v212, v212
    v_exp_f32 v213, v213
    s_nop 0
    v_add_f32 v134, v212, v213
    s_nop 1
    v_add_f32_dpp v135, v134, v134 quad_perm:[1,0,3,2] row_mask:0xf bank_mask:0xf
    s_nop 1
    v_add_f32_dpp v134, v135, v135 quad_perm:[2,3,0,1] row_mask:0xf bank_mask:0xf
    v_rcp_f32 v134, v134
    s_nop 0
    v_mul_f32 v212, v212, v134
    v_mul_f32 v213, v213, v134
    v_cvt_pk_bf16_f32 v134, v212, v213
    s_nop 1
    v_mov_b32_dpp v214, v134 quad_perm:[0,0,0,0] row_mask:0xf bank_mask:0xf
    v_mov_b32_dpp v215, v134 quad_perm:[1,1,1,1] row_mask:0xf bank_mask:0xf
    v_mov_b32_dpp v216, v134 quad_perm:[2,2,2,2] row_mask:0xf bank_mask:0xf
    v_mov_b32_dpp v217, v134 quad_perm:[3,3,3,3] row_mask:0xf bank_mask:0xf
    v_mov_b32 v218, 0
    v_mov_b32 v219, 0
    v_mov_b32 v220, 0
    v_mov_b32 v221, 0
    v_mov_b32 v222, 0
    v_mov_b32 v223, 0
    v_mov_b32 v224, 0
    v_mov_b32 v225, 0
    s_mov_b32 s52, 0x05040100
    s_mov_b32 s53, 0x07060302
    v_perm_b32 v134, v184, v180, s52
    v_perm_b32 v135, v184, v180, s53
    v_dot2_f32_bf16 v218, v134, v214, v218
    v_dot2_f32_bf16 v219, v135, v214, v219
    v_perm_b32 v134, v185, v181, s52
    v_perm_b32 v135, v185, v181, s53
    v_dot2_f32_bf16 v220, v134, v214, v220
    v_dot2_f32_bf16 v221, v135, v214, v221
    v_perm_b32 v134, v186, v182, s52
    v_perm_b32 v135, v186, v182, s53
    v_dot2_f32_bf16 v222, v134, v214, v222
    v_dot2_f32_bf16 v223, v135, v214, v223
    v_perm_b32 v134, v187, v183, s52
    v_perm_b32 v135, v187, v183, s53
    v_dot2_f32_bf16 v224, v134, v214, v224
    v_dot2_f32_bf16 v225, v135, v214, v225
    v_perm_b32 v134, v192, v188, s52
    v_perm_b32 v135, v192, v188, s53
    v_dot2_f32_bf16 v218, v134, v215, v218
    v_dot2_f32_bf16 v219, v135, v215, v219
    v_perm_b32 v134, v193, v189, s52
    v_perm_b32 v135, v193, v189, s53
    v_dot2_f32_bf16 v220, v134, v215, v220
    v_dot2_f32_bf16 v221, v135, v215, v221
    v_perm_b32 v134, v194, v190, s52
    v_perm_b32 v135, v194, v190, s53
    v_dot2_f32_bf16 v222, v134, v215, v222
    v_dot2_f32_bf16 v223, v135, v215, v223
    v_perm_b32 v134, v195, v191, s52
    v_perm_b32 v135, v195, v191, s53
    v_dot2_f32_bf16 v224, v134, v215, v224
    v_dot2_f32_bf16 v225, v135, v215, v225
    v_perm_b32 v134, v200, v196, s52
    v_perm_b32 v135, v200, v196, s53
    v_dot2_f32_bf16 v218, v134, v216, v218
    v_dot2_f32_bf16 v219, v135, v216, v219
    v_perm_b32 v134, v201, v197, s52
    v_perm_b32 v135, v201, v197, s53
    v_dot2_f32_bf16 v220, v134, v216, v220
    v_dot2_f32_bf16 v221, v135, v216, v221
    v_perm_b32 v134, v202, v198, s52
    v_perm_b32 v135, v202, v198, s53
    v_dot2_f32_bf16 v222, v134, v216, v222
    v_dot2_f32_bf16 v223, v135, v216, v223
    v_perm_b32 v134, v203, v199, s52
    v_perm_b32 v135, v203, v199, s53
    v_dot2_f32_bf16 v224, v134, v216, v224
    v_dot2_f32_bf16 v225, v135, v216, v225
    v_perm_b32 v134, v208, v204, s52
    v_perm_b32 v135, v208, v204, s53
    v_dot2_f32_bf16 v218, v134, v217, v218
    v_dot2_f32_bf16 v219, v135, v217, v219
    v_perm_b32 v134, v209, v205, s52
    v_perm_b32 v135, v209, v205, s53
    v_dot2_f32_bf16 v220, v134, v217, v220
    v_dot2_f32_bf16 v221, v135, v217, v221
    v_perm_b32 v134, v210, v206, s52
    v_perm_b32 v135, v210, v206, s53
    v_dot2_f32_bf16 v222, v134, v217, v222
    v_dot2_f32_bf16 v223, v135, v217, v223
    v_perm_b32 v134, v211, v207, s52
    v_perm_b32 v135, v211, v207, s53
    v_dot2_f32_bf16 v224, v134, v217, v224
    v_dot2_f32_bf16 v225, v135, v217, v225
    v_cvt_pk_bf16_f32 v226, v218, v219
    v_cvt_pk_bf16_f32 v227, v220, v221
    v_cvt_pk_bf16_f32 v228, v222, v223
    v_cvt_pk_bf16_f32 v229, v224, v225
    v_add_u32 v135, s6, v130
    v_mul_u32_u24 v135, 896, v135
    v_lshl_add_u32 v136, s5, 1, v129
    v_mul_u32_u24 v136, 56, v136
    v_lshlrev_b32 v137, 4, v128
    v_add3_u32 v135, v135, v136, v137
    buffer_store_dwordx2 v[226:227], v135, s[16:19], 0 offen
    v_cmp_gt_u32 vcc, 3, v128
    s_and_saveexec_b64 s[54:55], vcc
    buffer_store_dwordx2 v[228:229], v135, s[16:19], 0 offen offset:8
    s_mov_b64 exec, s[54:55]
L_qkv1_kernel_done:
    s_endpgm
.globl wo1_kernel
.p2align 8
.type wo1_kernel,@function
wo1_kernel:
    s_cmp_ge_u32 s2, 256
    s_cbranch_scc1 L_wo1_kernel_done
    s_load_dwordx4 s[32:35], s[0:1], 0
    s_load_dwordx4 s[36:39], s[0:1], 64
    s_load_dwordx2 s[40:41], s[0:1], 80
    v_lshrrev_b32 v4, 6, v0
    v_and_b32 v1, 63, v0
    v_readfirstlane_b32 s3, v4
    s_lshr_b32 s7, s2, 3
    s_mul_hi_u32 s4, s7, 0x40000000
    s_mul_i32 s42, s4, 4
    s_sub_u32 s5, s7, s42
    s_and_b32 s7, s2, 7
    s_mul_i32 s7, s7, 8
    s_add_u32 s4, s4, s7
    s_mul_i32 s6, s4, 32
    v_and_b32 v2, 15, v1
    v_lshrrev_b32 v3, 4, v1
    s_mov_b32 s28, 0x3f803f80
    s_mov_b32 s29, 0x3d372713
    s_mov_b32 s30, 0xc0135761
    s_waitcnt lgkmcnt(0)
    s_mov_b32 s8, s40
    s_mov_b32 s9, s41
    s_and_b32 s9, s9, 0xffff
    s_mov_b32 s10, 0x10000000
    s_mov_b32 s11, 0x00020000
    s_add_u32 s12, s40, 0x2306000
    s_addc_u32 s13, s41, 0
    s_and_b32 s13, s13, 0xffff
    s_mov_b32 s14, 0x1c0000
    s_mov_b32 s15, 0x00020000
    s_add_u32 s16, s40, 0x24c6000
    s_addc_u32 s17, s41, 0
    s_and_b32 s17, s17, 0xffff
    s_mov_b32 s18, 0x1c0000
    s_mov_b32 s19, 0x00020000
    s_add_u32 s20, s40, 0x1446000
    s_addc_u32 s21, s41, 0
    s_and_b32 s21, s21, 0xffff
    s_mov_b32 s22, 0x1c0000
    s_mov_b32 s23, 0x00020000
    v_lshrrev_b32 v82, 4, v1
    v_and_b32 v83, 15, v1
    s_mul_i32 s42, s3, 4
    v_add_u32 v82, s42, v82
    v_mul_u32_u24 v85, 928, v82
    v_lshl_add_u32 v85, v83, 3, v85
    v_add_u32 v85, 256, v85
    v_add_u32 v84, s6, v82
    s_movk_i32 s42, 896
    v_mul_lo_u32 v84, v84, s42
    v_lshl_add_u32 v84, v83, 3, v84
    buffer_load_dwordx2 v[68:69], v84, s[12:15], 0 offen offset:0
    buffer_load_dwordx2 v[70:71], v84, s[12:15], 0 offen offset:128
    buffer_load_dwordx2 v[72:73], v84, s[12:15], 0 offen offset:256
    buffer_load_dwordx2 v[74:75], v84, s[12:15], 0 offen offset:384
    buffer_load_dwordx2 v[76:77], v84, s[12:15], 0 offen offset:512
    buffer_load_dwordx2 v[78:79], v84, s[12:15], 0 offen offset:640
    buffer_load_dwordx2 v[80:81], v84, s[12:15], 0 offen offset:768
    v_lshlrev_b32 v6, 4, v1
    s_mov_b32 s43, 0
    s_cmp_eq_u32 s3, 1
    s_cselect_b32 s43, 1, s43
    s_cmp_eq_u32 s3, 2
    s_cselect_b32 s43, 2, s43
    s_cmp_eq_u32 s3, 3
    s_cselect_b32 s43, 3, s43
    s_cmp_eq_u32 s3, 4
    s_cselect_b32 s43, 4, s43
    s_cmp_eq_u32 s3, 5
    s_cselect_b32 s43, 5, s43
    s_cmp_eq_u32 s3, 6
    s_cselect_b32 s43, 6, s43
    s_mul_i32 s48, s5, 7
    s_add_u32 s48, s48, s43
    s_mul_i32 s48, s48, 14336
    s_add_u32 s48, s48, 0x150000
    s_barrier
    buffer_load_dwordx4 v[12:15], v6, s[8:11], s48 offen offset:0
    buffer_load_dwordx4 v[16:19], v6, s[8:11], s48 offen offset:1024
    buffer_load_dwordx4 v[20:23], v6, s[8:11], s48 offen offset:2048
    buffer_load_dwordx4 v[24:27], v6, s[8:11], s48 offen offset:3072
    s_add_u32 s49, s48, 0x1000
    buffer_load_dwordx4 v[28:31], v6, s[8:11], s49 offen offset:0
    s_add_u32 s49, s48, 0x1000
    buffer_load_dwordx4 v[32:35], v6, s[8:11], s49 offen offset:1024
    s_add_u32 s49, s48, 0x1000
    buffer_load_dwordx4 v[36:39], v6, s[8:11], s49 offen offset:2048
    s_add_u32 s49, s48, 0x1000
    buffer_load_dwordx4 v[40:43], v6, s[8:11], s49 offen offset:3072
    s_add_u32 s49, s48, 0x2000
    buffer_load_dwordx4 v[44:47], v6, s[8:11], s49 offen offset:0
    s_add_u32 s49, s48, 0x2000
    buffer_load_dwordx4 v[48:51], v6, s[8:11], s49 offen offset:1024
    s_add_u32 s49, s48, 0x2000
    buffer_load_dwordx4 v[52:55], v6, s[8:11], s49 offen offset:2048
    s_add_u32 s49, s48, 0x2000
    buffer_load_dwordx4 v[56:59], v6, s[8:11], s49 offen offset:3072
    s_add_u32 s49, s48, 0x3000
    buffer_load_dwordx4 v[60:63], v6, s[8:11], s49 offen offset:0
    s_add_u32 s49, s48, 0x3000
    buffer_load_dwordx4 v[64:67], v6, s[8:11], s49 offen offset:1024
    s_waitcnt vmcnt(14)
    ds_write_b64 v85, v[68:69] offset:0
    ds_write_b64 v85, v[70:71] offset:128
    ds_write_b64 v85, v[72:73] offset:256
    ds_write_b64 v85, v[74:75] offset:384
    ds_write_b64 v85, v[76:77] offset:512
    ds_write_b64 v85, v[78:79] offset:640
    ds_write_b64 v85, v[80:81] offset:768
    s_waitcnt lgkmcnt(0)
    s_barrier
    v_mul_u32_u24 v7, 928, v2
    v_lshl_add_u32 v7, v3, 4, v7
    v_add_u32 v7, 256, v7
    s_movk_i32 s42, 896
    v_mul_lo_u32 v8, v2, s42
    v_lshl_add_u32 v8, v3, 3, v8
    v_lshlrev_b32 v9, 3, v2
    s_cmp_eq_u32 s3, 0
    s_cbranch_scc1 L_wo1_kernel_var_1
    s_cmp_eq_u32 s3, 1
    s_cbranch_scc1 L_wo1_kernel_var_1
    s_cmp_eq_u32 s3, 2
    s_cbranch_scc1 L_wo1_kernel_var_1
    s_cmp_eq_u32 s3, 3
    s_cbranch_scc1 L_wo1_kernel_var_1
    s_cmp_eq_u32 s3, 4
    s_cbranch_scc1 L_wo1_kernel_var_1
    s_cmp_eq_u32 s3, 5
    s_cbranch_scc1 L_wo1_kernel_var_1
    s_cmp_eq_u32 s3, 6
    s_cbranch_scc1 L_wo1_kernel_var_1
    s_branch L_wo1_kernel_end
L_wo1_kernel_var_1:
    s_nop 4
    v_mov_b32 v68, 0
    v_mov_b32 v69, 0
    v_mov_b32 v70, 0
    v_mov_b32 v71, 0
    v_mov_b32 v72, 0
    v_mov_b32 v73, 0
    v_mov_b32 v74, 0
    v_mov_b32 v75, 0
    s_mul_i32 s50, s6, 896
    s_mul_i32 s51, s5, 224
    s_add_u32 s50, s50, s51
    s_lshl_b32 s51, s43, 5
    s_add_u32 s50, s50, s51
    buffer_load_dwordx2 v[92:93], v8, s[20:23], s50 offen offset:0
    s_add_u32 s52, s50, 14336
    buffer_load_dwordx2 v[94:95], v8, s[20:23], s52 offen offset:0
    ds_read_b128 v[76:79], v7 offset:0
    ds_read_b128 v[80:83], v7 offset:14848
    ds_read_b128 v[84:87], v7 offset:64
    ds_read_b128 v[88:91], v7 offset:14912
    s_waitcnt lgkmcnt(2)
    s_waitcnt vmcnt(15)
    v_mfma_f32_16x16x32_bf16 v[68:71], v[12:15], v[76:79], v[68:71]
    v_mfma_f32_16x16x32_bf16 v[72:75], v[12:15], v[80:83], v[72:75]
    ds_read_b128 v[76:79], v7 offset:128
    ds_read_b128 v[80:83], v7 offset:14976
    s_waitcnt lgkmcnt(2)
    s_waitcnt vmcnt(14)
    v_mfma_f32_16x16x32_bf16 v[68:71], v[16:19], v[84:87], v[68:71]
    v_mfma_f32_16x16x32_bf16 v[72:75], v[16:19], v[88:91], v[72:75]
    ds_read_b128 v[84:87], v7 offset:192
    ds_read_b128 v[88:91], v7 offset:15040
    s_waitcnt lgkmcnt(2)
    s_waitcnt vmcnt(13)
    v_mfma_f32_16x16x32_bf16 v[68:71], v[20:23], v[76:79], v[68:71]
    v_mfma_f32_16x16x32_bf16 v[72:75], v[20:23], v[80:83], v[72:75]
    ds_read_b128 v[76:79], v7 offset:256
    ds_read_b128 v[80:83], v7 offset:15104
    s_waitcnt lgkmcnt(2)
    s_waitcnt vmcnt(12)
    v_mfma_f32_16x16x32_bf16 v[68:71], v[24:27], v[84:87], v[68:71]
    v_mfma_f32_16x16x32_bf16 v[72:75], v[24:27], v[88:91], v[72:75]
    ds_read_b128 v[84:87], v7 offset:320
    ds_read_b128 v[88:91], v7 offset:15168
    s_waitcnt lgkmcnt(2)
    s_waitcnt vmcnt(11)
    v_mfma_f32_16x16x32_bf16 v[68:71], v[28:31], v[76:79], v[68:71]
    v_mfma_f32_16x16x32_bf16 v[72:75], v[28:31], v[80:83], v[72:75]
    ds_read_b128 v[76:79], v7 offset:384
    ds_read_b128 v[80:83], v7 offset:15232
    s_waitcnt lgkmcnt(2)
    s_waitcnt vmcnt(10)
    v_mfma_f32_16x16x32_bf16 v[68:71], v[32:35], v[84:87], v[68:71]
    v_mfma_f32_16x16x32_bf16 v[72:75], v[32:35], v[88:91], v[72:75]
    ds_read_b128 v[84:87], v7 offset:448
    ds_read_b128 v[88:91], v7 offset:15296
    s_waitcnt lgkmcnt(2)
    s_waitcnt vmcnt(9)
    v_mfma_f32_16x16x32_bf16 v[68:71], v[36:39], v[76:79], v[68:71]
    v_mfma_f32_16x16x32_bf16 v[72:75], v[36:39], v[80:83], v[72:75]
    ds_read_b128 v[76:79], v7 offset:512
    ds_read_b128 v[80:83], v7 offset:15360
    s_waitcnt lgkmcnt(2)
    s_waitcnt vmcnt(8)
    v_mfma_f32_16x16x32_bf16 v[68:71], v[40:43], v[84:87], v[68:71]
    v_mfma_f32_16x16x32_bf16 v[72:75], v[40:43], v[88:91], v[72:75]
    ds_read_b128 v[84:87], v7 offset:576
    ds_read_b128 v[88:91], v7 offset:15424
    s_waitcnt lgkmcnt(2)
    s_waitcnt vmcnt(7)
    v_mfma_f32_16x16x32_bf16 v[68:71], v[44:47], v[76:79], v[68:71]
    v_mfma_f32_16x16x32_bf16 v[72:75], v[44:47], v[80:83], v[72:75]
    ds_read_b128 v[76:79], v7 offset:640
    ds_read_b128 v[80:83], v7 offset:15488
    s_waitcnt lgkmcnt(2)
    s_waitcnt vmcnt(6)
    v_mfma_f32_16x16x32_bf16 v[68:71], v[48:51], v[84:87], v[68:71]
    v_mfma_f32_16x16x32_bf16 v[72:75], v[48:51], v[88:91], v[72:75]
    ds_read_b128 v[84:87], v7 offset:704
    ds_read_b128 v[88:91], v7 offset:15552
    s_waitcnt lgkmcnt(2)
    s_waitcnt vmcnt(5)
    v_mfma_f32_16x16x32_bf16 v[68:71], v[52:55], v[76:79], v[68:71]
    v_mfma_f32_16x16x32_bf16 v[72:75], v[52:55], v[80:83], v[72:75]
    ds_read_b128 v[76:79], v7 offset:768
    ds_read_b128 v[80:83], v7 offset:15616
    s_waitcnt lgkmcnt(2)
    s_waitcnt vmcnt(4)
    v_mfma_f32_16x16x32_bf16 v[68:71], v[56:59], v[84:87], v[68:71]
    v_mfma_f32_16x16x32_bf16 v[72:75], v[56:59], v[88:91], v[72:75]
    ds_read_b128 v[84:87], v7 offset:832
    ds_read_b128 v[88:91], v7 offset:15680
    s_waitcnt lgkmcnt(2)
    s_waitcnt vmcnt(3)
    v_mfma_f32_16x16x32_bf16 v[68:71], v[60:63], v[76:79], v[68:71]
    v_mfma_f32_16x16x32_bf16 v[72:75], v[60:63], v[80:83], v[72:75]
    s_waitcnt lgkmcnt(0)
    s_waitcnt vmcnt(2)
    v_mfma_f32_16x16x32_bf16 v[68:71], v[64:67], v[84:87], v[68:71]
    v_mfma_f32_16x16x32_bf16 v[72:75], v[64:67], v[88:91], v[72:75]
    s_waitcnt vmcnt(0)
    s_nop 5
    v_cvt_pk_bf16_f32 v96, v68, v69
    v_cvt_pk_bf16_f32 v97, v70, v71
    v_lshlrev_b32 v100, 16, v92
    v_and_b32 v101, 0xffff0000, v92
    v_lshlrev_b32 v98, 16, v96
    v_and_b32 v99, 0xffff0000, v96
    v_add_f32 v98, v98, v100
    v_add_f32 v99, v99, v101
    v_cvt_pk_bf16_f32 v96, v98, v99
    v_lshlrev_b32 v100, 16, v93
    v_and_b32 v101, 0xffff0000, v93
    v_lshlrev_b32 v98, 16, v97
    v_and_b32 v99, 0xffff0000, v97
    v_add_f32 v98, v98, v100
    v_add_f32 v99, v99, v101
    v_cvt_pk_bf16_f32 v97, v98, v99
    buffer_store_dwordx2 v[96:97], v8, s[16:19], s50 offen offset:0
    s_add_u32 s52, s50, 14336
    v_cvt_pk_bf16_f32 v96, v72, v73
    v_cvt_pk_bf16_f32 v97, v74, v75
    v_lshlrev_b32 v100, 16, v94
    v_and_b32 v101, 0xffff0000, v94
    v_lshlrev_b32 v98, 16, v96
    v_and_b32 v99, 0xffff0000, v96
    v_add_f32 v98, v98, v100
    v_add_f32 v99, v99, v101
    v_cvt_pk_bf16_f32 v96, v98, v99
    v_lshlrev_b32 v100, 16, v95
    v_and_b32 v101, 0xffff0000, v95
    v_lshlrev_b32 v98, 16, v97
    v_and_b32 v99, 0xffff0000, v97
    v_add_f32 v98, v98, v100
    v_add_f32 v99, v99, v101
    v_cvt_pk_bf16_f32 v97, v98, v99
    buffer_store_dwordx2 v[96:97], v8, s[16:19], s52 offen offset:0
    s_branch L_wo1_kernel_end
L_wo1_kernel_end:
    s_nop 1
L_wo1_kernel_done:
    s_endpgm
.globl w11_kernel
.p2align 8
.type w11_kernel,@function
w11_kernel:
    s_cmp_ge_u32 s2, 256
    s_cbranch_scc1 L_w11_kernel_done
    s_load_dwordx4 s[32:35], s[0:1], 0
    s_load_dwordx4 s[36:39], s[0:1], 64
    s_load_dwordx2 s[40:41], s[0:1], 80
    v_lshrrev_b32 v4, 6, v0
    v_and_b32 v1, 63, v0
    v_readfirstlane_b32 s3, v4
    s_lshr_b32 s7, s2, 3
    s_mul_hi_u32 s4, s7, 0x40000000
    s_mul_i32 s42, s4, 4
    s_sub_u32 s5, s7, s42
    s_and_b32 s7, s2, 7
    s_mul_i32 s7, s7, 8
    s_add_u32 s4, s4, s7
    s_mul_i32 s6, s4, 32
    v_and_b32 v2, 15, v1
    v_lshrrev_b32 v3, 4, v1
    s_mov_b32 s28, 0x3f803f80
    s_mov_b32 s29, 0x3d372713
    s_mov_b32 s30, 0xc0135761
    s_waitcnt lgkmcnt(0)
    s_mov_b32 s8, s40
    s_mov_b32 s9, s41
    s_and_b32 s9, s9, 0xffff
    s_mov_b32 s10, 0x10000000
    s_mov_b32 s11, 0x00020000
    s_add_u32 s12, s40, 0x24c6000
    s_addc_u32 s13, s41, 0
    s_and_b32 s13, s13, 0xffff
    s_mov_b32 s14, 0x1c0000
    s_mov_b32 s15, 0x00020000
    s_add_u32 s16, s40, 0x2846000
    s_addc_u32 s17, s41, 0
    s_and_b32 s17, s17, 0xffff
    s_mov_b32 s18, 0x1c0000
    s_mov_b32 s19, 0x00020000
    s_add_u32 s44, s40, 0x348a000
    s_addc_u32 s45, s41, 0
    s_and_b32 s45, s45, 0xffff
    s_mov_b32 s46, 0x4000
    s_mov_b32 s47, 0x00020000
    v_lshrrev_b32 v86, 4, v1
    v_and_b32 v87, 15, v1
    s_mul_i32 s42, s3, 4
    v_add_u32 v86, s42, v86
    v_mul_u32_u24 v89, 928, v86
    v_lshl_add_u32 v89, v87, 3, v89
    v_add_u32 v89, 256, v89
    v_add_u32 v88, s6, v86
    s_movk_i32 s42, 896
    v_mul_lo_u32 v88, v88, s42
    v_lshl_add_u32 v88, v87, 3, v88
    buffer_load_dwordx2 v[72:73], v88, s[12:15], 0 offen offset:0
    buffer_load_dwordx2 v[74:75], v88, s[12:15], 0 offen offset:128
    buffer_load_dwordx2 v[76:77], v88, s[12:15], 0 offen offset:256
    buffer_load_dwordx2 v[78:79], v88, s[12:15], 0 offen offset:384
    buffer_load_dwordx2 v[80:81], v88, s[12:15], 0 offen offset:512
    buffer_load_dwordx2 v[82:83], v88, s[12:15], 0 offen offset:640
    buffer_load_dwordx2 v[84:85], v88, s[12:15], 0 offen offset:768
    v_lshlrev_b32 v6, 4, v1
    s_mov_b32 s43, 0
    s_cmp_eq_u32 s3, 1
    s_cselect_b32 s43, 1, s43
    s_cmp_eq_u32 s3, 2
    s_cselect_b32 s43, 2, s43
    s_cmp_eq_u32 s3, 3
    s_cselect_b32 s43, 3, s43
    s_cmp_eq_u32 s3, 4
    s_cselect_b32 s43, 4, s43
    s_cmp_eq_u32 s3, 5
    s_cselect_b32 s43, 5, s43
    s_cmp_eq_u32 s3, 6
    s_cselect_b32 s43, 6, s43
    s_mul_i32 s48, s5, 7
    s_add_u32 s48, s48, s43
    s_mul_i32 s48, s48, 14336
    s_add_u32 s48, s48, 0x1b2000
    s_barrier
    buffer_load_dwordx4 v[16:19], v6, s[8:11], s48 offen offset:0
    buffer_load_dwordx4 v[20:23], v6, s[8:11], s48 offen offset:1024
    buffer_load_dwordx4 v[24:27], v6, s[8:11], s48 offen offset:2048
    buffer_load_dwordx4 v[28:31], v6, s[8:11], s48 offen offset:3072
    s_add_u32 s49, s48, 0x1000
    buffer_load_dwordx4 v[32:35], v6, s[8:11], s49 offen offset:0
    s_add_u32 s49, s48, 0x1000
    buffer_load_dwordx4 v[36:39], v6, s[8:11], s49 offen offset:1024
    s_add_u32 s49, s48, 0x1000
    buffer_load_dwordx4 v[40:43], v6, s[8:11], s49 offen offset:2048
    s_add_u32 s49, s48, 0x1000
    buffer_load_dwordx4 v[44:47], v6, s[8:11], s49 offen offset:3072
    s_add_u32 s49, s48, 0x2000
    buffer_load_dwordx4 v[48:51], v6, s[8:11], s49 offen offset:0
    s_add_u32 s49, s48, 0x2000
    buffer_load_dwordx4 v[52:55], v6, s[8:11], s49 offen offset:1024
    s_add_u32 s49, s48, 0x2000
    buffer_load_dwordx4 v[56:59], v6, s[8:11], s49 offen offset:2048
    s_add_u32 s49, s48, 0x2000
    buffer_load_dwordx4 v[60:63], v6, s[8:11], s49 offen offset:3072
    s_add_u32 s49, s48, 0x3000
    buffer_load_dwordx4 v[64:67], v6, s[8:11], s49 offen offset:0
    s_add_u32 s49, s48, 0x3000
    buffer_load_dwordx4 v[68:71], v6, s[8:11], s49 offen offset:1024
    s_waitcnt vmcnt(14)
    v_mov_b32 v94, 0
    v_mov_b32 v95, 0
    v_mov_b32 v98, 0
    v_mov_b32 v99, 0
    v_dot2_f32_bf16 v94, v72, s28, v94
    v_dot2_f32_bf16 v95, v72, v72, v95
    v_dot2_f32_bf16 v98, v73, s28, v98
    v_dot2_f32_bf16 v99, v73, v73, v99
    v_dot2_f32_bf16 v94, v74, s28, v94
    v_dot2_f32_bf16 v95, v74, v74, v95
    v_dot2_f32_bf16 v98, v75, s28, v98
    v_dot2_f32_bf16 v99, v75, v75, v99
    v_dot2_f32_bf16 v94, v76, s28, v94
    v_dot2_f32_bf16 v95, v76, v76, v95
    v_dot2_f32_bf16 v98, v77, s28, v98
    v_dot2_f32_bf16 v99, v77, v77, v99
    v_dot2_f32_bf16 v94, v78, s28, v94
    v_dot2_f32_bf16 v95, v78, v78, v95
    v_dot2_f32_bf16 v98, v79, s28, v98
    v_dot2_f32_bf16 v99, v79, v79, v99
    v_dot2_f32_bf16 v94, v80, s28, v94
    v_dot2_f32_bf16 v95, v80, v80, v95
    v_dot2_f32_bf16 v98, v81, s28, v98
    v_dot2_f32_bf16 v99, v81, v81, v99
    v_dot2_f32_bf16 v94, v82, s28, v94
    v_dot2_f32_bf16 v95, v82, v82, v95
    v_dot2_f32_bf16 v98, v83, s28, v98
    v_dot2_f32_bf16 v99, v83, v83, v99
    v_dot2_f32_bf16 v94, v84, s28, v94
    v_dot2_f32_bf16 v95, v84, v84, v95
    v_dot2_f32_bf16 v98, v85, s28, v98
    v_dot2_f32_bf16 v99, v85, v85, v99
    s_nop 1
    v_add_f32 v94, v94, v98
    v_add_f32 v95, v95, v99
    s_nop 0
    v_add_f32_dpp v96, v94, v94 quad_perm:[1,0,3,2] row_mask:0xf bank_mask:0xf
    s_nop 1
    v_add_f32_dpp v94, v96, v96 quad_perm:[2,3,0,1] row_mask:0xf bank_mask:0xf
    s_nop 1
    v_add_f32_dpp v96, v94, v94 row_half_mirror row_mask:0xf bank_mask:0xf
    s_nop 1
    v_add_f32_dpp v94, v96, v96 row_mirror row_mask:0xf bank_mask:0xf
    v_add_f32_dpp v96, v95, v95 quad_perm:[1,0,3,2] row_mask:0xf bank_mask:0xf
    s_nop 1
    v_add_f32_dpp v95, v96, v96 quad_perm:[2,3,0,1] row_mask:0xf bank_mask:0xf
    s_nop 1
    v_add_f32_dpp v96, v95, v95 row_half_mirror row_mask:0xf bank_mask:0xf
    s_nop 1
    v_add_f32_dpp v95, v96, v96 row_mirror row_mask:0xf bank_mask:0xf
    v_mul_f32 v94, 0x3b124925, v94
    v_mul_f32 v95, 0x3b124925, v95
    v_fma_f32 v95, -v94, v94, v95
    v_max_f32 v95, 0, v95
    v_cvt_pk_bf16_f32 v96, v94, v94
    v_lshlrev_b32 v92, 16, v96
    v_cvt_pk_bf16_f32 v96, v95, v95
    v_lshlrev_b32 v97, 16, v96
    v_add_f32 v97, 0x3727c5ac, v97
    v_cvt_pk_bf16_f32 v96, v97, v97
    v_lshlrev_b32 v97, 16, v96
    v_sqrt_f32 v97, v97
    s_nop 0
    v_cvt_pk_bf16_f32 v96, v97, v97
    v_lshlrev_b32 v97, 16, v96
    v_rcp_f32 v93, v97
    s_nop 0
    v_fma_f32 v96, -v97, v93, 2.0
    v_mul_f32 v93, v93, v96
    v_sub_f32 v98, v94, v92
    v_mul_f32 v98, v98, v93
    v_cvt_pk_bf16_f32 v96, v98, v98
    v_lshlrev_b32 v98, 16, v96
    v_mul_f32 v99, v93, v93
    v_mul_f32 v99, v99, v95
    v_cvt_pk_bf16_f32 v96, v99, v99
    v_lshlrev_b32 v99, 16, v96
    v_add_f32 v99, 0x3727c5ac, v99
    v_cvt_pk_bf16_f32 v96, v99, v99
    v_lshlrev_b32 v99, 16, v96
    v_sqrt_f32 v99, v99
    s_nop 0
    v_cvt_pk_bf16_f32 v96, v99, v99
    v_lshlrev_b32 v99, 16, v96
    v_rcp_f32 v97, v99
    s_nop 0
    v_fma_f32 v96, -v99, v97, 2.0
    v_mul_f32 v97, v97, v96
    v_mul_f32 v90, v93, v97
    v_fma_f32 v91, v92, v93, v98
    v_mul_f32 v91, v91, v97
    v_lshlrev_b32 v100, 3, v86
    ds_write_b64 v100, v[90:91] offset:0
    s_cmp_lg_u32 s5, 0
    s_cbranch_scc1 L_w11_kernel_nost_1
    v_add_u32 v101, s6, v86
    v_lshlrev_b32 v101, 3, v101
    buffer_store_dwordx2 v[92:93], v101, s[44:47], 0 offen
L_w11_kernel_nost_1:
    s_nop 1
    ds_write_b64 v89, v[72:73] offset:0
    ds_write_b64 v89, v[74:75] offset:128
    ds_write_b64 v89, v[76:77] offset:256
    ds_write_b64 v89, v[78:79] offset:384
    ds_write_b64 v89, v[80:81] offset:512
    ds_write_b64 v89, v[82:83] offset:640
    ds_write_b64 v89, v[84:85] offset:768
    s_waitcnt lgkmcnt(0)
    s_barrier
    v_mul_u32_u24 v7, 928, v2
    v_lshl_add_u32 v7, v3, 4, v7
    v_add_u32 v7, 256, v7
    s_movk_i32 s42, 896
    v_mul_lo_u32 v8, v2, s42
    v_lshl_add_u32 v8, v3, 3, v8
    v_mov_b32 v12, s28
    v_mov_b32 v13, s28
    v_mov_b32 v14, s28
    v_mov_b32 v15, s28
    v_lshlrev_b32 v9, 3, v2
    s_cmp_eq_u32 s3, 0
    s_cbranch_scc1 L_w11_kernel_var_2
    s_cmp_eq_u32 s3, 1
    s_cbranch_scc1 L_w11_kernel_var_2
    s_cmp_eq_u32 s3, 2
    s_cbranch_scc1 L_w11_kernel_var_2
    s_cmp_eq_u32 s3, 3
    s_cbranch_scc1 L_w11_kernel_var_2
    s_cmp_eq_u32 s3, 4
    s_cbranch_scc1 L_w11_kernel_var_2
    s_cmp_eq_u32 s3, 5
    s_cbranch_scc1 L_w11_kernel_var_2
    s_cmp_eq_u32 s3, 6
    s_cbranch_scc1 L_w11_kernel_var_2
    s_branch L_w11_kernel_end
L_w11_kernel_var_2:
    s_nop 4
    v_mov_b32 v72, 0
    v_mov_b32 v73, 0
    v_mov_b32 v74, 0
    v_mov_b32 v75, 0
    v_mov_b32 v76, 0
    v_mov_b32 v77, 0
    v_mov_b32 v78, 0
    v_mov_b32 v79, 0
    v_mov_b32 v96, 0
    v_mov_b32 v97, 0
    v_mov_b32 v98, 0
    v_mov_b32 v99, 0
    s_mul_i32 s50, s6, 896
    s_mul_i32 s51, s5, 224
    s_add_u32 s50, s50, s51
    s_lshl_b32 s51, s43, 5
    s_add_u32 s50, s50, s51
    ds_read_b128 v[80:83], v7 offset:0
    ds_read_b128 v[84:87], v7 offset:14848
    ds_read_b128 v[88:91], v7 offset:64
    ds_read_b128 v[92:95], v7 offset:14912
    s_waitcnt lgkmcnt(2)
    s_waitcnt vmcnt(14)
    v_mfma_f32_16x16x32_bf16 v[72:75], v[16:19], v[80:83], v[72:75]
    v_mfma_f32_16x16x32_bf16 v[76:79], v[16:19], v[84:87], v[76:79]
    v_mfma_f32_16x16x32_bf16 v[96:99], v[16:19], v[12:15], v[96:99]
    ds_read_b128 v[80:83], v7 offset:128
    ds_read_b128 v[84:87], v7 offset:14976
    s_waitcnt lgkmcnt(2)
    s_waitcnt vmcnt(13)
    v_mfma_f32_16x16x32_bf16 v[72:75], v[20:23], v[88:91], v[72:75]
    v_mfma_f32_16x16x32_bf16 v[76:79], v[20:23], v[92:95], v[76:79]
    v_mfma_f32_16x16x32_bf16 v[96:99], v[20:23], v[12:15], v[96:99]
    ds_read_b128 v[88:91], v7 offset:192
    ds_read_b128 v[92:95], v7 offset:15040
    s_waitcnt lgkmcnt(2)
    s_waitcnt vmcnt(12)
    v_mfma_f32_16x16x32_bf16 v[72:75], v[24:27], v[80:83], v[72:75]
    v_mfma_f32_16x16x32_bf16 v[76:79], v[24:27], v[84:87], v[76:79]
    v_mfma_f32_16x16x32_bf16 v[96:99], v[24:27], v[12:15], v[96:99]
    ds_read_b128 v[80:83], v7 offset:256
    ds_read_b128 v[84:87], v7 offset:15104
    s_waitcnt lgkmcnt(2)
    s_waitcnt vmcnt(11)
    v_mfma_f32_16x16x32_bf16 v[72:75], v[28:31], v[88:91], v[72:75]
    v_mfma_f32_16x16x32_bf16 v[76:79], v[28:31], v[92:95], v[76:79]
    v_mfma_f32_16x16x32_bf16 v[96:99], v[28:31], v[12:15], v[96:99]
    ds_read_b128 v[88:91], v7 offset:320
    ds_read_b128 v[92:95], v7 offset:15168
    s_waitcnt lgkmcnt(2)
    s_waitcnt vmcnt(10)
    v_mfma_f32_16x16x32_bf16 v[72:75], v[32:35], v[80:83], v[72:75]
    v_mfma_f32_16x16x32_bf16 v[76:79], v[32:35], v[84:87], v[76:79]
    v_mfma_f32_16x16x32_bf16 v[96:99], v[32:35], v[12:15], v[96:99]
    ds_read_b128 v[80:83], v7 offset:384
    ds_read_b128 v[84:87], v7 offset:15232
    s_waitcnt lgkmcnt(2)
    s_waitcnt vmcnt(9)
    v_mfma_f32_16x16x32_bf16 v[72:75], v[36:39], v[88:91], v[72:75]
    v_mfma_f32_16x16x32_bf16 v[76:79], v[36:39], v[92:95], v[76:79]
    v_mfma_f32_16x16x32_bf16 v[96:99], v[36:39], v[12:15], v[96:99]
    ds_read_b128 v[88:91], v7 offset:448
    ds_read_b128 v[92:95], v7 offset:15296
    s_waitcnt lgkmcnt(2)
    s_waitcnt vmcnt(8)
    v_mfma_f32_16x16x32_bf16 v[72:75], v[40:43], v[80:83], v[72:75]
    v_mfma_f32_16x16x32_bf16 v[76:79], v[40:43], v[84:87], v[76:79]
    v_mfma_f32_16x16x32_bf16 v[96:99], v[40:43], v[12:15], v[96:99]
    ds_read_b128 v[80:83], v7 offset:512
    ds_read_b128 v[84:87], v7 offset:15360
    s_waitcnt lgkmcnt(2)
    s_waitcnt vmcnt(7)
    v_mfma_f32_16x16x32_bf16 v[72:75], v[44:47], v[88:91], v[72:75]
    v_mfma_f32_16x16x32_bf16 v[76:79], v[44:47], v[92:95], v[76:79]
    v_mfma_f32_16x16x32_bf16 v[96:99], v[44:47], v[12:15], v[96:99]
    ds_read_b128 v[88:91], v7 offset:576
    ds_read_b128 v[92:95], v7 offset:15424
    s_waitcnt lgkmcnt(2)
    s_waitcnt vmcnt(6)
    v_mfma_f32_16x16x32_bf16 v[72:75], v[48:51], v[80:83], v[72:75]
    v_mfma_f32_16x16x32_bf16 v[76:79], v[48:51], v[84:87], v[76:79]
    v_mfma_f32_16x16x32_bf16 v[96:99], v[48:51], v[12:15], v[96:99]
    ds_read_b128 v[80:83], v7 offset:640
    ds_read_b128 v[84:87], v7 offset:15488
    s_waitcnt lgkmcnt(2)
    s_waitcnt vmcnt(5)
    v_mfma_f32_16x16x32_bf16 v[72:75], v[52:55], v[88:91], v[72:75]
    v_mfma_f32_16x16x32_bf16 v[76:79], v[52:55], v[92:95], v[76:79]
    v_mfma_f32_16x16x32_bf16 v[96:99], v[52:55], v[12:15], v[96:99]
    ds_read_b128 v[88:91], v7 offset:704
    ds_read_b128 v[92:95], v7 offset:15552
    s_waitcnt lgkmcnt(2)
    s_waitcnt vmcnt(4)
    v_mfma_f32_16x16x32_bf16 v[72:75], v[56:59], v[80:83], v[72:75]
    v_mfma_f32_16x16x32_bf16 v[76:79], v[56:59], v[84:87], v[76:79]
    v_mfma_f32_16x16x32_bf16 v[96:99], v[56:59], v[12:15], v[96:99]
    ds_read_b128 v[80:83], v7 offset:768
    ds_read_b128 v[84:87], v7 offset:15616
    s_waitcnt lgkmcnt(2)
    s_waitcnt vmcnt(3)
    v_mfma_f32_16x16x32_bf16 v[72:75], v[60:63], v[88:91], v[72:75]
    v_mfma_f32_16x16x32_bf16 v[76:79], v[60:63], v[92:95], v[76:79]
    v_mfma_f32_16x16x32_bf16 v[96:99], v[60:63], v[12:15], v[96:99]
    ds_read_b128 v[88:91], v7 offset:832
    ds_read_b128 v[92:95], v7 offset:15680
    s_waitcnt lgkmcnt(2)
    s_waitcnt vmcnt(2)
    v_mfma_f32_16x16x32_bf16 v[72:75], v[64:67], v[80:83], v[72:75]
    v_mfma_f32_16x16x32_bf16 v[76:79], v[64:67], v[84:87], v[76:79]
    v_mfma_f32_16x16x32_bf16 v[96:99], v[64:67], v[12:15], v[96:99]
    s_waitcnt lgkmcnt(0)
    s_waitcnt vmcnt(1)
    v_mfma_f32_16x16x32_bf16 v[72:75], v[68:71], v[88:91], v[72:75]
    v_mfma_f32_16x16x32_bf16 v[76:79], v[68:71], v[92:95], v[76:79]
    v_mfma_f32_16x16x32_bf16 v[96:99], v[68:71], v[12:15], v[96:99]
    ds_read_b64 v[108:109], v9 offset:0
    ds_read_b64 v[110:111], v9 offset:128
    s_waitcnt lgkmcnt(0)
    s_nop 4
    v_mul_f32 v102, v96, v109
    v_fma_f32 v72, v72, v108, -v102
    v_mul_f32 v102, v97, v109
    v_fma_f32 v73, v73, v108, -v102
    v_mul_f32 v102, v98, v109
    v_fma_f32 v74, v74, v108, -v102
    v_mul_f32 v102, v99, v109
    v_fma_f32 v75, v75, v108, -v102
    v_cvt_pk_bf16_f32 v100, v72, v73
    v_cvt_pk_bf16_f32 v101, v74, v75
    v_lshlrev_b32 v102, 16, v100
    v_and_b32 v103, 0xffff0000, v100
    v_mul_f32 v104, v102, v102
    v_mul_f32 v105, v103, v103
    v_fma_f32 v104, v104, s29, 1.0
    v_fma_f32 v105, v105, s29, 1.0
    v_mul_f32 v104, v104, v102
    v_mul_f32 v105, v105, v103
    v_mul_f32 v104, s30, v104
    v_mul_f32 v105, s30, v105
    v_exp_f32 v104, v104
    v_exp_f32 v105, v105
    v_add_f32 v104, 1.0, v104
    v_add_f32 v105, 1.0, v105
    v_rcp_f32 v104, v104
    v_rcp_f32 v105, v105
    v_mul_f32 v102, v102, v104
    v_mul_f32 v103, v103, v105
    v_cvt_pk_bf16_f32 v100, v102, v103
    v_lshlrev_b32 v102, 16, v101
    v_and_b32 v103, 0xffff0000, v101
    v_mul_f32 v104, v102, v102
    v_mul_f32 v105, v103, v103
    v_fma_f32 v104, v104, s29, 1.0
    v_fma_f32 v105, v105, s29, 1.0
    v_mul_f32 v104, v104, v102
    v_mul_f32 v105, v105, v103
    v_mul_f32 v104, s30, v104
    v_mul_f32 v105, s30, v105
    v_exp_f32 v104, v104
    v_exp_f32 v105, v105
    v_add_f32 v104, 1.0, v104
    v_add_f32 v105, 1.0, v105
    v_rcp_f32 v104, v104
    v_rcp_f32 v105, v105
    v_mul_f32 v102, v102, v104
    v_mul_f32 v103, v103, v105
    v_cvt_pk_bf16_f32 v101, v102, v103
    buffer_store_dwordx2 v[100:101], v8, s[16:19], s50 offen offset:0
    s_add_u32 s52, s50, 14336
    v_mul_f32 v102, v96, v111
    v_fma_f32 v76, v76, v110, -v102
    v_mul_f32 v102, v97, v111
    v_fma_f32 v77, v77, v110, -v102
    v_mul_f32 v102, v98, v111
    v_fma_f32 v78, v78, v110, -v102
    v_mul_f32 v102, v99, v111
    v_fma_f32 v79, v79, v110, -v102
    v_cvt_pk_bf16_f32 v100, v76, v77
    v_cvt_pk_bf16_f32 v101, v78, v79
    v_lshlrev_b32 v102, 16, v100
    v_and_b32 v103, 0xffff0000, v100
    v_mul_f32 v104, v102, v102
    v_mul_f32 v105, v103, v103
    v_fma_f32 v104, v104, s29, 1.0
    v_fma_f32 v105, v105, s29, 1.0
    v_mul_f32 v104, v104, v102
    v_mul_f32 v105, v105, v103
    v_mul_f32 v104, s30, v104
    v_mul_f32 v105, s30, v105
    v_exp_f32 v104, v104
    v_exp_f32 v105, v105
    v_add_f32 v104, 1.0, v104
    v_add_f32 v105, 1.0, v105
    v_rcp_f32 v104, v104
    v_rcp_f32 v105, v105
    v_mul_f32 v102, v102, v104
    v_mul_f32 v103, v103, v105
    v_cvt_pk_bf16_f32 v100, v102, v103
    v_lshlrev_b32 v102, 16, v101
    v_and_b32 v103, 0xffff0000, v101
    v_mul_f32 v104, v102, v102
    v_mul_f32 v105, v103, v103
    v_fma_f32 v104, v104, s29, 1.0
    v_fma_f32 v105, v105, s29, 1.0
    v_mul_f32 v104, v104, v102
    v_mul_f32 v105, v105, v103
    v_mul_f32 v104, s30, v104
    v_mul_f32 v105, s30, v105
    v_exp_f32 v104, v104
    v_exp_f32 v105, v105
    v_add_f32 v104, 1.0, v104
    v_add_f32 v105, 1.0, v105
    v_rcp_f32 v104, v104
    v_rcp_f32 v105, v105
    v_mul_f32 v102, v102, v104
    v_mul_f32 v103, v103, v105
    v_cvt_pk_bf16_f32 v101, v102, v103
    buffer_store_dwordx2 v[100:101], v8, s[16:19], s52 offen offset:0
    s_branch L_w11_kernel_end
L_w11_kernel_end:
    s_nop 1
L_w11_kernel_done:
    s_endpgm
.globl w21_kernel
.p2align 8
.type w21_kernel,@function
w21_kernel:
    s_cmp_ge_u32 s2, 256
    s_cbranch_scc1 L_w21_kernel_done
    s_load_dwordx4 s[32:35], s[0:1], 0
    s_load_dwordx4 s[36:39], s[0:1], 64
    s_load_dwordx2 s[40:41], s[0:1], 80
    v_lshrrev_b32 v4, 6, v0
    v_and_b32 v1, 63, v0
    v_readfirstlane_b32 s3, v4
    s_lshr_b32 s7, s2, 3
    s_mul_hi_u32 s4, s7, 0x40000000
    s_mul_i32 s42, s4, 4
    s_sub_u32 s5, s7, s42
    s_and_b32 s7, s2, 7
    s_mul_i32 s7, s7, 8
    s_add_u32 s4, s4, s7
    s_mul_i32 s6, s4, 32
    v_and_b32 v2, 15, v1
    v_lshrrev_b32 v3, 4, v1
    s_mov_b32 s28, 0x3f803f80
    s_mov_b32 s29, 0x3d372713
    s_mov_b32 s30, 0xc0135761
    s_waitcnt lgkmcnt(0)
    s_mov_b32 s8, s40
    s_mov_b32 s9, s41
    s_and_b32 s9, s9, 0xffff
    s_mov_b32 s10, 0x10000000
    s_mov_b32 s11, 0x00020000
    s_add_u32 s12, s40, 0x2846000
    s_addc_u32 s13, s41, 0
    s_and_b32 s13, s13, 0xffff
    s_mov_b32 s14, 0x1c0000
    s_mov_b32 s15, 0x00020000
    s_add_u32 s16, s40, 0x2a06000
    s_addc_u32 s17, s41, 0
    s_and_b32 s17, s17, 0xffff
    s_mov_b32 s18, 0x1c0000
    s_mov_b32 s19, 0x00020000
    s_add_u32 s20, s40, 0x24c6000
    s_addc_u32 s21, s41, 0
    s_and_b32 s21, s21, 0xffff
    s_mov_b32 s22, 0x1c0000
    s_mov_b32 s23, 0x00020000
    s_add_u32 s44, s40, 0x348a000
    s_addc_u32 s45, s41, 0
    s_and_b32 s45, s45, 0xffff
    s_mov_b32 s46, 0x4000
    s_mov_b32 s47, 0x00020000
    v_lshrrev_b32 v82, 4, v1
    v_and_b32 v83, 15, v1
    s_mul_i32 s42, s3, 4
    v_add_u32 v82, s42, v82
    v_mul_u32_u24 v85, 928, v82
    v_lshl_add_u32 v85, v83, 3, v85
    v_add_u32 v85, 256, v85
    v_add_u32 v84, s6, v82
    s_movk_i32 s42, 896
    v_mul_lo_u32 v84, v84, s42
    v_lshl_add_u32 v84, v83, 3, v84
    v_add_u32 v86, 0xfffffc80, v84
    buffer_load_dwordx2 v[68:69], v86, s[12:15], 0 offen
    v_cmp_gt_u32 vcc, 12, v83
    v_mov_b32 v4, 0x400
    v_mov_b32 v5, 0xfffffd00
    v_cndmask_b32 v86, v4, v5, vcc
    v_add_u32 v86, v86, v84
    buffer_load_dwordx2 v[70:71], v86, s[12:15], 0 offen
    v_add_u32 v86, 0x480, v84
    buffer_load_dwordx2 v[72:73], v86, s[12:15], 0 offen
    v_cmp_gt_u32 vcc, 8, v83
    v_mov_b32 v4, 0xfffffa80
    v_mov_b32 v5, 0x500
    v_cndmask_b32 v86, v4, v5, vcc
    v_add_u32 v86, v86, v84
    buffer_load_dwordx2 v[74:75], v86, s[12:15], 0 offen
    v_add_u32 v86, 0xfffffb00, v84
    buffer_load_dwordx2 v[76:77], v86, s[12:15], 0 offen
    v_cmp_gt_u32 vcc, 4, v83
    v_mov_b32 v4, 0x980
    v_mov_b32 v5, 0xfffffb80
    v_cndmask_b32 v86, v4, v5, vcc
    v_add_u32 v86, v86, v84
    buffer_load_dwordx2 v[78:79], v86, s[12:15], 0 offen
    v_add_u32 v86, 0xa00, v84
    buffer_load_dwordx2 v[80:81], v86, s[12:15], 0 offen
    v_lshlrev_b32 v6, 4, v1
    s_mov_b32 s43, 0
    s_cmp_eq_u32 s3, 1
    s_cselect_b32 s43, 1, s43
    s_cmp_eq_u32 s3, 2
    s_cselect_b32 s43, 2, s43
    s_cmp_eq_u32 s3, 3
    s_cselect_b32 s43, 3, s43
    s_cmp_eq_u32 s3, 4
    s_cselect_b32 s43, 4, s43
    s_cmp_eq_u32 s3, 5
    s_cselect_b32 s43, 5, s43
    s_cmp_eq_u32 s3, 6
    s_cselect_b32 s43, 6, s43
    s_mul_i32 s48, s5, 7
    s_add_u32 s48, s48, s43
    s_mul_i32 s48, s48, 14336
    s_add_u32 s48, s48, 0x214000
    s_barrier
    buffer_load_dwordx4 v[12:15], v6, s[8:11], s48 offen offset:0
    buffer_load_dwordx4 v[16:19], v6, s[8:11], s48 offen offset:1024
    buffer_load_dwordx4 v[20:23], v6, s[8:11], s48 offen offset:2048
    buffer_load_dwordx4 v[24:27], v6, s[8:11], s48 offen offset:3072
    s_add_u32 s49, s48, 0x1000
    buffer_load_dwordx4 v[28:31], v6, s[8:11], s49 offen offset:0
    s_add_u32 s49, s48, 0x1000
    buffer_load_dwordx4 v[32:35], v6, s[8:11], s49 offen offset:1024
    s_add_u32 s49, s48, 0x1000
    buffer_load_dwordx4 v[36:39], v6, s[8:11], s49 offen offset:2048
    s_add_u32 s49, s48, 0x1000
    buffer_load_dwordx4 v[40:43], v6, s[8:11], s49 offen offset:3072
    s_add_u32 s49, s48, 0x2000
    buffer_load_dwordx4 v[44:47], v6, s[8:11], s49 offen offset:0
    s_add_u32 s49, s48, 0x2000
    buffer_load_dwordx4 v[48:51], v6, s[8:11], s49 offen offset:1024
    s_add_u32 s49, s48, 0x2000
    buffer_load_dwordx4 v[52:55], v6, s[8:11], s49 offen offset:2048
    s_add_u32 s49, s48, 0x2000
    buffer_load_dwordx4 v[56:59], v6, s[8:11], s49 offen offset:3072
    s_add_u32 s49, s48, 0x3000
    buffer_load_dwordx4 v[60:63], v6, s[8:11], s49 offen offset:0
    s_add_u32 s49, s48, 0x3000
    buffer_load_dwordx4 v[64:67], v6, s[8:11], s49 offen offset:1024
    s_waitcnt vmcnt(14)
    ds_write_b64 v85, v[68:69] offset:0
    ds_write_b64 v85, v[70:71] offset:128
    ds_write_b64 v85, v[72:73] offset:256
    ds_write_b64 v85, v[74:75] offset:384
    ds_write_b64 v85, v[76:77] offset:512
    ds_write_b64 v85, v[78:79] offset:640
    ds_write_b64 v85, v[80:81] offset:768
    s_waitcnt lgkmcnt(0)
    s_barrier
    v_mul_u32_u24 v7, 928, v2
    v_lshl_add_u32 v7, v3, 4, v7
    v_add_u32 v7, 256, v7
    s_movk_i32 s42, 896
    v_mul_lo_u32 v8, v2, s42
    v_lshl_add_u32 v8, v3, 3, v8
    v_lshlrev_b32 v9, 3, v2
    s_cmp_eq_u32 s3, 0
    s_cbranch_scc1 L_w21_kernel_var_1
    s_cmp_eq_u32 s3, 1
    s_cbranch_scc1 L_w21_kernel_var_1
    s_cmp_eq_u32 s3, 2
    s_cbranch_scc1 L_w21_kernel_var_1
    s_cmp_eq_u32 s3, 3
    s_cbranch_scc1 L_w21_kernel_var_1
    s_cmp_eq_u32 s3, 4
    s_cbranch_scc1 L_w21_kernel_var_1
    s_cmp_eq_u32 s3, 5
    s_cbranch_scc1 L_w21_kernel_var_1
    s_cmp_eq_u32 s3, 6
    s_cbranch_scc1 L_w21_kernel_var_1
    s_branch L_w21_kernel_end
L_w21_kernel_var_1:
    s_nop 4
    v_mov_b32 v68, 0
    v_mov_b32 v69, 0
    v_mov_b32 v70, 0
    v_mov_b32 v71, 0
    v_mov_b32 v72, 0
    v_mov_b32 v73, 0
    v_mov_b32 v74, 0
    v_mov_b32 v75, 0
    s_mul_i32 s50, s6, 896
    s_mul_i32 s51, s5, 224
    s_add_u32 s50, s50, s51
    s_lshl_b32 s51, s43, 5
    s_add_u32 s50, s50, s51
    buffer_load_dwordx2 v[92:93], v8, s[20:23], s50 offen offset:0
    s_add_u32 s52, s50, 14336
    buffer_load_dwordx2 v[94:95], v8, s[20:23], s52 offen offset:0
    v_add_u32 v100, s6, v2
    v_lshlrev_b32 v100, 3, v100
    buffer_load_dwordx2 v[96:97], v100, s[44:47], 0 offen offset:0
    buffer_load_dwordx2 v[98:99], v100, s[44:47], 0 offen offset:128
    ds_read_b128 v[76:79], v7 offset:0
    ds_read_b128 v[80:83], v7 offset:14848
    ds_read_b128 v[84:87], v7 offset:64
    ds_read_b128 v[88:91], v7 offset:14912
    s_waitcnt lgkmcnt(2)
    s_waitcnt vmcnt(17)
    v_mfma_f32_16x16x32_bf16 v[68:71], v[12:15], v[76:79], v[68:71]
    v_mfma_f32_16x16x32_bf16 v[72:75], v[12:15], v[80:83], v[72:75]
    ds_read_b128 v[76:79], v7 offset:128
    ds_read_b128 v[80:83], v7 offset:14976
    s_waitcnt lgkmcnt(2)
    s_waitcnt vmcnt(16)
    v_mfma_f32_16x16x32_bf16 v[68:71], v[16:19], v[84:87], v[68:71]
    v_mfma_f32_16x16x32_bf16 v[72:75], v[16:19], v[88:91], v[72:75]
    ds_read_b128 v[84:87], v7 offset:192
    ds_read_b128 v[88:91], v7 offset:15040
    s_waitcnt lgkmcnt(2)
    s_waitcnt vmcnt(15)
    v_mfma_f32_16x16x32_bf16 v[68:71], v[20:23], v[76:79], v[68:71]
    v_mfma_f32_16x16x32_bf16 v[72:75], v[20:23], v[80:83], v[72:75]
    ds_read_b128 v[76:79], v7 offset:256
    ds_read_b128 v[80:83], v7 offset:15104
    s_waitcnt lgkmcnt(2)
    s_waitcnt vmcnt(14)
    v_mfma_f32_16x16x32_bf16 v[68:71], v[24:27], v[84:87], v[68:71]
    v_mfma_f32_16x16x32_bf16 v[72:75], v[24:27], v[88:91], v[72:75]
    ds_read_b128 v[84:87], v7 offset:320
    ds_read_b128 v[88:91], v7 offset:15168
    s_waitcnt lgkmcnt(2)
    s_waitcnt vmcnt(13)
    v_mfma_f32_16x16x32_bf16 v[68:71], v[28:31], v[76:79], v[68:71]
    v_mfma_f32_16x16x32_bf16 v[72:75], v[28:31], v[80:83], v[72:75]
    ds_read_b128 v[76:79], v7 offset:384
    ds_read_b128 v[80:83], v7 offset:15232
    s_waitcnt lgkmcnt(2)
    s_waitcnt vmcnt(12)
    v_mfma_f32_16x16x32_bf16 v[68:71], v[32:35], v[84:87], v[68:71]
    v_mfma_f32_16x16x32_bf16 v[72:75], v[32:35], v[88:91], v[72:75]
    ds_read_b128 v[84:87], v7 offset:448
    ds_read_b128 v[88:91], v7 offset:15296
    s_waitcnt lgkmcnt(2)
    s_waitcnt vmcnt(11)
    v_mfma_f32_16x16x32_bf16 v[68:71], v[36:39], v[76:79], v[68:71]
    v_mfma_f32_16x16x32_bf16 v[72:75], v[36:39], v[80:83], v[72:75]
    ds_read_b128 v[76:79], v7 offset:512
    ds_read_b128 v[80:83], v7 offset:15360
    s_waitcnt lgkmcnt(2)
    s_waitcnt vmcnt(10)
    v_mfma_f32_16x16x32_bf16 v[68:71], v[40:43], v[84:87], v[68:71]
    v_mfma_f32_16x16x32_bf16 v[72:75], v[40:43], v[88:91], v[72:75]
    ds_read_b128 v[84:87], v7 offset:576
    ds_read_b128 v[88:91], v7 offset:15424
    s_waitcnt lgkmcnt(2)
    s_waitcnt vmcnt(9)
    v_mfma_f32_16x16x32_bf16 v[68:71], v[44:47], v[76:79], v[68:71]
    v_mfma_f32_16x16x32_bf16 v[72:75], v[44:47], v[80:83], v[72:75]
    ds_read_b128 v[76:79], v7 offset:640
    ds_read_b128 v[80:83], v7 offset:15488
    s_waitcnt lgkmcnt(2)
    s_waitcnt vmcnt(8)
    v_mfma_f32_16x16x32_bf16 v[68:71], v[48:51], v[84:87], v[68:71]
    v_mfma_f32_16x16x32_bf16 v[72:75], v[48:51], v[88:91], v[72:75]
    ds_read_b128 v[84:87], v7 offset:704
    ds_read_b128 v[88:91], v7 offset:15552
    s_waitcnt lgkmcnt(2)
    s_waitcnt vmcnt(7)
    v_mfma_f32_16x16x32_bf16 v[68:71], v[52:55], v[76:79], v[68:71]
    v_mfma_f32_16x16x32_bf16 v[72:75], v[52:55], v[80:83], v[72:75]
    ds_read_b128 v[76:79], v7 offset:768
    ds_read_b128 v[80:83], v7 offset:15616
    s_waitcnt lgkmcnt(2)
    s_waitcnt vmcnt(6)
    v_mfma_f32_16x16x32_bf16 v[68:71], v[56:59], v[84:87], v[68:71]
    v_mfma_f32_16x16x32_bf16 v[72:75], v[56:59], v[88:91], v[72:75]
    ds_read_b128 v[84:87], v7 offset:832
    ds_read_b128 v[88:91], v7 offset:15680
    s_waitcnt lgkmcnt(2)
    s_waitcnt vmcnt(5)
    v_mfma_f32_16x16x32_bf16 v[68:71], v[60:63], v[76:79], v[68:71]
    v_mfma_f32_16x16x32_bf16 v[72:75], v[60:63], v[80:83], v[72:75]
    s_waitcnt lgkmcnt(0)
    s_waitcnt vmcnt(4)
    v_mfma_f32_16x16x32_bf16 v[68:71], v[64:67], v[84:87], v[68:71]
    v_mfma_f32_16x16x32_bf16 v[72:75], v[64:67], v[88:91], v[72:75]
    s_waitcnt vmcnt(0)
    s_nop 5
    v_cvt_pk_bf16_f32 v102, v68, v69
    v_cvt_pk_bf16_f32 v103, v70, v71
    v_lshlrev_b32 v106, 16, v92
    v_and_b32 v107, 0xffff0000, v92
    v_sub_f32 v106, v106, v96
    v_sub_f32 v107, v107, v96
    v_cvt_pk_bf16_f32 v104, v106, v107
    v_lshlrev_b32 v106, 16, v104
    v_and_b32 v107, 0xffff0000, v104
    v_mul_f32 v106, v106, v97
    v_mul_f32 v107, v107, v97
    v_cvt_pk_bf16_f32 v104, v106, v107
    v_lshlrev_b32 v106, 16, v104
    v_and_b32 v107, 0xffff0000, v104
    v_lshlrev_b32 v104, 16, v102
    v_and_b32 v105, 0xffff0000, v102
    v_add_f32 v104, v104, v106
    v_add_f32 v105, v105, v107
    v_cvt_pk_bf16_f32 v102, v104, v105
    v_lshlrev_b32 v106, 16, v93
    v_and_b32 v107, 0xffff0000, v93
    v_sub_f32 v106, v106, v96
    v_sub_f32 v107, v107, v96
    v_cvt_pk_bf16_f32 v104, v106, v107
    v_lshlrev_b32 v106, 16, v104
    v_and_b32 v107, 0xffff0000, v104
    v_mul_f32 v106, v106, v97
    v_mul_f32 v107, v107, v97
    v_cvt_pk_bf16_f32 v104, v106, v107
    v_lshlrev_b32 v106, 16, v104
    v_and_b32 v107, 0xffff0000, v104
    v_lshlrev_b32 v104, 16, v103
    v_and_b32 v105, 0xffff0000, v103
    v_add_f32 v104, v104, v106
    v_add_f32 v105, v105, v107
    v_cvt_pk_bf16_f32 v103, v104, v105
    buffer_store_dwordx2 v[102:103], v8, s[16:19], s50 offen offset:0
    s_add_u32 s52, s50, 14336
    v_cvt_pk_bf16_f32 v102, v72, v73
    v_cvt_pk_bf16_f32 v103, v74, v75
    v_lshlrev_b32 v106, 16, v94
    v_and_b32 v107, 0xffff0000, v94
    v_sub_f32 v106, v106, v98
    v_sub_f32 v107, v107, v98
    v_cvt_pk_bf16_f32 v104, v106, v107
    v_lshlrev_b32 v106, 16, v104
    v_and_b32 v107, 0xffff0000, v104
    v_mul_f32 v106, v106, v99
    v_mul_f32 v107, v107, v99
    v_cvt_pk_bf16_f32 v104, v106, v107
    v_lshlrev_b32 v106, 16, v104
    v_and_b32 v107, 0xffff0000, v104
    v_lshlrev_b32 v104, 16, v102
    v_and_b32 v105, 0xffff0000, v102
    v_add_f32 v104, v104, v106
    v_add_f32 v105, v105, v107
    v_cvt_pk_bf16_f32 v102, v104, v105
    v_lshlrev_b32 v106, 16, v95
    v_and_b32 v107, 0xffff0000, v95
    v_sub_f32 v106, v106, v98
    v_sub_f32 v107, v107, v98
    v_cvt_pk_bf16_f32 v104, v106, v107
    v_lshlrev_b32 v106, 16, v104
    v_and_b32 v107, 0xffff0000, v104
    v_mul_f32 v106, v106, v99
    v_mul_f32 v107, v107, v99
    v_cvt_pk_bf16_f32 v104, v106, v107
    v_lshlrev_b32 v106, 16, v104
    v_and_b32 v107, 0xffff0000, v104
    v_lshlrev_b32 v104, 16, v103
    v_and_b32 v105, 0xffff0000, v103
    v_add_f32 v104, v104, v106
    v_add_f32 v105, v105, v107
    v_cvt_pk_bf16_f32 v103, v104, v105
    buffer_store_dwordx2 v[102:103], v8, s[16:19], s52 offen offset:0
    s_branch L_w21_kernel_end
L_w21_kernel_end:
    s_nop 1
L_w21_kernel_done:
    s_endpgm
.globl w31_kernel
.p2align 8
.type w31_kernel,@function
w31_kernel:
    s_cmp_ge_u32 s2, 224
    s_cbranch_scc1 L_w31_kernel_done
    s_load_dwordx4 s[32:35], s[0:1], 0
    s_load_dwordx4 s[36:39], s[0:1], 64
    s_load_dwordx2 s[40:41], s[0:1], 80
    v_lshrrev_b32 v4, 6, v0
    v_and_b32 v1, 63, v0
    v_readfirstlane_b32 s3, v4
    s_lshr_b32 s7, s2, 3
    s_mul_hi_u32 s4, s7, 0x24924925
    s_mul_i32 s42, s4, 7
    s_sub_u32 s5, s7, s42
    s_and_b32 s7, s2, 7
    s_mul_i32 s7, s7, 4
    s_add_u32 s4, s4, s7
    s_mul_i32 s6, s4, 64
    v_and_b32 v2, 15, v1
    v_lshrrev_b32 v3, 4, v1
    s_mov_b32 s28, 0x3f803f80
    s_mov_b32 s29, 0x3d372713
    s_mov_b32 s30, 0xc0135761
    s_waitcnt lgkmcnt(0)
    s_mov_b32 s8, s40
    s_mov_b32 s9, s41
    s_and_b32 s9, s9, 0xffff
    s_mov_b32 s10, 0x10000000
    s_mov_b32 s11, 0x00020000
    s_add_u32 s12, s40, 0x2a06000
    s_addc_u32 s13, s41, 0
    s_and_b32 s13, s13, 0xffff
    s_mov_b32 s14, 0x1c0000
    s_mov_b32 s15, 0x00020000
    s_add_u32 s16, s40, 0x2d86000
    s_addc_u32 s17, s41, 0
    s_and_b32 s17, s17, 0xffff
    s_mov_b32 s18, 0x700000
    s_mov_b32 s19, 0x00020000
    v_lshrrev_b32 v156, 3, v1
    v_and_b32 v157, 7, v1
    s_mul_i32 s42, s3, 8
    v_add_u32 v156, s42, v156
    v_mul_u32_u24 v159, 928, v156
    v_lshl_add_u32 v159, v157, 4, v159
    v_add_u32 v159, 512, v159
    v_add_u32 v158, s6, v156
    s_movk_i32 s42, 896
    v_mul_lo_u32 v158, v158, s42
    v_lshl_add_u32 v158, v157, 4, v158
    buffer_load_dwordx4 v[128:131], v158, s[12:15], 0 offen offset:0
    buffer_load_dwordx4 v[132:135], v158, s[12:15], 0 offen offset:128
    buffer_load_dwordx4 v[136:139], v158, s[12:15], 0 offen offset:256
    buffer_load_dwordx4 v[140:143], v158, s[12:15], 0 offen offset:384
    buffer_load_dwordx4 v[144:147], v158, s[12:15], 0 offen offset:512
    buffer_load_dwordx4 v[148:151], v158, s[12:15], 0 offen offset:640
    buffer_load_dwordx4 v[152:155], v158, s[12:15], 0 offen offset:768
    v_lshlrev_b32 v6, 4, v1
    s_mov_b32 s43, 0
    s_cmp_eq_u32 s3, 1
    s_cselect_b32 s43, 2, s43
    s_cmp_eq_u32 s3, 2
    s_cselect_b32 s43, 4, s43
    s_cmp_eq_u32 s3, 3
    s_cselect_b32 s43, 6, s43
    s_cmp_eq_u32 s3, 4
    s_cselect_b32 s43, 8, s43
    s_cmp_eq_u32 s3, 5
    s_cselect_b32 s43, 10, s43
    s_cmp_eq_u32 s3, 6
    s_cselect_b32 s43, 12, s43
    s_cmp_eq_u32 s3, 7
    s_cselect_b32 s43, 14, s43
    s_mul_i32 s48, s5, 16
    s_add_u32 s48, s48, s43
    s_mul_i32 s48, s48, 14336
    s_add_u32 s48, s48, 0x276000
    s_barrier
    buffer_load_dwordx4 v[16:19], v6, s[8:11], s48 offen offset:0
    s_add_u32 s49, s48, 0x3000
    buffer_load_dwordx4 v[72:75], v6, s[8:11], s49 offen offset:2048
    buffer_load_dwordx4 v[20:23], v6, s[8:11], s48 offen offset:1024
    s_add_u32 s49, s48, 0x3000
    buffer_load_dwordx4 v[76:79], v6, s[8:11], s49 offen offset:3072
    buffer_load_dwordx4 v[24:27], v6, s[8:11], s48 offen offset:2048
    s_add_u32 s49, s48, 0x4000
    buffer_load_dwordx4 v[80:83], v6, s[8:11], s49 offen offset:0
    buffer_load_dwordx4 v[28:31], v6, s[8:11], s48 offen offset:3072
    s_add_u32 s49, s48, 0x4000
    buffer_load_dwordx4 v[84:87], v6, s[8:11], s49 offen offset:1024
    s_add_u32 s49, s48, 0x1000
    buffer_load_dwordx4 v[32:35], v6, s[8:11], s49 offen offset:0
    s_add_u32 s49, s48, 0x4000
    buffer_load_dwordx4 v[88:91], v6, s[8:11], s49 offen offset:2048
    s_add_u32 s49, s48, 0x1000
    buffer_load_dwordx4 v[36:39], v6, s[8:11], s49 offen offset:1024
    s_add_u32 s49, s48, 0x4000
    buffer_load_dwordx4 v[92:95], v6, s[8:11], s49 offen offset:3072
    s_add_u32 s49, s48, 0x1000
    buffer_load_dwordx4 v[40:43], v6, s[8:11], s49 offen offset:2048
    s_add_u32 s49, s48, 0x5000
    buffer_load_dwordx4 v[96:99], v6, s[8:11], s49 offen offset:0
    s_add_u32 s49, s48, 0x1000
    buffer_load_dwordx4 v[44:47], v6, s[8:11], s49 offen offset:3072
    s_add_u32 s49, s48, 0x5000
    buffer_load_dwordx4 v[100:103], v6, s[8:11], s49 offen offset:1024
    s_add_u32 s49, s48, 0x2000
    buffer_load_dwordx4 v[48:51], v6, s[8:11], s49 offen offset:0
    s_add_u32 s49, s48, 0x5000
    buffer_load_dwordx4 v[104:107], v6, s[8:11], s49 offen offset:2048
    s_add_u32 s49, s48, 0x2000
    buffer_load_dwordx4 v[52:55], v6, s[8:11], s49 offen offset:1024
    s_add_u32 s49, s48, 0x5000
    buffer_load_dwordx4 v[108:111], v6, s[8:11], s49 offen offset:3072
    s_add_u32 s49, s48, 0x2000
    buffer_load_dwordx4 v[56:59], v6, s[8:11], s49 offen offset:2048
    s_add_u32 s49, s48, 0x6000
    buffer_load_dwordx4 v[112:115], v6, s[8:11], s49 offen offset:0
    s_add_u32 s49, s48, 0x2000
    buffer_load_dwordx4 v[60:63], v6, s[8:11], s49 offen offset:3072
    s_add_u32 s49, s48, 0x6000
    buffer_load_dwordx4 v[116:119], v6, s[8:11], s49 offen offset:1024
    s_add_u32 s49, s48, 0x3000
    buffer_load_dwordx4 v[64:67], v6, s[8:11], s49 offen offset:0
    s_add_u32 s49, s48, 0x6000
    buffer_load_dwordx4 v[120:123], v6, s[8:11], s49 offen offset:2048
    s_add_u32 s49, s48, 0x3000
    buffer_load_dwordx4 v[68:71], v6, s[8:11], s49 offen offset:1024
    s_add_u32 s49, s48, 0x6000
    buffer_load_dwordx4 v[124:127], v6, s[8:11], s49 offen offset:3072
    s_waitcnt vmcnt(28)
    v_mov_b32 v164, 0
    v_mov_b32 v165, 0
    v_mov_b32 v168, 0
    v_mov_b32 v169, 0
    v_dot2_f32_bf16 v164, v128, s28, v164
    v_dot2_f32_bf16 v165, v128, v128, v165
    v_dot2_f32_bf16 v168, v129, s28, v168
    v_dot2_f32_bf16 v169, v129, v129, v169
    v_dot2_f32_bf16 v164, v130, s28, v164
    v_dot2_f32_bf16 v165, v130, v130, v165
    v_dot2_f32_bf16 v168, v131, s28, v168
    v_dot2_f32_bf16 v169, v131, v131, v169
    v_dot2_f32_bf16 v164, v132, s28, v164
    v_dot2_f32_bf16 v165, v132, v132, v165
    v_dot2_f32_bf16 v168, v133, s28, v168
    v_dot2_f32_bf16 v169, v133, v133, v169
    v_dot2_f32_bf16 v164, v134, s28, v164
    v_dot2_f32_bf16 v165, v134, v134, v165
    v_dot2_f32_bf16 v168, v135, s28, v168
    v_dot2_f32_bf16 v169, v135, v135, v169
    v_dot2_f32_bf16 v164, v136, s28, v164
    v_dot2_f32_bf16 v165, v136, v136, v165
    v_dot2_f32_bf16 v168, v137, s28, v168
    v_dot2_f32_bf16 v169, v137, v137, v169
    v_dot2_f32_bf16 v164, v138, s28, v164
    v_dot2_f32_bf16 v165, v138, v138, v165
    v_dot2_f32_bf16 v168, v139, s28, v168
    v_dot2_f32_bf16 v169, v139, v139, v169
    v_dot2_f32_bf16 v164, v140, s28, v164
    v_dot2_f32_bf16 v165, v140, v140, v165
    v_dot2_f32_bf16 v168, v141, s28, v168
    v_dot2_f32_bf16 v169, v141, v141, v169
    v_dot2_f32_bf16 v164, v142, s28, v164
    v_dot2_f32_bf16 v165, v142, v142, v165
    v_dot2_f32_bf16 v168, v143, s28, v168
    v_dot2_f32_bf16 v169, v143, v143, v169
    v_dot2_f32_bf16 v164, v144, s28, v164
    v_dot2_f32_bf16 v165, v144, v144, v165
    v_dot2_f32_bf16 v168, v145, s28, v168
    v_dot2_f32_bf16 v169, v145, v145, v169
    v_dot2_f32_bf16 v164, v146, s28, v164
    v_dot2_f32_bf16 v165, v146, v146, v165
    v_dot2_f32_bf16 v168, v147, s28, v168
    v_dot2_f32_bf16 v169, v147, v147, v169
    v_dot2_f32_bf16 v164, v148, s28, v164
    v_dot2_f32_bf16 v165, v148, v148, v165
    v_dot2_f32_bf16 v168, v149, s28, v168
    v_dot2_f32_bf16 v169, v149, v149, v169
    v_dot2_f32_bf16 v164, v150, s28, v164
    v_dot2_f32_bf16 v165, v150, v150, v165
    v_dot2_f32_bf16 v168, v151, s28, v168
    v_dot2_f32_bf16 v169, v151, v151, v169
    v_dot2_f32_bf16 v164, v152, s28, v164
    v_dot2_f32_bf16 v165, v152, v152, v165
    v_dot2_f32_bf16 v168, v153, s28, v168
    v_dot2_f32_bf16 v169, v153, v153, v169
    v_dot2_f32_bf16 v164, v154, s28, v164
    v_dot2_f32_bf16 v165, v154, v154, v165
    v_dot2_f32_bf16 v168, v155, s28, v168
    v_dot2_f32_bf16 v169, v155, v155, v169
    s_nop 1
    v_add_f32 v164, v164, v168
    v_add_f32 v165, v165, v169
    s_nop 0
    v_add_f32_dpp v166, v164, v164 quad_perm:[1,0,3,2] row_mask:0xf bank_mask:0xf
    s_nop 1
    v_add_f32_dpp v164, v166, v166 quad_perm:[2,3,0,1] row_mask:0xf bank_mask:0xf
    s_nop 1
    v_add_f32_dpp v166, v164, v164 row_half_mirror row_mask:0xf bank_mask:0xf
    v_mov_b32 v164, v166
    v_add_f32_dpp v166, v165, v165 quad_perm:[1,0,3,2] row_mask:0xf bank_mask:0xf
    s_nop 1
    v_add_f32_dpp v165, v166, v166 quad_perm:[2,3,0,1] row_mask:0xf bank_mask:0xf
    s_nop 1
    v_add_f32_dpp v166, v165, v165 row_half_mirror row_mask:0xf bank_mask:0xf
    v_mov_b32 v165, v166
    v_mul_f32 v164, 0x3b124925, v164
    v_mul_f32 v165, 0x3b124925, v165
    v_fma_f32 v165, -v164, v164, v165
    v_max_f32 v165, 0, v165
    v_cvt_pk_bf16_f32 v166, v164, v164
    v_lshlrev_b32 v162, 16, v166
    v_cvt_pk_bf16_f32 v166, v165, v165
    v_lshlrev_b32 v167, 16, v166
    v_add_f32 v167, 0x3727c5ac, v167
    v_cvt_pk_bf16_f32 v166, v167, v167
    v_lshlrev_b32 v167, 16, v166
    v_sqrt_f32 v167, v167
    s_nop 0
    v_cvt_pk_bf16_f32 v166, v167, v167
    v_lshlrev_b32 v167, 16, v166
    v_rcp_f32 v163, v167
    s_nop 0
    v_fma_f32 v166, -v167, v163, 2.0
    v_mul_f32 v163, v163, v166
    v_mov_b32 v160, v163
    v_mul_f32 v161, v162, v163
    v_lshlrev_b32 v170, 3, v156
    ds_write_b64 v170, v[160:161] offset:0
    ds_write_b128 v159, v[128:131] offset:0
    ds_write_b128 v159, v[132:135] offset:128
    ds_write_b128 v159, v[136:139] offset:256
    ds_write_b128 v159, v[140:143] offset:384
    ds_write_b128 v159, v[144:147] offset:512
    ds_write_b128 v159, v[148:151] offset:640
    ds_write_b128 v159, v[152:155] offset:768
    s_waitcnt lgkmcnt(0)
    s_barrier
    v_mul_u32_u24 v7, 928, v2
    v_lshl_add_u32 v7, v3, 4, v7
    v_add_u32 v7, 512, v7
    s_movk_i32 s42, 3584
    v_mul_lo_u32 v8, v2, s42
    v_lshl_add_u32 v8, v3, 3, v8
    v_mov_b32 v12, s28
    v_mov_b32 v13, s28
    v_mov_b32 v14, s28
    v_mov_b32 v15, s28
    v_lshlrev_b32 v9, 3, v2
    s_cmp_eq_u32 s3, 0
    s_cbranch_scc1 L_w31_kernel_var_1
    s_cmp_eq_u32 s3, 1
    s_cbranch_scc1 L_w31_kernel_var_1
    s_cmp_eq_u32 s3, 2
    s_cbranch_scc1 L_w31_kernel_var_1
    s_cmp_eq_u32 s3, 3
    s_cbranch_scc1 L_w31_kernel_var_1
    s_cmp_eq_u32 s3, 4
    s_cbranch_scc1 L_w31_kernel_var_1
    s_cmp_eq_u32 s3, 5
    s_cbranch_scc1 L_w31_kernel_var_1
    s_cmp_eq_u32 s3, 6
    s_cbranch_scc1 L_w31_kernel_var_1
    s_cmp_eq_u32 s3, 7
    s_cbranch_scc1 L_w31_kernel_var_1
    s_branch L_w31_kernel_end
L_w31_kernel_var_1:
    s_nop 4
    v_mov_b32 v128, 0
    v_mov_b32 v129, 0
    v_mov_b32 v130, 0
    v_mov_b32 v131, 0
    v_mov_b32 v132, 0
    v_mov_b32 v133, 0
    v_mov_b32 v134, 0
    v_mov_b32 v135, 0
    v_mov_b32 v136, 0
    v_mov_b32 v137, 0
    v_mov_b32 v138, 0
    v_mov_b32 v139, 0
    v_mov_b32 v140, 0
    v_mov_b32 v141, 0
    v_mov_b32 v142, 0
    v_mov_b32 v143, 0
    v_mov_b32 v144, 0
    v_mov_b32 v145, 0
    v_mov_b32 v146, 0
    v_mov_b32 v147, 0
    v_mov_b32 v148, 0
    v_mov_b32 v149, 0
    v_mov_b32 v150, 0
    v_mov_b32 v151, 0
    v_mov_b32 v152, 0
    v_mov_b32 v153, 0
    v_mov_b32 v154, 0
    v_mov_b32 v155, 0
    v_mov_b32 v156, 0
    v_mov_b32 v157, 0
    v_mov_b32 v158, 0
    v_mov_b32 v159, 0
    v_mov_b32 v192, 0
    v_mov_b32 v193, 0
    v_mov_b32 v194, 0
    v_mov_b32 v195, 0
    v_mov_b32 v196, 0
    v_mov_b32 v197, 0
    v_mov_b32 v198, 0
    v_mov_b32 v199, 0
    s_mul_i32 s50, s6, 3584
    s_mul_i32 s51, s5, 512
    s_add_u32 s50, s50, s51
    s_lshl_b32 s51, s43, 5
    s_add_u32 s50, s50, s51
    ds_read_b128 v[160:163], v7 offset:0
    ds_read_b128 v[164:167], v7 offset:14848
    ds_read_b128 v[168:171], v7 offset:29696
    ds_read_b128 v[172:175], v7 offset:44544
    ds_read_b128 v[176:179], v7 offset:64
    ds_read_b128 v[180:183], v7 offset:14912
    ds_read_b128 v[184:187], v7 offset:29760
    ds_read_b128 v[188:191], v7 offset:44608
    s_waitcnt lgkmcnt(4)
    s_waitcnt vmcnt(27)
    s_waitcnt vmcnt(26)
    v_mfma_f32_16x16x32_bf16 v[128:131], v[16:19], v[160:163], v[128:131]
    v_mfma_f32_16x16x32_bf16 v[136:139], v[16:19], v[164:167], v[136:139]
    v_mfma_f32_16x16x32_bf16 v[144:147], v[16:19], v[168:171], v[144:147]
    v_mfma_f32_16x16x32_bf16 v[152:155], v[16:19], v[172:175], v[152:155]
    v_mfma_f32_16x16x32_bf16 v[192:195], v[16:19], v[12:15], v[192:195]
    v_mfma_f32_16x16x32_bf16 v[132:135], v[72:75], v[160:163], v[132:135]
    v_mfma_f32_16x16x32_bf16 v[140:143], v[72:75], v[164:167], v[140:143]
    v_mfma_f32_16x16x32_bf16 v[148:151], v[72:75], v[168:171], v[148:151]
    v_mfma_f32_16x16x32_bf16 v[156:159], v[72:75], v[172:175], v[156:159]
    v_mfma_f32_16x16x32_bf16 v[196:199], v[72:75], v[12:15], v[196:199]
    ds_read_b128 v[160:163], v7 offset:128
    ds_read_b128 v[164:167], v7 offset:14976
    ds_read_b128 v[168:171], v7 offset:29824
    ds_read_b128 v[172:175], v7 offset:44672
    s_waitcnt lgkmcnt(4)
    s_waitcnt vmcnt(25)
    s_waitcnt vmcnt(24)
    v_mfma_f32_16x16x32_bf16 v[128:131], v[20:23], v[176:179], v[128:131]
    v_mfma_f32_16x16x32_bf16 v[136:139], v[20:23], v[180:183], v[136:139]
    v_mfma_f32_16x16x32_bf16 v[144:147], v[20:23], v[184:187], v[144:147]
    v_mfma_f32_16x16x32_bf16 v[152:155], v[20:23], v[188:191], v[152:155]
    v_mfma_f32_16x16x32_bf16 v[192:195], v[20:23], v[12:15], v[192:195]
    v_mfma_f32_16x16x32_bf16 v[132:135], v[76:79], v[176:179], v[132:135]
    v_mfma_f32_16x16x32_bf16 v[140:143], v[76:79], v[180:183], v[140:143]
    v_mfma_f32_16x16x32_bf16 v[148:151], v[76:79], v[184:187], v[148:151]
    v_mfma_f32_16x16x32_bf16 v[156:159], v[76:79], v[188:191], v[156:159]
    v_mfma_f32_16x16x32_bf16 v[196:199], v[76:79], v[12:15], v[196:199]
    ds_read_b128 v[176:179], v7 offset:192
    ds_read_b128 v[180:183], v7 offset:15040
    ds_read_b128 v[184:187], v7 offset:29888
    ds_read_b128 v[188:191], v7 offset:44736
    s_waitcnt lgkmcnt(4)
    s_waitcnt vmcnt(23)
    s_waitcnt vmcnt(22)
    v_mfma_f32_16x16x32_bf16 v[128:131], v[24:27], v[160:163], v[128:131]
    v_mfma_f32_16x16x32_bf16 v[136:139], v[24:27], v[164:167], v[136:139]
    v_mfma_f32_16x16x32_bf16 v[144:147], v[24:27], v[168:171], v[144:147]
    v_mfma_f32_16x16x32_bf16 v[152:155], v[24:27], v[172:175], v[152:155]
    v_mfma_f32_16x16x32_bf16 v[192:195], v[24:27], v[12:15], v[192:195]
    v_mfma_f32_16x16x32_bf16 v[132:135], v[80:83], v[160:163], v[132:135]
    v_mfma_f32_16x16x32_bf16 v[140:143], v[80:83], v[164:167], v[140:143]
    v_mfma_f32_16x16x32_bf16 v[148:151], v[80:83], v[168:171], v[148:151]
    v_mfma_f32_16x16x32_bf16 v[156:159], v[80:83], v[172:175], v[156:159]
    v_mfma_f32_16x16x32_bf16 v[196:199], v[80:83], v[12:15], v[196:199]
    ds_read_b128 v[160:163], v7 offset:256
    ds_read_b128 v[164:167], v7 offset:15104
    ds_read_b128 v[168:171], v7 offset:29952
    ds_read_b128 v[172:175], v7 offset:44800
    s_waitcnt lgkmcnt(4)
    s_waitcnt vmcnt(21)
    s_waitcnt vmcnt(20)
    v_mfma_f32_16x16x32_bf16 v[128:131], v[28:31], v[176:179], v[128:131]
    v_mfma_f32_16x16x32_bf16 v[136:139], v[28:31], v[180:183], v[136:139]
    v_mfma_f32_16x16x32_bf16 v[144:147], v[28:31], v[184:187], v[144:147]
    v_mfma_f32_16x16x32_bf16 v[152:155], v[28:31], v[188:191], v[152:155]
    v_mfma_f32_16x16x32_bf16 v[192:195], v[28:31], v[12:15], v[192:195]
    v_mfma_f32_16x16x32_bf16 v[132:135], v[84:87], v[176:179], v[132:135]
    v_mfma_f32_16x16x32_bf16 v[140:143], v[84:87], v[180:183], v[140:143]
    v_mfma_f32_16x16x32_bf16 v[148:151], v[84:87], v[184:187], v[148:151]
    v_mfma_f32_16x16x32_bf16 v[156:159], v[84:87], v[188:191], v[156:159]
    v_mfma_f32_16x16x32_bf16 v[196:199], v[84:87], v[12:15], v[196:199]
    ds_read_b128 v[176:179], v7 offset:320
    ds_read_b128 v[180:183], v7 offset:15168
    ds_read_b128 v[184:187], v7 offset:30016
    ds_read_b128 v[188:191], v7 offset:44864
    s_waitcnt lgkmcnt(4)
    s_waitcnt vmcnt(19)
    s_waitcnt vmcnt(18)
    v_mfma_f32_16x16x32_bf16 v[128:131], v[32:35], v[160:163], v[128:131]
    v_mfma_f32_16x16x32_bf16 v[136:139], v[32:35], v[164:167], v[136:139]
    v_mfma_f32_16x16x32_bf16 v[144:147], v[32:35], v[168:171], v[144:147]
    v_mfma_f32_16x16x32_bf16 v[152:155], v[32:35], v[172:175], v[152:155]
    v_mfma_f32_16x16x32_bf16 v[192:195], v[32:35], v[12:15], v[192:195]
    v_mfma_f32_16x16x32_bf16 v[132:135], v[88:91], v[160:163], v[132:135]
    v_mfma_f32_16x16x32_bf16 v[140:143], v[88:91], v[164:167], v[140:143]
    v_mfma_f32_16x16x32_bf16 v[148:151], v[88:91], v[168:171], v[148:151]
    v_mfma_f32_16x16x32_bf16 v[156:159], v[88:91], v[172:175], v[156:159]
    v_mfma_f32_16x16x32_bf16 v[196:199], v[88:91], v[12:15], v[196:199]
    ds_read_b128 v[160:163], v7 offset:384
    ds_read_b128 v[164:167], v7 offset:15232
    ds_read_b128 v[168:171], v7 offset:30080
    ds_read_b128 v[172:175], v7 offset:44928
    s_waitcnt lgkmcnt(4)
    s_waitcnt vmcnt(17)
    s_waitcnt vmcnt(16)
    v_mfma_f32_16x16x32_bf16 v[128:131], v[36:39], v[176:179], v[128:131]
    v_mfma_f32_16x16x32_bf16 v[136:139], v[36:39], v[180:183], v[136:139]
    v_mfma_f32_16x16x32_bf16 v[144:147], v[36:39], v[184:187], v[144:147]
    v_mfma_f32_16x16x32_bf16 v[152:155], v[36:39], v[188:191], v[152:155]
    v_mfma_f32_16x16x32_bf16 v[192:195], v[36:39], v[12:15], v[192:195]
    v_mfma_f32_16x16x32_bf16 v[132:135], v[92:95], v[176:179], v[132:135]
    v_mfma_f32_16x16x32_bf16 v[140:143], v[92:95], v[180:183], v[140:143]
    v_mfma_f32_16x16x32_bf16 v[148:151], v[92:95], v[184:187], v[148:151]
    v_mfma_f32_16x16x32_bf16 v[156:159], v[92:95], v[188:191], v[156:159]
    v_mfma_f32_16x16x32_bf16 v[196:199], v[92:95], v[12:15], v[196:199]
    ds_read_b128 v[176:179], v7 offset:448
    ds_read_b128 v[180:183], v7 offset:15296
    ds_read_b128 v[184:187], v7 offset:30144
    ds_read_b128 v[188:191], v7 offset:44992
    s_waitcnt lgkmcnt(4)
    s_waitcnt vmcnt(15)
    s_waitcnt vmcnt(14)
    v_mfma_f32_16x16x32_bf16 v[128:131], v[40:43], v[160:163], v[128:131]
    v_mfma_f32_16x16x32_bf16 v[136:139], v[40:43], v[164:167], v[136:139]
    v_mfma_f32_16x16x32_bf16 v[144:147], v[40:43], v[168:171], v[144:147]
    v_mfma_f32_16x16x32_bf16 v[152:155], v[40:43], v[172:175], v[152:155]
    v_mfma_f32_16x16x32_bf16 v[192:195], v[40:43], v[12:15], v[192:195]
    v_mfma_f32_16x16x32_bf16 v[132:135], v[96:99], v[160:163], v[132:135]
    v_mfma_f32_16x16x32_bf16 v[140:143], v[96:99], v[164:167], v[140:143]
    v_mfma_f32_16x16x32_bf16 v[148:151], v[96:99], v[168:171], v[148:151]
    v_mfma_f32_16x16x32_bf16 v[156:159], v[96:99], v[172:175], v[156:159]
    v_mfma_f32_16x16x32_bf16 v[196:199], v[96:99], v[12:15], v[196:199]
    ds_read_b128 v[160:163], v7 offset:512
    ds_read_b128 v[164:167], v7 offset:15360
    ds_read_b128 v[168:171], v7 offset:30208
    ds_read_b128 v[172:175], v7 offset:45056
    s_waitcnt lgkmcnt(4)
    s_waitcnt vmcnt(13)
    s_waitcnt vmcnt(12)
    v_mfma_f32_16x16x32_bf16 v[128:131], v[44:47], v[176:179], v[128:131]
    v_mfma_f32_16x16x32_bf16 v[136:139], v[44:47], v[180:183], v[136:139]
    v_mfma_f32_16x16x32_bf16 v[144:147], v[44:47], v[184:187], v[144:147]
    v_mfma_f32_16x16x32_bf16 v[152:155], v[44:47], v[188:191], v[152:155]
    v_mfma_f32_16x16x32_bf16 v[192:195], v[44:47], v[12:15], v[192:195]
    v_mfma_f32_16x16x32_bf16 v[132:135], v[100:103], v[176:179], v[132:135]
    v_mfma_f32_16x16x32_bf16 v[140:143], v[100:103], v[180:183], v[140:143]
    v_mfma_f32_16x16x32_bf16 v[148:151], v[100:103], v[184:187], v[148:151]
    v_mfma_f32_16x16x32_bf16 v[156:159], v[100:103], v[188:191], v[156:159]
    v_mfma_f32_16x16x32_bf16 v[196:199], v[100:103], v[12:15], v[196:199]
    ds_read_b128 v[176:179], v7 offset:576
    ds_read_b128 v[180:183], v7 offset:15424
    ds_read_b128 v[184:187], v7 offset:30272
    ds_read_b128 v[188:191], v7 offset:45120
    s_waitcnt lgkmcnt(4)
    s_waitcnt vmcnt(11)
    s_waitcnt vmcnt(10)
    v_mfma_f32_16x16x32_bf16 v[128:131], v[48:51], v[160:163], v[128:131]
    v_mfma_f32_16x16x32_bf16 v[136:139], v[48:51], v[164:167], v[136:139]
    v_mfma_f32_16x16x32_bf16 v[144:147], v[48:51], v[168:171], v[144:147]
    v_mfma_f32_16x16x32_bf16 v[152:155], v[48:51], v[172:175], v[152:155]
    v_mfma_f32_16x16x32_bf16 v[192:195], v[48:51], v[12:15], v[192:195]
    v_mfma_f32_16x16x32_bf16 v[132:135], v[104:107], v[160:163], v[132:135]
    v_mfma_f32_16x16x32_bf16 v[140:143], v[104:107], v[164:167], v[140:143]
    v_mfma_f32_16x16x32_bf16 v[148:151], v[104:107], v[168:171], v[148:151]
    v_mfma_f32_16x16x32_bf16 v[156:159], v[104:107], v[172:175], v[156:159]
    v_mfma_f32_16x16x32_bf16 v[196:199], v[104:107], v[12:15], v[196:199]
    ds_read_b128 v[160:163], v7 offset:640
    ds_read_b128 v[164:167], v7 offset:15488
    ds_read_b128 v[168:171], v7 offset:30336
    ds_read_b128 v[172:175], v7 offset:45184
    s_waitcnt lgkmcnt(4)
    s_waitcnt vmcnt(9)
    s_waitcnt vmcnt(8)
    v_mfma_f32_16x16x32_bf16 v[128:131], v[52:55], v[176:179], v[128:131]
    v_mfma_f32_16x16x32_bf16 v[136:139], v[52:55], v[180:183], v[136:139]
    v_mfma_f32_16x16x32_bf16 v[144:147], v[52:55], v[184:187], v[144:147]
    v_mfma_f32_16x16x32_bf16 v[152:155], v[52:55], v[188:191], v[152:155]
    v_mfma_f32_16x16x32_bf16 v[192:195], v[52:55], v[12:15], v[192:195]
    v_mfma_f32_16x16x32_bf16 v[132:135], v[108:111], v[176:179], v[132:135]
    v_mfma_f32_16x16x32_bf16 v[140:143], v[108:111], v[180:183], v[140:143]
    v_mfma_f32_16x16x32_bf16 v[148:151], v[108:111], v[184:187], v[148:151]
    v_mfma_f32_16x16x32_bf16 v[156:159], v[108:111], v[188:191], v[156:159]
    v_mfma_f32_16x16x32_bf16 v[196:199], v[108:111], v[12:15], v[196:199]
    ds_read_b128 v[176:179], v7 offset:704
    ds_read_b128 v[180:183], v7 offset:15552
    ds_read_b128 v[184:187], v7 offset:30400
    ds_read_b128 v[188:191], v7 offset:45248
    s_waitcnt lgkmcnt(4)
    s_waitcnt vmcnt(7)
    s_waitcnt vmcnt(6)
    v_mfma_f32_16x16x32_bf16 v[128:131], v[56:59], v[160:163], v[128:131]
    v_mfma_f32_16x16x32_bf16 v[136:139], v[56:59], v[164:167], v[136:139]
    v_mfma_f32_16x16x32_bf16 v[144:147], v[56:59], v[168:171], v[144:147]
    v_mfma_f32_16x16x32_bf16 v[152:155], v[56:59], v[172:175], v[152:155]
    v_mfma_f32_16x16x32_bf16 v[192:195], v[56:59], v[12:15], v[192:195]
    v_mfma_f32_16x16x32_bf16 v[132:135], v[112:115], v[160:163], v[132:135]
    v_mfma_f32_16x16x32_bf16 v[140:143], v[112:115], v[164:167], v[140:143]
    v_mfma_f32_16x16x32_bf16 v[148:151], v[112:115], v[168:171], v[148:151]
    v_mfma_f32_16x16x32_bf16 v[156:159], v[112:115], v[172:175], v[156:159]
    v_mfma_f32_16x16x32_bf16 v[196:199], v[112:115], v[12:15], v[196:199]
    ds_read_b128 v[160:163], v7 offset:768
    ds_read_b128 v[164:167], v7 offset:15616
    ds_read_b128 v[168:171], v7 offset:30464
    ds_read_b128 v[172:175], v7 offset:45312
    s_waitcnt lgkmcnt(4)
    s_waitcnt vmcnt(5)
    s_waitcnt vmcnt(4)
    v_mfma_f32_16x16x32_bf16 v[128:131], v[60:63], v[176:179], v[128:131]
    v_mfma_f32_16x16x32_bf16 v[136:139], v[60:63], v[180:183], v[136:139]
    v_mfma_f32_16x16x32_bf16 v[144:147], v[60:63], v[184:187], v[144:147]
    v_mfma_f32_16x16x32_bf16 v[152:155], v[60:63], v[188:191], v[152:155]
    v_mfma_f32_16x16x32_bf16 v[192:195], v[60:63], v[12:15], v[192:195]
    v_mfma_f32_16x16x32_bf16 v[132:135], v[116:119], v[176:179], v[132:135]
    v_mfma_f32_16x16x32_bf16 v[140:143], v[116:119], v[180:183], v[140:143]
    v_mfma_f32_16x16x32_bf16 v[148:151], v[116:119], v[184:187], v[148:151]
    v_mfma_f32_16x16x32_bf16 v[156:159], v[116:119], v[188:191], v[156:159]
    v_mfma_f32_16x16x32_bf16 v[196:199], v[116:119], v[12:15], v[196:199]
    ds_read_b128 v[176:179], v7 offset:832
    ds_read_b128 v[180:183], v7 offset:15680
    ds_read_b128 v[184:187], v7 offset:30528
    ds_read_b128 v[188:191], v7 offset:45376
    s_waitcnt lgkmcnt(4)
    s_waitcnt vmcnt(3)
    s_waitcnt vmcnt(2)
    v_mfma_f32_16x16x32_bf16 v[128:131], v[64:67], v[160:163], v[128:131]
    v_mfma_f32_16x16x32_bf16 v[136:139], v[64:67], v[164:167], v[136:139]
    v_mfma_f32_16x16x32_bf16 v[144:147], v[64:67], v[168:171], v[144:147]
    v_mfma_f32_16x16x32_bf16 v[152:155], v[64:67], v[172:175], v[152:155]
    v_mfma_f32_16x16x32_bf16 v[192:195], v[64:67], v[12:15], v[192:195]
    v_mfma_f32_16x16x32_bf16 v[132:135], v[120:123], v[160:163], v[132:135]
    v_mfma_f32_16x16x32_bf16 v[140:143], v[120:123], v[164:167], v[140:143]
    v_mfma_f32_16x16x32_bf16 v[148:151], v[120:123], v[168:171], v[148:151]
    v_mfma_f32_16x16x32_bf16 v[156:159], v[120:123], v[172:175], v[156:159]
    v_mfma_f32_16x16x32_bf16 v[196:199], v[120:123], v[12:15], v[196:199]
    s_waitcnt lgkmcnt(0)
    s_waitcnt vmcnt(1)
    s_waitcnt vmcnt(0)
    v_mfma_f32_16x16x32_bf16 v[128:131], v[68:71], v[176:179], v[128:131]
    v_mfma_f32_16x16x32_bf16 v[136:139], v[68:71], v[180:183], v[136:139]
    v_mfma_f32_16x16x32_bf16 v[144:147], v[68:71], v[184:187], v[144:147]
    v_mfma_f32_16x16x32_bf16 v[152:155], v[68:71], v[188:191], v[152:155]
    v_mfma_f32_16x16x32_bf16 v[192:195], v[68:71], v[12:15], v[192:195]
    v_mfma_f32_16x16x32_bf16 v[132:135], v[124:127], v[176:179], v[132:135]
    v_mfma_f32_16x16x32_bf16 v[140:143], v[124:127], v[180:183], v[140:143]
    v_mfma_f32_16x16x32_bf16 v[148:151], v[124:127], v[184:187], v[148:151]
    v_mfma_f32_16x16x32_bf16 v[156:159], v[124:127], v[188:191], v[156:159]
    v_mfma_f32_16x16x32_bf16 v[196:199], v[124:127], v[12:15], v[196:199]
    ds_read_b64 v[208:209], v9 offset:0
    ds_read_b64 v[210:211], v9 offset:128
    ds_read_b64 v[212:213], v9 offset:256
    ds_read_b64 v[214:215], v9 offset:384
    s_waitcnt lgkmcnt(0)
    v_mul_f32 v202, v192, v209
    v_fma_f32 v128, v128, v208, -v202
    v_mul_f32 v202, v193, v209
    v_fma_f32 v129, v129, v208, -v202
    v_mul_f32 v202, v194, v209
    v_fma_f32 v130, v130, v208, -v202
    v_mul_f32 v202, v195, v209
    v_fma_f32 v131, v131, v208, -v202
    v_cvt_pk_bf16_f32 v200, v128, v129
    v_cvt_pk_bf16_f32 v201, v130, v131
    v_lshlrev_b32 v202, 16, v200
    v_and_b32 v203, 0xffff0000, v200
    v_mul_f32 v204, v202, v202
    v_mul_f32 v205, v203, v203
    v_fma_f32 v204, v204, s29, 1.0
    v_fma_f32 v205, v205, s29, 1.0
    v_mul_f32 v204, v204, v202
    v_mul_f32 v205, v205, v203
    v_mul_f32 v204, s30, v204
    v_mul_f32 v205, s30, v205
    v_exp_f32 v204, v204
    v_exp_f32 v205, v205
    v_add_f32 v204, 1.0, v204
    v_add_f32 v205, 1.0, v205
    v_rcp_f32 v204, v204
    v_rcp_f32 v205, v205
    v_mul_f32 v202, v202, v204
    v_mul_f32 v203, v203, v205
    v_cvt_pk_bf16_f32 v200, v202, v203
    v_lshlrev_b32 v202, 16, v201
    v_and_b32 v203, 0xffff0000, v201
    v_mul_f32 v204, v202, v202
    v_mul_f32 v205, v203, v203
    v_fma_f32 v204, v204, s29, 1.0
    v_fma_f32 v205, v205, s29, 1.0
    v_mul_f32 v204, v204, v202
    v_mul_f32 v205, v205, v203
    v_mul_f32 v204, s30, v204
    v_mul_f32 v205, s30, v205
    v_exp_f32 v204, v204
    v_exp_f32 v205, v205
    v_add_f32 v204, 1.0, v204
    v_add_f32 v205, 1.0, v205
    v_rcp_f32 v204, v204
    v_rcp_f32 v205, v205
    v_mul_f32 v202, v202, v204
    v_mul_f32 v203, v203, v205
    v_cvt_pk_bf16_f32 v201, v202, v203
    buffer_store_dwordx2 v[200:201], v8, s[16:19], s50 offen offset:0
    v_mul_f32 v202, v196, v209
    v_fma_f32 v132, v132, v208, -v202
    v_mul_f32 v202, v197, v209
    v_fma_f32 v133, v133, v208, -v202
    v_mul_f32 v202, v198, v209
    v_fma_f32 v134, v134, v208, -v202
    v_mul_f32 v202, v199, v209
    v_fma_f32 v135, v135, v208, -v202
    v_cvt_pk_bf16_f32 v200, v132, v133
    v_cvt_pk_bf16_f32 v201, v134, v135
    v_lshlrev_b32 v202, 16, v200
    v_and_b32 v203, 0xffff0000, v200
    v_mul_f32 v204, v202, v202
    v_mul_f32 v205, v203, v203
    v_fma_f32 v204, v204, s29, 1.0
    v_fma_f32 v205, v205, s29, 1.0
    v_mul_f32 v204, v204, v202
    v_mul_f32 v205, v205, v203
    v_mul_f32 v204, s30, v204
    v_mul_f32 v205, s30, v205
    v_exp_f32 v204, v204
    v_exp_f32 v205, v205
    v_add_f32 v204, 1.0, v204
    v_add_f32 v205, 1.0, v205
    v_rcp_f32 v204, v204
    v_rcp_f32 v205, v205
    v_mul_f32 v202, v202, v204
    v_mul_f32 v203, v203, v205
    v_cvt_pk_bf16_f32 v200, v202, v203
    v_lshlrev_b32 v202, 16, v201
    v_and_b32 v203, 0xffff0000, v201
    v_mul_f32 v204, v202, v202
    v_mul_f32 v205, v203, v203
    v_fma_f32 v204, v204, s29, 1.0
    v_fma_f32 v205, v205, s29, 1.0
    v_mul_f32 v204, v204, v202
    v_mul_f32 v205, v205, v203
    v_mul_f32 v204, s30, v204
    v_mul_f32 v205, s30, v205
    v_exp_f32 v204, v204
    v_exp_f32 v205, v205
    v_add_f32 v204, 1.0, v204
    v_add_f32 v205, 1.0, v205
    v_rcp_f32 v204, v204
    v_rcp_f32 v205, v205
    v_mul_f32 v202, v202, v204
    v_mul_f32 v203, v203, v205
    v_cvt_pk_bf16_f32 v201, v202, v203
    buffer_store_dwordx2 v[200:201], v8, s[16:19], s50 offen offset:32
    s_add_u32 s52, s50, 57344
    v_mul_f32 v202, v192, v211
    v_fma_f32 v136, v136, v210, -v202
    v_mul_f32 v202, v193, v211
    v_fma_f32 v137, v137, v210, -v202
    v_mul_f32 v202, v194, v211
    v_fma_f32 v138, v138, v210, -v202
    v_mul_f32 v202, v195, v211
    v_fma_f32 v139, v139, v210, -v202
    v_cvt_pk_bf16_f32 v200, v136, v137
    v_cvt_pk_bf16_f32 v201, v138, v139
    v_lshlrev_b32 v202, 16, v200
    v_and_b32 v203, 0xffff0000, v200
    v_mul_f32 v204, v202, v202
    v_mul_f32 v205, v203, v203
    v_fma_f32 v204, v204, s29, 1.0
    v_fma_f32 v205, v205, s29, 1.0
    v_mul_f32 v204, v204, v202
    v_mul_f32 v205, v205, v203
    v_mul_f32 v204, s30, v204
    v_mul_f32 v205, s30, v205
    v_exp_f32 v204, v204
    v_exp_f32 v205, v205
    v_add_f32 v204, 1.0, v204
    v_add_f32 v205, 1.0, v205
    v_rcp_f32 v204, v204
    v_rcp_f32 v205, v205
    v_mul_f32 v202, v202, v204
    v_mul_f32 v203, v203, v205
    v_cvt_pk_bf16_f32 v200, v202, v203
    v_lshlrev_b32 v202, 16, v201
    v_and_b32 v203, 0xffff0000, v201
    v_mul_f32 v204, v202, v202
    v_mul_f32 v205, v203, v203
    v_fma_f32 v204, v204, s29, 1.0
    v_fma_f32 v205, v205, s29, 1.0
    v_mul_f32 v204, v204, v202
    v_mul_f32 v205, v205, v203
    v_mul_f32 v204, s30, v204
    v_mul_f32 v205, s30, v205
    v_exp_f32 v204, v204
    v_exp_f32 v205, v205
    v_add_f32 v204, 1.0, v204
    v_add_f32 v205, 1.0, v205
    v_rcp_f32 v204, v204
    v_rcp_f32 v205, v205
    v_mul_f32 v202, v202, v204
    v_mul_f32 v203, v203, v205
    v_cvt_pk_bf16_f32 v201, v202, v203
    buffer_store_dwordx2 v[200:201], v8, s[16:19], s52 offen offset:0
    v_mul_f32 v202, v196, v211
    v_fma_f32 v140, v140, v210, -v202
    v_mul_f32 v202, v197, v211
    v_fma_f32 v141, v141, v210, -v202
    v_mul_f32 v202, v198, v211
    v_fma_f32 v142, v142, v210, -v202
    v_mul_f32 v202, v199, v211
    v_fma_f32 v143, v143, v210, -v202
    v_cvt_pk_bf16_f32 v200, v140, v141
    v_cvt_pk_bf16_f32 v201, v142, v143
    v_lshlrev_b32 v202, 16, v200
    v_and_b32 v203, 0xffff0000, v200
    v_mul_f32 v204, v202, v202
    v_mul_f32 v205, v203, v203
    v_fma_f32 v204, v204, s29, 1.0
    v_fma_f32 v205, v205, s29, 1.0
    v_mul_f32 v204, v204, v202
    v_mul_f32 v205, v205, v203
    v_mul_f32 v204, s30, v204
    v_mul_f32 v205, s30, v205
    v_exp_f32 v204, v204
    v_exp_f32 v205, v205
    v_add_f32 v204, 1.0, v204
    v_add_f32 v205, 1.0, v205
    v_rcp_f32 v204, v204
    v_rcp_f32 v205, v205
    v_mul_f32 v202, v202, v204
    v_mul_f32 v203, v203, v205
    v_cvt_pk_bf16_f32 v200, v202, v203
    v_lshlrev_b32 v202, 16, v201
    v_and_b32 v203, 0xffff0000, v201
    v_mul_f32 v204, v202, v202
    v_mul_f32 v205, v203, v203
    v_fma_f32 v204, v204, s29, 1.0
    v_fma_f32 v205, v205, s29, 1.0
    v_mul_f32 v204, v204, v202
    v_mul_f32 v205, v205, v203
    v_mul_f32 v204, s30, v204
    v_mul_f32 v205, s30, v205
    v_exp_f32 v204, v204
    v_exp_f32 v205, v205
    v_add_f32 v204, 1.0, v204
    v_add_f32 v205, 1.0, v205
    v_rcp_f32 v204, v204
    v_rcp_f32 v205, v205
    v_mul_f32 v202, v202, v204
    v_mul_f32 v203, v203, v205
    v_cvt_pk_bf16_f32 v201, v202, v203
    buffer_store_dwordx2 v[200:201], v8, s[16:19], s52 offen offset:32
    s_add_u32 s52, s50, 114688
    v_mul_f32 v202, v192, v213
    v_fma_f32 v144, v144, v212, -v202
    v_mul_f32 v202, v193, v213
    v_fma_f32 v145, v145, v212, -v202
    v_mul_f32 v202, v194, v213
    v_fma_f32 v146, v146, v212, -v202
    v_mul_f32 v202, v195, v213
    v_fma_f32 v147, v147, v212, -v202
    v_cvt_pk_bf16_f32 v200, v144, v145
    v_cvt_pk_bf16_f32 v201, v146, v147
    v_lshlrev_b32 v202, 16, v200
    v_and_b32 v203, 0xffff0000, v200
    v_mul_f32 v204, v202, v202
    v_mul_f32 v205, v203, v203
    v_fma_f32 v204, v204, s29, 1.0
    v_fma_f32 v205, v205, s29, 1.0
    v_mul_f32 v204, v204, v202
    v_mul_f32 v205, v205, v203
    v_mul_f32 v204, s30, v204
    v_mul_f32 v205, s30, v205
    v_exp_f32 v204, v204
    v_exp_f32 v205, v205
    v_add_f32 v204, 1.0, v204
    v_add_f32 v205, 1.0, v205
    v_rcp_f32 v204, v204
    v_rcp_f32 v205, v205
    v_mul_f32 v202, v202, v204
    v_mul_f32 v203, v203, v205
    v_cvt_pk_bf16_f32 v200, v202, v203
    v_lshlrev_b32 v202, 16, v201
    v_and_b32 v203, 0xffff0000, v201
    v_mul_f32 v204, v202, v202
    v_mul_f32 v205, v203, v203
    v_fma_f32 v204, v204, s29, 1.0
    v_fma_f32 v205, v205, s29, 1.0
    v_mul_f32 v204, v204, v202
    v_mul_f32 v205, v205, v203
    v_mul_f32 v204, s30, v204
    v_mul_f32 v205, s30, v205
    v_exp_f32 v204, v204
    v_exp_f32 v205, v205
    v_add_f32 v204, 1.0, v204
    v_add_f32 v205, 1.0, v205
    v_rcp_f32 v204, v204
    v_rcp_f32 v205, v205
    v_mul_f32 v202, v202, v204
    v_mul_f32 v203, v203, v205
    v_cvt_pk_bf16_f32 v201, v202, v203
    buffer_store_dwordx2 v[200:201], v8, s[16:19], s52 offen offset:0
    v_mul_f32 v202, v196, v213
    v_fma_f32 v148, v148, v212, -v202
    v_mul_f32 v202, v197, v213
    v_fma_f32 v149, v149, v212, -v202
    v_mul_f32 v202, v198, v213
    v_fma_f32 v150, v150, v212, -v202
    v_mul_f32 v202, v199, v213
    v_fma_f32 v151, v151, v212, -v202
    v_cvt_pk_bf16_f32 v200, v148, v149
    v_cvt_pk_bf16_f32 v201, v150, v151
    v_lshlrev_b32 v202, 16, v200
    v_and_b32 v203, 0xffff0000, v200
    v_mul_f32 v204, v202, v202
    v_mul_f32 v205, v203, v203
    v_fma_f32 v204, v204, s29, 1.0
    v_fma_f32 v205, v205, s29, 1.0
    v_mul_f32 v204, v204, v202
    v_mul_f32 v205, v205, v203
    v_mul_f32 v204, s30, v204
    v_mul_f32 v205, s30, v205
    v_exp_f32 v204, v204
    v_exp_f32 v205, v205
    v_add_f32 v204, 1.0, v204
    v_add_f32 v205, 1.0, v205
    v_rcp_f32 v204, v204
    v_rcp_f32 v205, v205
    v_mul_f32 v202, v202, v204
    v_mul_f32 v203, v203, v205
    v_cvt_pk_bf16_f32 v200, v202, v203
    v_lshlrev_b32 v202, 16, v201
    v_and_b32 v203, 0xffff0000, v201
    v_mul_f32 v204, v202, v202
    v_mul_f32 v205, v203, v203
    v_fma_f32 v204, v204, s29, 1.0
    v_fma_f32 v205, v205, s29, 1.0
    v_mul_f32 v204, v204, v202
    v_mul_f32 v205, v205, v203
    v_mul_f32 v204, s30, v204
    v_mul_f32 v205, s30, v205
    v_exp_f32 v204, v204
    v_exp_f32 v205, v205
    v_add_f32 v204, 1.0, v204
    v_add_f32 v205, 1.0, v205
    v_rcp_f32 v204, v204
    v_rcp_f32 v205, v205
    v_mul_f32 v202, v202, v204
    v_mul_f32 v203, v203, v205
    v_cvt_pk_bf16_f32 v201, v202, v203
    buffer_store_dwordx2 v[200:201], v8, s[16:19], s52 offen offset:32
    s_add_u32 s52, s50, 172032
    v_mul_f32 v202, v192, v215
    v_fma_f32 v152, v152, v214, -v202
    v_mul_f32 v202, v193, v215
    v_fma_f32 v153, v153, v214, -v202
    v_mul_f32 v202, v194, v215
    v_fma_f32 v154, v154, v214, -v202
    v_mul_f32 v202, v195, v215
    v_fma_f32 v155, v155, v214, -v202
    v_cvt_pk_bf16_f32 v200, v152, v153
    v_cvt_pk_bf16_f32 v201, v154, v155
    v_lshlrev_b32 v202, 16, v200
    v_and_b32 v203, 0xffff0000, v200
    v_mul_f32 v204, v202, v202
    v_mul_f32 v205, v203, v203
    v_fma_f32 v204, v204, s29, 1.0
    v_fma_f32 v205, v205, s29, 1.0
    v_mul_f32 v204, v204, v202
    v_mul_f32 v205, v205, v203
    v_mul_f32 v204, s30, v204
    v_mul_f32 v205, s30, v205
    v_exp_f32 v204, v204
    v_exp_f32 v205, v205
    v_add_f32 v204, 1.0, v204
    v_add_f32 v205, 1.0, v205
    v_rcp_f32 v204, v204
    v_rcp_f32 v205, v205
    v_mul_f32 v202, v202, v204
    v_mul_f32 v203, v203, v205
    v_cvt_pk_bf16_f32 v200, v202, v203
    v_lshlrev_b32 v202, 16, v201
    v_and_b32 v203, 0xffff0000, v201
    v_mul_f32 v204, v202, v202
    v_mul_f32 v205, v203, v203
    v_fma_f32 v204, v204, s29, 1.0
    v_fma_f32 v205, v205, s29, 1.0
    v_mul_f32 v204, v204, v202
    v_mul_f32 v205, v205, v203
    v_mul_f32 v204, s30, v204
    v_mul_f32 v205, s30, v205
    v_exp_f32 v204, v204
    v_exp_f32 v205, v205
    v_add_f32 v204, 1.0, v204
    v_add_f32 v205, 1.0, v205
    v_rcp_f32 v204, v204
    v_rcp_f32 v205, v205
    v_mul_f32 v202, v202, v204
    v_mul_f32 v203, v203, v205
    v_cvt_pk_bf16_f32 v201, v202, v203
    buffer_store_dwordx2 v[200:201], v8, s[16:19], s52 offen offset:0
    v_mul_f32 v202, v196, v215
    v_fma_f32 v156, v156, v214, -v202
    v_mul_f32 v202, v197, v215
    v_fma_f32 v157, v157, v214, -v202
    v_mul_f32 v202, v198, v215
    v_fma_f32 v158, v158, v214, -v202
    v_mul_f32 v202, v199, v215
    v_fma_f32 v159, v159, v214, -v202
    v_cvt_pk_bf16_f32 v200, v156, v157
    v_cvt_pk_bf16_f32 v201, v158, v159
    v_lshlrev_b32 v202, 16, v200
    v_and_b32 v203, 0xffff0000, v200
    v_mul_f32 v204, v202, v202
    v_mul_f32 v205, v203, v203
    v_fma_f32 v204, v204, s29, 1.0
    v_fma_f32 v205, v205, s29, 1.0
    v_mul_f32 v204, v204, v202
    v_mul_f32 v205, v205, v203
    v_mul_f32 v204, s30, v204
    v_mul_f32 v205, s30, v205
    v_exp_f32 v204, v204
    v_exp_f32 v205, v205
    v_add_f32 v204, 1.0, v204
    v_add_f32 v205, 1.0, v205
    v_rcp_f32 v204, v204
    v_rcp_f32 v205, v205
    v_mul_f32 v202, v202, v204
    v_mul_f32 v203, v203, v205
    v_cvt_pk_bf16_f32 v200, v202, v203
    v_lshlrev_b32 v202, 16, v201
    v_and_b32 v203, 0xffff0000, v201
    v_mul_f32 v204, v202, v202
    v_mul_f32 v205, v203, v203
    v_fma_f32 v204, v204, s29, 1.0
    v_fma_f32 v205, v205, s29, 1.0
    v_mul_f32 v204, v204, v202
    v_mul_f32 v205, v205, v203
    v_mul_f32 v204, s30, v204
    v_mul_f32 v205, s30, v205
    v_exp_f32 v204, v204
    v_exp_f32 v205, v205
    v_add_f32 v204, 1.0, v204
    v_add_f32 v205, 1.0, v205
    v_rcp_f32 v204, v204
    v_rcp_f32 v205, v205
    v_mul_f32 v202, v202, v204
    v_mul_f32 v203, v203, v205
    v_cvt_pk_bf16_f32 v201, v202, v203
    buffer_store_dwordx2 v[200:201], v8, s[16:19], s52 offen offset:32
    s_branch L_w31_kernel_end
L_w31_kernel_end:
    s_nop 1
L_w31_kernel_done:
    s_endpgm
.globl w41_kernel
.p2align 8
.type w41_kernel,@function
w41_kernel:
    s_cmp_ge_u32 s2, 256
    s_cbranch_scc1 L_w41_kernel_done
    s_load_dwordx4 s[32:35], s[0:1], 0
    s_load_dwordx4 s[36:39], s[0:1], 64
    s_load_dwordx2 s[40:41], s[0:1], 80
    v_lshrrev_b32 v4, 6, v0
    v_and_b32 v1, 63, v0
    v_readfirstlane_b32 s3, v4
    s_lshr_b32 s7, s2, 3
    s_mul_hi_u32 s4, s7, 0x40000000
    s_mul_i32 s42, s4, 4
    s_sub_u32 s5, s7, s42
    s_and_b32 s7, s2, 7
    s_mul_i32 s7, s7, 8
    s_add_u32 s4, s4, s7
    s_mul_i32 s6, s4, 32
    v_and_b32 v2, 15, v1
    v_lshrrev_b32 v3, 4, v1
    s_mov_b32 s28, 0x3f803f80
    s_mov_b32 s29, 0x3d372713
    s_mov_b32 s30, 0xc0135761
    s_waitcnt lgkmcnt(0)
    s_mov_b32 s8, s40
    s_mov_b32 s9, s41
    s_and_b32 s9, s9, 0xffff
    s_mov_b32 s10, 0x10000000
    s_mov_b32 s11, 0x00020000
    s_add_u32 s12, s40, 0x2d86000
    s_addc_u32 s13, s41, 0
    s_and_b32 s13, s13, 0xffff
    s_mov_b32 s14, 0x700000
    s_mov_b32 s15, 0x00020000
    s_mov_b32 s16, s36
    s_mov_b32 s17, s37
    s_and_b32 s17, s17, 0xffff
    s_mov_b32 s18, 0x1c0000
    s_mov_b32 s19, 0x00020000
    s_add_u32 s20, s40, 0x2a06000
    s_addc_u32 s21, s41, 0
    s_and_b32 s21, s21, 0xffff
    s_mov_b32 s22, 0x1c0000
    s_mov_b32 s23, 0x00020000
    s_add_u32 s24, s40, 0x24c6000
    s_addc_u32 s25, s41, 0
    s_and_b32 s25, s25, 0xffff
    s_mov_b32 s26, 0x1c0000
    s_mov_b32 s27, 0x00020000
    v_lshrrev_b32 v132, 4, v1
    v_and_b32 v133, 15, v1
    s_mul_i32 s42, s3, 4
    v_add_u32 v132, s42, v132
    v_mul_u32_u24 v135, 3616, v132
    v_lshl_add_u32 v135, v133, 4, v135
    v_add_u32 v135, 256, v135
    v_add_u32 v134, s6, v132
    s_movk_i32 s42, 3584
    v_mul_lo_u32 v134, v134, s42
    v_lshl_add_u32 v134, v133, 4, v134
    buffer_load_dwordx4 v[76:79], v134, s[12:15], 0 offen offset:0
    buffer_load_dwordx4 v[80:83], v134, s[12:15], 0 offen offset:256
    buffer_load_dwordx4 v[84:87], v134, s[12:15], 0 offen offset:512
    buffer_load_dwordx4 v[88:91], v134, s[12:15], 0 offen offset:768
    buffer_load_dwordx4 v[92:95], v134, s[12:15], 0 offen offset:1024
    buffer_load_dwordx4 v[96:99], v134, s[12:15], 0 offen offset:1280
    buffer_load_dwordx4 v[100:103], v134, s[12:15], 0 offen offset:1536
    buffer_load_dwordx4 v[104:107], v134, s[12:15], 0 offen offset:1792
    buffer_load_dwordx4 v[108:111], v134, s[12:15], 0 offen offset:2048
    buffer_load_dwordx4 v[112:115], v134, s[12:15], 0 offen offset:2304
    buffer_load_dwordx4 v[116:119], v134, s[12:15], 0 offen offset:2560
    buffer_load_dwordx4 v[120:123], v134, s[12:15], 0 offen offset:2816
    buffer_load_dwordx4 v[124:127], v134, s[12:15], 0 offen offset:3072
    buffer_load_dwordx4 v[128:131], v134, s[12:15], 0 offen offset:3328
    v_lshlrev_b32 v6, 4, v1
    s_mov_b32 s43, 0
    s_cmp_eq_u32 s3, 1
    s_cselect_b32 s43, 1, s43
    s_cmp_eq_u32 s3, 2
    s_cselect_b32 s43, 2, s43
    s_cmp_eq_u32 s3, 3
    s_cselect_b32 s43, 3, s43
    s_cmp_eq_u32 s3, 4
    s_cselect_b32 s43, 4, s43
    s_cmp_eq_u32 s3, 5
    s_cselect_b32 s43, 5, s43
    s_cmp_eq_u32 s3, 6
    s_cselect_b32 s43, 6, s43
    s_mul_i32 s48, s5, 7
    s_add_u32 s48, s48, s43
    s_mul_i32 s48, s48, 57344
    s_add_u32 s48, s48, 0x3fe000
    s_barrier
    buffer_load_dwordx4 v[12:15], v6, s[8:11], s48 offen offset:0
    buffer_load_dwordx4 v[16:19], v6, s[8:11], s48 offen offset:1024
    buffer_load_dwordx4 v[20:23], v6, s[8:11], s48 offen offset:2048
    buffer_load_dwordx4 v[24:27], v6, s[8:11], s48 offen offset:3072
    s_add_u32 s49, s48, 0x1000
    buffer_load_dwordx4 v[28:31], v6, s[8:11], s49 offen offset:0
    s_add_u32 s49, s48, 0x1000
    buffer_load_dwordx4 v[32:35], v6, s[8:11], s49 offen offset:1024
    s_add_u32 s49, s48, 0x1000
    buffer_load_dwordx4 v[36:39], v6, s[8:11], s49 offen offset:2048
    s_add_u32 s49, s48, 0x1000
    buffer_load_dwordx4 v[40:43], v6, s[8:11], s49 offen offset:3072
    s_add_u32 s49, s48, 0x2000
    buffer_load_dwordx4 v[44:47], v6, s[8:11], s49 offen offset:0
    s_add_u32 s49, s48, 0x2000
    buffer_load_dwordx4 v[48:51], v6, s[8:11], s49 offen offset:1024
    s_add_u32 s49, s48, 0x2000
    buffer_load_dwordx4 v[52:55], v6, s[8:11], s49 offen offset:2048
    s_add_u32 s49, s48, 0x2000
    buffer_load_dwordx4 v[56:59], v6, s[8:11], s49 offen offset:3072
    s_add_u32 s49, s48, 0x3000
    buffer_load_dwordx4 v[60:63], v6, s[8:11], s49 offen offset:0
    s_add_u32 s49, s48, 0x3000
    buffer_load_dwordx4 v[64:67], v6, s[8:11], s49 offen offset:1024
    s_add_u32 s49, s48, 0x3000
    buffer_load_dwordx4 v[68:71], v6, s[8:11], s49 offen offset:2048
    s_add_u32 s49, s48, 0x3000
    buffer_load_dwordx4 v[72:75], v6, s[8:11], s49 offen offset:3072
    s_waitcnt vmcnt(16)
    ds_write_b128 v135, v[76:79] offset:0
    ds_write_b128 v135, v[80:83] offset:256
    ds_write_b128 v135, v[84:87] offset:512
    ds_write_b128 v135, v[88:91] offset:768
    ds_write_b128 v135, v[92:95] offset:1024
    ds_write_b128 v135, v[96:99] offset:1280
    ds_write_b128 v135, v[100:103] offset:1536
    ds_write_b128 v135, v[104:107] offset:1792
    ds_write_b128 v135, v[108:111] offset:2048
    ds_write_b128 v135, v[112:115] offset:2304
    ds_write_b128 v135, v[116:119] offset:2560
    ds_write_b128 v135, v[120:123] offset:2816
    ds_write_b128 v135, v[124:127] offset:3072
    ds_write_b128 v135, v[128:131] offset:3328
    s_waitcnt lgkmcnt(0)
    s_barrier
    v_mul_u32_u24 v7, 3616, v2
    v_lshl_add_u32 v7, v3, 4, v7
    v_add_u32 v7, 256, v7
    s_movk_i32 s42, 896
    v_mul_lo_u32 v8, v2, s42
    v_lshl_add_u32 v8, v3, 3, v8
    v_lshlrev_b32 v9, 3, v2
    s_cmp_eq_u32 s3, 0
    s_cbranch_scc1 L_w41_kernel_var_1
    s_cmp_eq_u32 s3, 1
    s_cbranch_scc1 L_w41_kernel_var_1
    s_cmp_eq_u32 s3, 2
    s_cbranch_scc1 L_w41_kernel_var_1
    s_cmp_eq_u32 s3, 3
    s_cbranch_scc1 L_w41_kernel_var_1
    s_cmp_eq_u32 s3, 4
    s_cbranch_scc1 L_w41_kernel_var_1
    s_cmp_eq_u32 s3, 5
    s_cbranch_scc1 L_w41_kernel_var_1
    s_cmp_eq_u32 s3, 6
    s_cbranch_scc1 L_w41_kernel_var_1
    s_branch L_w41_kernel_end
L_w41_kernel_var_1:
    s_nop 4
    v_mov_b32 v76, 0
    v_mov_b32 v77, 0
    v_mov_b32 v78, 0
    v_mov_b32 v79, 0
    v_mov_b32 v80, 0
    v_mov_b32 v81, 0
    v_mov_b32 v82, 0
    v_mov_b32 v83, 0
    s_mul_i32 s50, s6, 896
    s_mul_i32 s51, s5, 224
    s_add_u32 s50, s50, s51
    s_lshl_b32 s51, s43, 5
    s_add_u32 s50, s50, s51
    buffer_load_dwordx2 v[100:101], v8, s[20:23], s50 offen offset:0
    buffer_load_dwordx2 v[102:103], v8, s[24:27], s50 offen offset:0
    s_add_u32 s52, s50, 14336
    buffer_load_dwordx2 v[104:105], v8, s[20:23], s52 offen offset:0
    buffer_load_dwordx2 v[106:107], v8, s[24:27], s52 offen offset:0
    ds_read_b128 v[84:87], v7 offset:0
    ds_read_b128 v[88:91], v7 offset:57856
    ds_read_b128 v[92:95], v7 offset:64
    ds_read_b128 v[96:99], v7 offset:57920
    s_waitcnt lgkmcnt(2)
    s_waitcnt vmcnt(19)
    v_mfma_f32_16x16x32_bf16 v[76:79], v[12:15], v[84:87], v[76:79]
    v_mfma_f32_16x16x32_bf16 v[80:83], v[12:15], v[88:91], v[80:83]
    s_add_u32 s49, s48, 0x4000
    buffer_load_dwordx4 v[12:15], v6, s[8:11], s49 offen offset:0
    ds_read_b128 v[84:87], v7 offset:128
    ds_read_b128 v[88:91], v7 offset:57984
    s_waitcnt lgkmcnt(2)
    s_waitcnt vmcnt(19)
    v_mfma_f32_16x16x32_bf16 v[76:79], v[16:19], v[92:95], v[76:79]
    v_mfma_f32_16x16x32_bf16 v[80:83], v[16:19], v[96:99], v[80:83]
    s_add_u32 s49, s48, 0x4000
    buffer_load_dwordx4 v[16:19], v6, s[8:11], s49 offen offset:1024
    ds_read_b128 v[92:95], v7 offset:192
    ds_read_b128 v[96:99], v7 offset:58048
    s_waitcnt lgkmcnt(2)
    s_waitcnt vmcnt(19)
    v_mfma_f32_16x16x32_bf16 v[76:79], v[20:23], v[84:87], v[76:79]
    v_mfma_f32_16x16x32_bf16 v[80:83], v[20:23], v[88:91], v[80:83]
    s_add_u32 s49, s48, 0x4000
    buffer_load_dwordx4 v[20:23], v6, s[8:11], s49 offen offset:2048
    ds_read_b128 v[84:87], v7 offset:256
    ds_read_b128 v[88:91], v7 offset:58112
    s_waitcnt lgkmcnt(2)
    s_waitcnt vmcnt(19)
    v_mfma_f32_16x16x32_bf16 v[76:79], v[24:27], v[92:95], v[76:79]
    v_mfma_f32_16x16x32_bf16 v[80:83], v[24:27], v[96:99], v[80:83]
    s_add_u32 s49, s48, 0x4000
    buffer_load_dwordx4 v[24:27], v6, s[8:11], s49 offen offset:3072
    ds_read_b128 v[92:95], v7 offset:320
    ds_read_b128 v[96:99], v7 offset:58176
    s_waitcnt lgkmcnt(2)
    s_waitcnt vmcnt(19)
    v_mfma_f32_16x16x32_bf16 v[76:79], v[28:31], v[84:87], v[76:79]
    v_mfma_f32_16x16x32_bf16 v[80:83], v[28:31], v[88:91], v[80:83]
    s_add_u32 s49, s48, 0x5000
    buffer_load_dwordx4 v[28:31], v6, s[8:11], s49 offen offset:0
    ds_read_b128 v[84:87], v7 offset:384
    ds_read_b128 v[88:91], v7 offset:58240
    s_waitcnt lgkmcnt(2)
    s_waitcnt vmcnt(19)
    v_mfma_f32_16x16x32_bf16 v[76:79], v[32:35], v[92:95], v[76:79]
    v_mfma_f32_16x16x32_bf16 v[80:83], v[32:35], v[96:99], v[80:83]
    s_add_u32 s49, s48, 0x5000
    buffer_load_dwordx4 v[32:35], v6, s[8:11], s49 offen offset:1024
    ds_read_b128 v[92:95], v7 offset:448
    ds_read_b128 v[96:99], v7 offset:58304
    s_waitcnt lgkmcnt(2)
    s_waitcnt vmcnt(19)
    v_mfma_f32_16x16x32_bf16 v[76:79], v[36:39], v[84:87], v[76:79]
    v_mfma_f32_16x16x32_bf16 v[80:83], v[36:39], v[88:91], v[80:83]
    s_add_u32 s49, s48, 0x5000
    buffer_load_dwordx4 v[36:39], v6, s[8:11], s49 offen offset:2048
    ds_read_b128 v[84:87], v7 offset:512
    ds_read_b128 v[88:91], v7 offset:58368
    s_waitcnt lgkmcnt(2)
    s_waitcnt vmcnt(19)
    v_mfma_f32_16x16x32_bf16 v[76:79], v[40:43], v[92:95], v[76:79]
    v_mfma_f32_16x16x32_bf16 v[80:83], v[40:43], v[96:99], v[80:83]
    s_add_u32 s49, s48, 0x5000
    buffer_load_dwordx4 v[40:43], v6, s[8:11], s49 offen offset:3072
    ds_read_b128 v[92:95], v7 offset:576
    ds_read_b128 v[96:99], v7 offset:58432
    s_waitcnt lgkmcnt(2)
    s_waitcnt vmcnt(19)
    v_mfma_f32_16x16x32_bf16 v[76:79], v[44:47], v[84:87], v[76:79]
    v_mfma_f32_16x16x32_bf16 v[80:83], v[44:47], v[88:91], v[80:83]
    s_add_u32 s49, s48, 0x6000
    buffer_load_dwordx4 v[44:47], v6, s[8:11], s49 offen offset:0
    ds_read_b128 v[84:87], v7 offset:640
    ds_read_b128 v[88:91], v7 offset:58496
    s_waitcnt lgkmcnt(2)
    s_waitcnt vmcnt(19)
    v_mfma_f32_16x16x32_bf16 v[76:79], v[48:51], v[92:95], v[76:79]
    v_mfma_f32_16x16x32_bf16 v[80:83], v[48:51], v[96:99], v[80:83]
    s_add_u32 s49, s48, 0x6000
    buffer_load_dwordx4 v[48:51], v6, s[8:11], s49 offen offset:1024
    ds_read_b128 v[92:95], v7 offset:704
    ds_read_b128 v[96:99], v7 offset:58560
    s_waitcnt lgkmcnt(2)
    s_waitcnt vmcnt(19)
    v_mfma_f32_16x16x32_bf16 v[76:79], v[52:55], v[84:87], v[76:79]
    v_mfma_f32_16x16x32_bf16 v[80:83], v[52:55], v[88:91], v[80:83]
    s_add_u32 s49, s48, 0x6000
    buffer_load_dwordx4 v[52:55], v6, s[8:11], s49 offen offset:2048
    ds_read_b128 v[84:87], v7 offset:768
    ds_read_b128 v[88:91], v7 offset:58624
    s_waitcnt lgkmcnt(2)
    s_waitcnt vmcnt(19)
    v_mfma_f32_16x16x32_bf16 v[76:79], v[56:59], v[92:95], v[76:79]
    v_mfma_f32_16x16x32_bf16 v[80:83], v[56:59], v[96:99], v[80:83]
    s_add_u32 s49, s48, 0x6000
    buffer_load_dwordx4 v[56:59], v6, s[8:11], s49 offen offset:3072
    ds_read_b128 v[92:95], v7 offset:832
    ds_read_b128 v[96:99], v7 offset:58688
    s_waitcnt lgkmcnt(2)
    s_waitcnt vmcnt(19)
    v_mfma_f32_16x16x32_bf16 v[76:79], v[60:63], v[84:87], v[76:79]
    v_mfma_f32_16x16x32_bf16 v[80:83], v[60:63], v[88:91], v[80:83]
    s_add_u32 s49, s48, 0x7000
    buffer_load_dwordx4 v[60:63], v6, s[8:11], s49 offen offset:0
    ds_read_b128 v[84:87], v7 offset:896
    ds_read_b128 v[88:91], v7 offset:58752
    s_waitcnt lgkmcnt(2)
    s_waitcnt vmcnt(19)
    v_mfma_f32_16x16x32_bf16 v[76:79], v[64:67], v[92:95], v[76:79]
    v_mfma_f32_16x16x32_bf16 v[80:83], v[64:67], v[96:99], v[80:83]
    s_add_u32 s49, s48, 0x7000
    buffer_load_dwordx4 v[64:67], v6, s[8:11], s49 offen offset:1024
    ds_read_b128 v[92:95], v7 offset:960
    ds_read_b128 v[96:99], v7 offset:58816
    s_waitcnt lgkmcnt(2)
    s_waitcnt vmcnt(19)
    v_mfma_f32_16x16x32_bf16 v[76:79], v[68:71], v[84:87], v[76:79]
    v_mfma_f32_16x16x32_bf16 v[80:83], v[68:71], v[88:91], v[80:83]
    s_add_u32 s49, s48, 0x7000
    buffer_load_dwordx4 v[68:71], v6, s[8:11], s49 offen offset:2048
    ds_read_b128 v[84:87], v7 offset:1024
    ds_read_b128 v[88:91], v7 offset:58880
    s_waitcnt lgkmcnt(2)
    s_waitcnt vmcnt(19)
    v_mfma_f32_16x16x32_bf16 v[76:79], v[72:75], v[92:95], v[76:79]
    v_mfma_f32_16x16x32_bf16 v[80:83], v[72:75], v[96:99], v[80:83]
    s_add_u32 s49, s48, 0x7000
    buffer_load_dwordx4 v[72:75], v6, s[8:11], s49 offen offset:3072
    ds_read_b128 v[92:95], v7 offset:1088
    ds_read_b128 v[96:99], v7 offset:58944
    s_waitcnt lgkmcnt(2)
    s_waitcnt vmcnt(15)
    v_mfma_f32_16x16x32_bf16 v[76:79], v[12:15], v[84:87], v[76:79]
    v_mfma_f32_16x16x32_bf16 v[80:83], v[12:15], v[88:91], v[80:83]
    s_add_u32 s49, s48, 0x8000
    buffer_load_dwordx4 v[12:15], v6, s[8:11], s49 offen offset:0
    ds_read_b128 v[84:87], v7 offset:1152
    ds_read_b128 v[88:91], v7 offset:59008
    s_waitcnt lgkmcnt(2)
    s_waitcnt vmcnt(15)
    v_mfma_f32_16x16x32_bf16 v[76:79], v[16:19], v[92:95], v[76:79]
    v_mfma_f32_16x16x32_bf16 v[80:83], v[16:19], v[96:99], v[80:83]
    s_add_u32 s49, s48, 0x8000
    buffer_load_dwordx4 v[16:19], v6, s[8:11], s49 offen offset:1024
    ds_read_b128 v[92:95], v7 offset:1216
    ds_read_b128 v[96:99], v7 offset:59072
    s_waitcnt lgkmcnt(2)
    s_waitcnt vmcnt(15)
    v_mfma_f32_16x16x32_bf16 v[76:79], v[20:23], v[84:87], v[76:79]
    v_mfma_f32_16x16x32_bf16 v[80:83], v[20:23], v[88:91], v[80:83]
    s_add_u32 s49, s48, 0x8000
    buffer_load_dwordx4 v[20:23], v6, s[8:11], s49 offen offset:2048
    ds_read_b128 v[84:87], v7 offset:1280
    ds_read_b128 v[88:91], v7 offset:59136
    s_waitcnt lgkmcnt(2)
    s_waitcnt vmcnt(15)
    v_mfma_f32_16x16x32_bf16 v[76:79], v[24:27], v[92:95], v[76:79]
    v_mfma_f32_16x16x32_bf16 v[80:83], v[24:27], v[96:99], v[80:83]
    s_add_u32 s49, s48, 0x8000
    buffer_load_dwordx4 v[24:27], v6, s[8:11], s49 offen offset:3072
    ds_read_b128 v[92:95], v7 offset:1344
    ds_read_b128 v[96:99], v7 offset:59200
    s_waitcnt lgkmcnt(2)
    s_waitcnt vmcnt(15)
    v_mfma_f32_16x16x32_bf16 v[76:79], v[28:31], v[84:87], v[76:79]
    v_mfma_f32_16x16x32_bf16 v[80:83], v[28:31], v[88:91], v[80:83]
    s_add_u32 s49, s48, 0x9000
    buffer_load_dwordx4 v[28:31], v6, s[8:11], s49 offen offset:0
    ds_read_b128 v[84:87], v7 offset:1408
    ds_read_b128 v[88:91], v7 offset:59264
    s_waitcnt lgkmcnt(2)
    s_waitcnt vmcnt(15)
    v_mfma_f32_16x16x32_bf16 v[76:79], v[32:35], v[92:95], v[76:79]
    v_mfma_f32_16x16x32_bf16 v[80:83], v[32:35], v[96:99], v[80:83]
    s_add_u32 s49, s48, 0x9000
    buffer_load_dwordx4 v[32:35], v6, s[8:11], s49 offen offset:1024
    ds_read_b128 v[92:95], v7 offset:1472
    ds_read_b128 v[96:99], v7 offset:59328
    s_waitcnt lgkmcnt(2)
    s_waitcnt vmcnt(15)
    v_mfma_f32_16x16x32_bf16 v[76:79], v[36:39], v[84:87], v[76:79]
    v_mfma_f32_16x16x32_bf16 v[80:83], v[36:39], v[88:91], v[80:83]
    s_add_u32 s49, s48, 0x9000
    buffer_load_dwordx4 v[36:39], v6, s[8:11], s49 offen offset:2048
    ds_read_b128 v[84:87], v7 offset:1536
    ds_read_b128 v[88:91], v7 offset:59392
    s_waitcnt lgkmcnt(2)
    s_waitcnt vmcnt(15)
    v_mfma_f32_16x16x32_bf16 v[76:79], v[40:43], v[92:95], v[76:79]
    v_mfma_f32_16x16x32_bf16 v[80:83], v[40:43], v[96:99], v[80:83]
    s_add_u32 s49, s48, 0x9000
    buffer_load_dwordx4 v[40:43], v6, s[8:11], s49 offen offset:3072
    ds_read_b128 v[92:95], v7 offset:1600
    ds_read_b128 v[96:99], v7 offset:59456
    s_waitcnt lgkmcnt(2)
    s_waitcnt vmcnt(15)
    v_mfma_f32_16x16x32_bf16 v[76:79], v[44:47], v[84:87], v[76:79]
    v_mfma_f32_16x16x32_bf16 v[80:83], v[44:47], v[88:91], v[80:83]
    s_add_u32 s49, s48, 0xa000
    buffer_load_dwordx4 v[44:47], v6, s[8:11], s49 offen offset:0
    ds_read_b128 v[84:87], v7 offset:1664
    ds_read_b128 v[88:91], v7 offset:59520
    s_waitcnt lgkmcnt(2)
    s_waitcnt vmcnt(15)
    v_mfma_f32_16x16x32_bf16 v[76:79], v[48:51], v[92:95], v[76:79]
    v_mfma_f32_16x16x32_bf16 v[80:83], v[48:51], v[96:99], v[80:83]
    s_add_u32 s49, s48, 0xa000
    buffer_load_dwordx4 v[48:51], v6, s[8:11], s49 offen offset:1024
    ds_read_b128 v[92:95], v7 offset:1728
    ds_read_b128 v[96:99], v7 offset:59584
    s_waitcnt lgkmcnt(2)
    s_waitcnt vmcnt(15)
    v_mfma_f32_16x16x32_bf16 v[76:79], v[52:55], v[84:87], v[76:79]
    v_mfma_f32_16x16x32_bf16 v[80:83], v[52:55], v[88:91], v[80:83]
    s_add_u32 s49, s48, 0xa000
    buffer_load_dwordx4 v[52:55], v6, s[8:11], s49 offen offset:2048
    ds_read_b128 v[84:87], v7 offset:1792
    ds_read_b128 v[88:91], v7 offset:59648
    s_waitcnt lgkmcnt(2)
    s_waitcnt vmcnt(15)
    v_mfma_f32_16x16x32_bf16 v[76:79], v[56:59], v[92:95], v[76:79]
    v_mfma_f32_16x16x32_bf16 v[80:83], v[56:59], v[96:99], v[80:83]
    s_add_u32 s49, s48, 0xa000
    buffer_load_dwordx4 v[56:59], v6, s[8:11], s49 offen offset:3072
    ds_read_b128 v[92:95], v7 offset:1856
    ds_read_b128 v[96:99], v7 offset:59712
    s_waitcnt lgkmcnt(2)
    s_waitcnt vmcnt(15)
    v_mfma_f32_16x16x32_bf16 v[76:79], v[60:63], v[84:87], v[76:79]
    v_mfma_f32_16x16x32_bf16 v[80:83], v[60:63], v[88:91], v[80:83]
    s_add_u32 s49, s48, 0xb000
    buffer_load_dwordx4 v[60:63], v6, s[8:11], s49 offen offset:0
    ds_read_b128 v[84:87], v7 offset:1920
    ds_read_b128 v[88:91], v7 offset:59776
    s_waitcnt lgkmcnt(2)
    s_waitcnt vmcnt(15)
    v_mfma_f32_16x16x32_bf16 v[76:79], v[64:67], v[92:95], v[76:79]
    v_mfma_f32_16x16x32_bf16 v[80:83], v[64:67], v[96:99], v[80:83]
    s_add_u32 s49, s48, 0xb000
    buffer_load_dwordx4 v[64:67], v6, s[8:11], s49 offen offset:1024
    ds_read_b128 v[92:95], v7 offset:1984
    ds_read_b128 v[96:99], v7 offset:59840
    s_waitcnt lgkmcnt(2)
    s_waitcnt vmcnt(15)
    v_mfma_f32_16x16x32_bf16 v[76:79], v[68:71], v[84:87], v[76:79]
    v_mfma_f32_16x16x32_bf16 v[80:83], v[68:71], v[88:91], v[80:83]
    s_add_u32 s49, s48, 0xb000
    buffer_load_dwordx4 v[68:71], v6, s[8:11], s49 offen offset:2048
    ds_read_b128 v[84:87], v7 offset:2048
    ds_read_b128 v[88:91], v7 offset:59904
    s_waitcnt lgkmcnt(2)
    s_waitcnt vmcnt(15)
    v_mfma_f32_16x16x32_bf16 v[76:79], v[72:75], v[92:95], v[76:79]
    v_mfma_f32_16x16x32_bf16 v[80:83], v[72:75], v[96:99], v[80:83]
    s_add_u32 s49, s48, 0xb000
    buffer_load_dwordx4 v[72:75], v6, s[8:11], s49 offen offset:3072
    ds_read_b128 v[92:95], v7 offset:2112
    ds_read_b128 v[96:99], v7 offset:59968
    s_waitcnt lgkmcnt(2)
    s_waitcnt vmcnt(15)
    v_mfma_f32_16x16x32_bf16 v[76:79], v[12:15], v[84:87], v[76:79]
    v_mfma_f32_16x16x32_bf16 v[80:83], v[12:15], v[88:91], v[80:83]
    s_add_u32 s49, s48, 0xc000
    buffer_load_dwordx4 v[12:15], v6, s[8:11], s49 offen offset:0
    ds_read_b128 v[84:87], v7 offset:2176
    ds_read_b128 v[88:91], v7 offset:60032
    s_waitcnt lgkmcnt(2)
    s_waitcnt vmcnt(15)
    v_mfma_f32_16x16x32_bf16 v[76:79], v[16:19], v[92:95], v[76:79]
    v_mfma_f32_16x16x32_bf16 v[80:83], v[16:19], v[96:99], v[80:83]
    s_add_u32 s49, s48, 0xc000
    buffer_load_dwordx4 v[16:19], v6, s[8:11], s49 offen offset:1024
    ds_read_b128 v[92:95], v7 offset:2240
    ds_read_b128 v[96:99], v7 offset:60096
    s_waitcnt lgkmcnt(2)
    s_waitcnt vmcnt(15)
    v_mfma_f32_16x16x32_bf16 v[76:79], v[20:23], v[84:87], v[76:79]
    v_mfma_f32_16x16x32_bf16 v[80:83], v[20:23], v[88:91], v[80:83]
    s_add_u32 s49, s48, 0xc000
    buffer_load_dwordx4 v[20:23], v6, s[8:11], s49 offen offset:2048
    ds_read_b128 v[84:87], v7 offset:2304
    ds_read_b128 v[88:91], v7 offset:60160
    s_waitcnt lgkmcnt(2)
    s_waitcnt vmcnt(15)
    v_mfma_f32_16x16x32_bf16 v[76:79], v[24:27], v[92:95], v[76:79]
    v_mfma_f32_16x16x32_bf16 v[80:83], v[24:27], v[96:99], v[80:83]
    s_add_u32 s49, s48, 0xc000
    buffer_load_dwordx4 v[24:27], v6, s[8:11], s49 offen offset:3072
    ds_read_b128 v[92:95], v7 offset:2368
    ds_read_b128 v[96:99], v7 offset:60224
    s_waitcnt lgkmcnt(2)
    s_waitcnt vmcnt(15)
    v_mfma_f32_16x16x32_bf16 v[76:79], v[28:31], v[84:87], v[76:79]
    v_mfma_f32_16x16x32_bf16 v[80:83], v[28:31], v[88:91], v[80:83]
    s_add_u32 s49, s48, 0xd000
    buffer_load_dwordx4 v[28:31], v6, s[8:11], s49 offen offset:0
    ds_read_b128 v[84:87], v7 offset:2432
    ds_read_b128 v[88:91], v7 offset:60288
    s_waitcnt lgkmcnt(2)
    s_waitcnt vmcnt(15)
    v_mfma_f32_16x16x32_bf16 v[76:79], v[32:35], v[92:95], v[76:79]
    v_mfma_f32_16x16x32_bf16 v[80:83], v[32:35], v[96:99], v[80:83]
    s_add_u32 s49, s48, 0xd000
    buffer_load_dwordx4 v[32:35], v6, s[8:11], s49 offen offset:1024
    ds_read_b128 v[92:95], v7 offset:2496
    ds_read_b128 v[96:99], v7 offset:60352
    s_waitcnt lgkmcnt(2)
    s_waitcnt vmcnt(15)
    v_mfma_f32_16x16x32_bf16 v[76:79], v[36:39], v[84:87], v[76:79]
    v_mfma_f32_16x16x32_bf16 v[80:83], v[36:39], v[88:91], v[80:83]
    s_add_u32 s49, s48, 0xd000
    buffer_load_dwordx4 v[36:39], v6, s[8:11], s49 offen offset:2048
    ds_read_b128 v[84:87], v7 offset:2560
    ds_read_b128 v[88:91], v7 offset:60416
    s_waitcnt lgkmcnt(2)
    s_waitcnt vmcnt(15)
    v_mfma_f32_16x16x32_bf16 v[76:79], v[40:43], v[92:95], v[76:79]
    v_mfma_f32_16x16x32_bf16 v[80:83], v[40:43], v[96:99], v[80:83]
    s_add_u32 s49, s48, 0xd000
    buffer_load_dwordx4 v[40:43], v6, s[8:11], s49 offen offset:3072
    ds_read_b128 v[92:95], v7 offset:2624
    ds_read_b128 v[96:99], v7 offset:60480
    s_waitcnt lgkmcnt(2)
    s_waitcnt vmcnt(15)
    v_mfma_f32_16x16x32_bf16 v[76:79], v[44:47], v[84:87], v[76:79]
    v_mfma_f32_16x16x32_bf16 v[80:83], v[44:47], v[88:91], v[80:83]
    ds_read_b128 v[84:87], v7 offset:2688
    ds_read_b128 v[88:91], v7 offset:60544
    s_waitcnt lgkmcnt(2)
    s_waitcnt vmcnt(14)
    v_mfma_f32_16x16x32_bf16 v[76:79], v[48:51], v[92:95], v[76:79]
    v_mfma_f32_16x16x32_bf16 v[80:83], v[48:51], v[96:99], v[80:83]
    ds_read_b128 v[92:95], v7 offset:2752
    ds_read_b128 v[96:99], v7 offset:60608
    s_waitcnt lgkmcnt(2)
    s_waitcnt vmcnt(13)
    v_mfma_f32_16x16x32_bf16 v[76:79], v[52:55], v[84:87], v[76:79]
    v_mfma_f32_16x16x32_bf16 v[80:83], v[52:55], v[88:91], v[80:83]
    ds_read_b128 v[84:87], v7 offset:2816
    ds_read_b128 v[88:91], v7 offset:60672
    s_waitcnt lgkmcnt(2)
    s_waitcnt vmcnt(12)
    v_mfma_f32_16x16x32_bf16 v[76:79], v[56:59], v[92:95], v[76:79]
    v_mfma_f32_16x16x32_bf16 v[80:83], v[56:59], v[96:99], v[80:83]
    ds_read_b128 v[92:95], v7 offset:2880
    ds_read_b128 v[96:99], v7 offset:60736
    s_waitcnt lgkmcnt(2)
    s_waitcnt vmcnt(11)
    v_mfma_f32_16x16x32_bf16 v[76:79], v[60:63], v[84:87], v[76:79]
    v_mfma_f32_16x16x32_bf16 v[80:83], v[60:63], v[88:91], v[80:83]
    ds_read_b128 v[84:87], v7 offset:2944
    ds_read_b128 v[88:91], v7 offset:60800
    s_waitcnt lgkmcnt(2)
    s_waitcnt vmcnt(10)
    v_mfma_f32_16x16x32_bf16 v[76:79], v[64:67], v[92:95], v[76:79]
    v_mfma_f32_16x16x32_bf16 v[80:83], v[64:67], v[96:99], v[80:83]
    ds_read_b128 v[92:95], v7 offset:3008
    ds_read_b128 v[96:99], v7 offset:60864
    s_waitcnt lgkmcnt(2)
    s_waitcnt vmcnt(9)
    v_mfma_f32_16x16x32_bf16 v[76:79], v[68:71], v[84:87], v[76:79]
    v_mfma_f32_16x16x32_bf16 v[80:83], v[68:71], v[88:91], v[80:83]
    ds_read_b128 v[84:87], v7 offset:3072
    ds_read_b128 v[88:91], v7 offset:60928
    s_waitcnt lgkmcnt(2)
    s_waitcnt vmcnt(8)
    v_mfma_f32_16x16x32_bf16 v[76:79], v[72:75], v[92:95], v[76:79]
    v_mfma_f32_16x16x32_bf16 v[80:83], v[72:75], v[96:99], v[80:83]
    ds_read_b128 v[92:95], v7 offset:3136
    ds_read_b128 v[96:99], v7 offset:60992
    s_waitcnt lgkmcnt(2)
    s_waitcnt vmcnt(7)
    v_mfma_f32_16x16x32_bf16 v[76:79], v[12:15], v[84:87], v[76:79]
    v_mfma_f32_16x16x32_bf16 v[80:83], v[12:15], v[88:91], v[80:83]
    ds_read_b128 v[84:87], v7 offset:3200
    ds_read_b128 v[88:91], v7 offset:61056
    s_waitcnt lgkmcnt(2)
    s_waitcnt vmcnt(6)
    v_mfma_f32_16x16x32_bf16 v[76:79], v[16:19], v[92:95], v[76:79]
    v_mfma_f32_16x16x32_bf16 v[80:83], v[16:19], v[96:99], v[80:83]
    ds_read_b128 v[92:95], v7 offset:3264
    ds_read_b128 v[96:99], v7 offset:61120
    s_waitcnt lgkmcnt(2)
    s_waitcnt vmcnt(5)
    v_mfma_f32_16x16x32_bf16 v[76:79], v[20:23], v[84:87], v[76:79]
    v_mfma_f32_16x16x32_bf16 v[80:83], v[20:23], v[88:91], v[80:83]
    ds_read_b128 v[84:87], v7 offset:3328
    ds_read_b128 v[88:91], v7 offset:61184
    s_waitcnt lgkmcnt(2)
    s_waitcnt vmcnt(4)
    v_mfma_f32_16x16x32_bf16 v[76:79], v[24:27], v[92:95], v[76:79]
    v_mfma_f32_16x16x32_bf16 v[80:83], v[24:27], v[96:99], v[80:83]
    ds_read_b128 v[92:95], v7 offset:3392
    ds_read_b128 v[96:99], v7 offset:61248
    s_waitcnt lgkmcnt(2)
    s_waitcnt vmcnt(3)
    v_mfma_f32_16x16x32_bf16 v[76:79], v[28:31], v[84:87], v[76:79]
    v_mfma_f32_16x16x32_bf16 v[80:83], v[28:31], v[88:91], v[80:83]
    ds_read_b128 v[84:87], v7 offset:3456
    ds_read_b128 v[88:91], v7 offset:61312
    s_waitcnt lgkmcnt(2)
    s_waitcnt vmcnt(2)
    v_mfma_f32_16x16x32_bf16 v[76:79], v[32:35], v[92:95], v[76:79]
    v_mfma_f32_16x16x32_bf16 v[80:83], v[32:35], v[96:99], v[80:83]
    ds_read_b128 v[92:95], v7 offset:3520
    ds_read_b128 v[96:99], v7 offset:61376
    s_waitcnt lgkmcnt(2)
    s_waitcnt vmcnt(1)
    v_mfma_f32_16x16x32_bf16 v[76:79], v[36:39], v[84:87], v[76:79]
    v_mfma_f32_16x16x32_bf16 v[80:83], v[36:39], v[88:91], v[80:83]
    s_waitcnt lgkmcnt(0)
    s_waitcnt vmcnt(0)
    v_mfma_f32_16x16x32_bf16 v[76:79], v[40:43], v[92:95], v[76:79]
    v_mfma_f32_16x16x32_bf16 v[80:83], v[40:43], v[96:99], v[80:83]
    s_waitcnt vmcnt(40)
    s_nop 5
    v_cvt_pk_bf16_f32 v108, v76, v77
    v_cvt_pk_bf16_f32 v109, v78, v79
    v_lshlrev_b32 v112, 16, v100
    v_and_b32 v113, 0xffff0000, v100
    v_lshlrev_b32 v110, 16, v108
    v_and_b32 v111, 0xffff0000, v108
    v_add_f32 v110, v110, v112
    v_add_f32 v111, v111, v113
    v_cvt_pk_bf16_f32 v108, v110, v111
    v_lshlrev_b32 v112, 16, v101
    v_and_b32 v113, 0xffff0000, v101
    v_lshlrev_b32 v110, 16, v109
    v_and_b32 v111, 0xffff0000, v109
    v_add_f32 v110, v110, v112
    v_add_f32 v111, v111, v113
    v_cvt_pk_bf16_f32 v109, v110, v111
    v_lshlrev_b32 v112, 16, v102
    v_and_b32 v113, 0xffff0000, v102
    v_lshlrev_b32 v110, 16, v108
    v_and_b32 v111, 0xffff0000, v108
    v_add_f32 v110, v110, v112
    v_add_f32 v111, v111, v113
    v_cvt_pk_bf16_f32 v108, v110, v111
    v_lshlrev_b32 v112, 16, v103
    v_and_b32 v113, 0xffff0000, v103
    v_lshlrev_b32 v110, 16, v109
    v_and_b32 v111, 0xffff0000, v109
    v_add_f32 v110, v110, v112
    v_add_f32 v111, v111, v113
    v_cvt_pk_bf16_f32 v109, v110, v111
    buffer_store_dwordx2 v[108:109], v8, s[16:19], s50 offen offset:0
    s_add_u32 s52, s50, 14336
    v_cvt_pk_bf16_f32 v108, v80, v81
    v_cvt_pk_bf16_f32 v109, v82, v83
    v_lshlrev_b32 v112, 16, v104
    v_and_b32 v113, 0xffff0000, v104
    v_lshlrev_b32 v110, 16, v108
    v_and_b32 v111, 0xffff0000, v108
    v_add_f32 v110, v110, v112
    v_add_f32 v111, v111, v113
    v_cvt_pk_bf16_f32 v108, v110, v111
    v_lshlrev_b32 v112, 16, v105
    v_and_b32 v113, 0xffff0000, v105
    v_lshlrev_b32 v110, 16, v109
    v_and_b32 v111, 0xffff0000, v109
    v_add_f32 v110, v110, v112
    v_add_f32 v111, v111, v113
    v_cvt_pk_bf16_f32 v109, v110, v111
    v_lshlrev_b32 v112, 16, v106
    v_and_b32 v113, 0xffff0000, v106
    v_lshlrev_b32 v110, 16, v108
    v_and_b32 v111, 0xffff0000, v108
    v_add_f32 v110, v110, v112
    v_add_f32 v111, v111, v113
    v_cvt_pk_bf16_f32 v108, v110, v111
    v_lshlrev_b32 v112, 16, v107
    v_and_b32 v113, 0xffff0000, v107
    v_lshlrev_b32 v110, 16, v109
    v_and_b32 v111, 0xffff0000, v109
    v_add_f32 v110, v110, v112
    v_add_f32 v111, v111, v113
    v_cvt_pk_bf16_f32 v109, v110, v111
    buffer_store_dwordx2 v[108:109], v8, s[16:19], s52 offen offset:0
    s_branch L_w41_kernel_end
L_w41_kernel_end:
    s_nop 1
L_w41_kernel_done:
    s_endpgm
.section .rodata,"a"
.p2align 6
.amdhsa_kernel prep_kernel
  .amdhsa_next_free_vgpr 48
  .amdhsa_next_free_sgpr 72
  .amdhsa_accum_offset 48
  .amdhsa_group_segment_fixed_size 0
  .amdhsa_kernarg_size 88
  .amdhsa_user_sgpr_count 2
  .amdhsa_user_sgpr_kernarg_segment_ptr 1
  .amdhsa_system_sgpr_workgroup_id_x 1
.end_amdhsa_kernel
.p2align 6
.amdhsa_kernel qkv0_kernel
  .amdhsa_next_free_vgpr 240
  .amdhsa_next_free_sgpr 64
  .amdhsa_accum_offset 240
  .amdhsa_group_segment_fixed_size 0
  .amdhsa_kernarg_size 88
  .amdhsa_user_sgpr_count 2
  .amdhsa_user_sgpr_kernarg_segment_ptr 1
  .amdhsa_system_sgpr_workgroup_id_x 1
.end_amdhsa_kernel
.p2align 6
.amdhsa_kernel wo0_kernel
  .amdhsa_next_free_vgpr 104
  .amdhsa_next_free_sgpr 64
  .amdhsa_accum_offset 104
  .amdhsa_group_segment_fixed_size 0
  .amdhsa_kernarg_size 88
  .amdhsa_user_sgpr_count 2
  .amdhsa_user_sgpr_kernarg_segment_ptr 1
  .amdhsa_system_sgpr_workgroup_id_x 1
.end_amdhsa_kernel
.p2align 6
.amdhsa_kernel w10_kernel
  .amdhsa_next_free_vgpr 112
  .amdhsa_next_free_sgpr 64
  .amdhsa_accum_offset 112
  .amdhsa_group_segment_fixed_size 0
  .amdhsa_kernarg_size 88
  .amdhsa_user_sgpr_count 2
  .amdhsa_user_sgpr_kernarg_segment_ptr 1
  .amdhsa_system_sgpr_workgroup_id_x 1
.end_amdhsa_kernel
.p2align 6
.amdhsa_kernel w20_kernel
  .amdhsa_next_free_vgpr 112
  .amdhsa_next_free_sgpr 64
  .amdhsa_accum_offset 112
  .amdhsa_group_segment_fixed_size 0
  .amdhsa_kernarg_size 88
  .amdhsa_user_sgpr_count 2
  .amdhsa_user_sgpr_kernarg_segment_ptr 1
  .amdhsa_system_sgpr_workgroup_id_x 1
.end_amdhsa_kernel
.p2align 6
.amdhsa_kernel w30_kernel
  .amdhsa_next_free_vgpr 216
  .amdhsa_next_free_sgpr 64
  .amdhsa_accum_offset 216
  .amdhsa_group_segment_fixed_size 0
  .amdhsa_kernarg_size 88
  .amdhsa_user_sgpr_count 2
  .amdhsa_user_sgpr_kernarg_segment_ptr 1
  .amdhsa_system_sgpr_workgroup_id_x 1
.end_amdhsa_kernel
.p2align 6
.amdhsa_kernel w40_kernel
  .amdhsa_next_free_vgpr 152
  .amdhsa_next_free_sgpr 64
  .amdhsa_accum_offset 152
  .amdhsa_group_segment_fixed_size 0
  .amdhsa_kernarg_size 88
  .amdhsa_user_sgpr_count 2
  .amdhsa_user_sgpr_kernarg_segment_ptr 1
  .amdhsa_system_sgpr_workgroup_id_x 1
.end_amdhsa_kernel
.p2align 6
.amdhsa_kernel qkv1_kernel
  .amdhsa_next_free_vgpr 240
  .amdhsa_next_free_sgpr 64
  .amdhsa_accum_offset 240
  .amdhsa_group_segment_fixed_size 0
  .amdhsa_kernarg_size 88
  .amdhsa_user_sgpr_count 2
  .amdhsa_user_sgpr_kernarg_segment_ptr 1
  .amdhsa_system_sgpr_workgroup_id_x 1
.end_amdhsa_kernel
.p2align 6
.amdhsa_kernel wo1_kernel
  .amdhsa_next_free_vgpr 104
  .amdhsa_next_free_sgpr 64
  .amdhsa_accum_offset 104
  .amdhsa_group_segment_fixed_size 0
  .amdhsa_kernarg_size 88
  .amdhsa_user_sgpr_count 2
  .amdhsa_user_sgpr_kernarg_segment_ptr 1
  .amdhsa_system_sgpr_workgroup_id_x 1
.end_amdhsa_kernel
.p2align 6
.amdhsa_kernel w11_kernel
  .amdhsa_next_free_vgpr 112
  .amdhsa_next_free_sgpr 64
  .amdhsa_accum_offset 112
  .amdhsa_group_segment_fixed_size 0
  .amdhsa_kernarg_size 88
  .amdhsa_user_sgpr_count 2
  .amdhsa_user_sgpr_kernarg_segment_ptr 1
  .amdhsa_system_sgpr_workgroup_id_x 1
.end_amdhsa_kernel
.p2align 6
.amdhsa_kernel w21_kernel
  .amdhsa_next_free_vgpr 112
  .amdhsa_next_free_sgpr 64
  .amdhsa_accum_offset 112
  .amdhsa_group_segment_fixed_size 0
  .amdhsa_kernarg_size 88
  .amdhsa_user_sgpr_count 2
  .amdhsa_user_sgpr_kernarg_segment_ptr 1
  .amdhsa_system_sgpr_workgroup_id_x 1
.end_amdhsa_kernel
.p2align 6
.amdhsa_kernel w31_kernel
  .amdhsa_next_free_vgpr 216
  .amdhsa_next_free_sgpr 64
  .amdhsa_accum_offset 216
  .amdhsa_group_segment_fixed_size 0
  .amdhsa_kernarg_size 88
  .amdhsa_user_sgpr_count 2
  .amdhsa_user_sgpr_kernarg_segment_ptr 1
  .amdhsa_system_sgpr_workgroup_id_x 1
.end_amdhsa_kernel
.p2align 6
.amdhsa_kernel w41_kernel
  .amdhsa_next_free_vgpr 152
  .amdhsa_next_free_sgpr 64
  .amdhsa_accum_offset 152
  .amdhsa_group_segment_fixed_size 0
  .amdhsa_kernarg_size 88
  .amdhsa_user_sgpr_count 2
  .amdhsa_user_sgpr_kernarg_segment_ptr 1
  .amdhsa_system_sgpr_workgroup_id_x 1
.end_amdhsa_kernel
```
